```python
import torch

def _softmax(x, axis=-1):
    return torch.softmax(x, dim=axis)
def _gelu(x):
    return torch.nn.functional.gelu(x, approximate="tanh")
def _silu(x):
    return torch.nn.functional.silu(x)
def _sigmoid(x):
    return torch.sigmoid(x)
def _layernorm(x, axis=-1, eps=1e-5):
    m = x.mean(dim=axis, keepdim=True)
    v = x.var(dim=axis, keepdim=True, unbiased=False)
    return (x - m) / torch.sqrt(v + eps)
def _scatter_add(tgt, idx, src, axis=0):
    return tgt.clone().index_add_(axis, idx, src)
def _segment_sum(src, seg, n):
    out = torch.zeros((n,) + src.shape[1:], dtype=src.dtype)
    return out.index_add_(0, seg, src)
def _pad(x, pw):
    flat = tuple(v for pair in reversed(pw) for v in pair)
    return torch.nn.functional.pad(x, flat)

kernel_name = 'parallel_sum__linear_kernel_hedgehog__dense_activation_relu__prompt'

def setup_inputs():

    _w = (lambda a: (lambda t: t.to(torch.bfloat16) if t.is_floating_point() else t)(torch.as_tensor(a)))
    def _A_setup():
        B, S, D, H = 1, 2048, 640, 32
        Dh = D // H
        return {
            "x": _w((lambda *s: torch.randn(*s, dtype=torch.bfloat16) * 0.05)(B, S, D)),
            "wqkv": _w((lambda *s: torch.randn(*s, dtype=torch.bfloat16) * 0.4)(D, 3 * D)),
            "w_phi": _w((lambda *s: torch.randn(*s, dtype=torch.bfloat16) * 0.4)(H, Dh, Dh) * (Dh ** -0.5)),
            "wo": _w((lambda *s: torch.randn(*s, dtype=torch.bfloat16) * 0.1)(D, D)),
        }
    _A_in = _A_setup()

    def _B_setup():
        B, S, D, Dff = 1, 2048, 640, 1728
        return {
            "x": _w((lambda *s: torch.randn(*s, dtype=torch.bfloat16) * 0.05)(B, S, D)),
            "w1": _w((lambda *s: torch.randn(*s, dtype=torch.bfloat16) * 0.05)(D, Dff)),
            "w2": _w((lambda *s: torch.randn(*s, dtype=torch.bfloat16) * 0.05)(Dff, D)),
        }
    _B_in = _B_setup()

    return {
        "A_x": _A_in["x"],
        "A_wqkv": _A_in["wqkv"],
        "A_w_phi": _A_in["w_phi"],
        "A_wo": _A_in["wo"],
        "B_x": _B_in["x"],
        "B_w1": _B_in["w1"],
        "B_w2": _B_in["w2"],
    }

def reference(A_x, A_wqkv, A_w_phi, A_wo, B_x, B_w1, B_w2):
    def _A_ref(x, wqkv, w_phi, wo):
        B, S, D = x.shape
        H = 32; Dh = D // H
        qkv = (lambda x, *d: x.permute(*d))((x @ wqkv).reshape(B, S, 3, H, Dh), 2, 0, 3, 1, 4)
        q, k, v = qkv[0], qkv[1], qkv[2]
        pq = torch.einsum("bhsd,hdf->bhsf", q, w_phi)
        pk = torch.einsum("bhsd,hdf->bhsf", k, w_phi)
        phi_q = torch.concatenate([_softmax(pq, axis=-1), _softmax(-pq, axis=-1)], axis=-1)
        phi_k = torch.concatenate([_softmax(pk, axis=-1), _softmax(-pk, axis=-1)], axis=-1)
        kv = torch.einsum("bhsf,bhsd->bhfd", phi_k, v)
        z  = torch.einsum("bhsf->bhf", phi_k)
        num = torch.einsum("bhqf,bhfd->bhqd", phi_q, kv)
        den = torch.einsum("bhqf,bhf->bhq", phi_q, z)[..., None] + 1e-6
        o = num / den
        return (lambda x, *d: x.permute(*d))(o, 0, 2, 1, 3).reshape(B, S, D) @ wo

    def _B_ref(x, w1, w2):
        h = torch.einsum("bsd,df->bsf", x, w1)
        zero = torch.zeros_like(h)
        h = torch.maximum(h, zero)
        return torch.einsum("bsf,fd->bsd", h, w2)

    x = A_x
    xn = _layernorm(x, axis=-1)
    return x + _A_ref(xn, A_wqkv, A_w_phi, A_wo) + _B_ref(xn, B_w1, B_w2)
```

```asm
; @launch grid=(256,1,1) block=(512,1,1) lds=163840
.amdgcn_target "amdgcn-amd-amdhsa--gfx950"
.text
.globl parallel_sum__linear_kernel_hedgehog__dense_activation_relu__prompt_kernel
.p2align 8
.type parallel_sum__linear_kernel_hedgehog__dense_activation_relu__prompt_kernel,@function
parallel_sum__linear_kernel_hedgehog__dense_activation_relu__prompt_kernel:
    s_cmp_ge_u32 s2, 256
    s_cbranch_scc1 KF_EXIT
    s_nop 0
    s_load_dwordx16 s[44:59], s[0:1], 0
    s_load_dwordx4 s[60:63], s[0:1], 64
    v_and_b32 v1, 63, v0
    v_lshrrev_b32 v7, 6, v0
    s_and_b32 s37, s2, 7
    v_readfirstlane_b32 s24, v7
    s_lshr_b32 s38, s2, 3
    s_lshr_b32 s39, s37, 1
    s_and_b32 s37, s37, 1
    s_lshl_b32 s42, s39, 3
    s_lshr_b32 s40, s38, 2
    s_add_u32 s42, s42, s40
    s_lshl_b32 s43, s37, 2
    s_and_b32 s40, s38, 3
    s_add_u32 s43, s43, s40
    s_lshl_b32 s39, s39, 2
    s_and_b32 s25, s24, 3
    s_lshr_b32 s26, s24, 2
    s_or_b32 s40, s2, s24
    s_cmp_lg_u32 s40, 0
    s_cbranch_scc1 KF_NODRAW
    s_nop 0
    s_memrealtime s[6:7]
    s_waitcnt lgkmcnt(0)
    s_xor_b32 s6, s6, s7
    s_or_b32 s6, s6, 1
    v_mov_b32 v8, 0
    v_mov_b32_e64 v9, s6
    global_store_dword v8, v9, s[60:61] sc1
KF_NODRAW:
    v_mov_b32 v8, 0
    v_mov_b32 v9, 0
    v_mov_b32 v10, 0
    v_mov_b32 v11, 0
    v_mov_b32 v7, 159744
    ds_write_b128 v7, v[8:11]
    ds_write_b128 v7, v[8:11] offset:16
    s_cmp_ge_u32 s38, 28
    s_cbranch_scc1 KF_DEC_HI
    s_mul_i32 s40, s38, 37
    s_lshr_b32 s40, s40, 8
    s_add_u32 s27, s39, s40
    s_mul_i32 s40, s40, 7
    s_sub_u32 s38, s38, s40
    s_lshl_b32 s37, s37, 2
    s_add_u32 s28, s37, s38
    s_mov_b32 s29, s28
    s_cmp_lt_u32 s38, 4
    s_cbranch_scc1 KF_ATT
    s_sub_u32 s28, s28, 4
    s_add_u32 s29, s28, 8
    s_branch KF_FFN
KF_DEC_HI:
    s_lshl_b32 s37, s37, 1
    s_add_u32 s27, s39, s37
    s_and_b32 s40, s38, 1
    s_add_u32 s27, s27, s40
    s_mov_b32 s28, 3
    s_mov_b32 s29, 11
    s_cmp_lt_u32 s38, 30
    s_cbranch_scc1 KF_FFN
    s_mov_b32 s29, 15
    s_branch KF_SPARE
KF_ATT:
    v_lshrrev_b32 v7, 3, v1
    s_lshl_b32 s37, s24, 4
    v_add_u32 v7, s37, v7
    v_mul_u32_u24 v7, 1280, v7
    v_lshrrev_b32 v8, 4, v1
    v_xor_b32 v8, v8, v1
    v_and_b32_e64 v8, 7, v8
    v_lshl_add_u32 v200, v8, 4, v7
    v_xor_b32_e64 v8, 4, v8
    v_lshl_add_u32 v201, v8, 4, v7
    v_add_u32 v201, 10240, v201
    s_lshl_b32 s35, s24, 11
    s_lshr_b32 s5, s27, 2
    s_mul_i32 s5, s5, 5
    s_lshr_b32 s5, s5, 1
    s_lshl_b32 s30, s5, 7
    v_cmp_le_u32 vcc, 30, v1
    s_nop 1
    s_nop 0
    v_cndmask_b32 v7, 0, 1, vcc
    v_mul_u32_u24 v8, 30, v7
    v_sub_u32 v8, v1, v8
    v_cmp_le_u32 vcc, 15, v8
    s_nop 1
    v_cndmask_b32 v9, 0, 1, vcc
    v_mul_u32_u24 v10, 15, v9
    v_sub_u32 v8, v8, v10
    v_mul_u32_u24 v10, 52, v8
    v_lshrrev_b32 v10, 8, v10
    v_mul_u32_u24 v11, 5, v10
    v_sub_u32 v8, v8, v11
    v_mul_u32_u24 v7, 15360, v7
    v_mul_u32_u24 v10, 1280, v10
    v_add_u32_e64 v7, v7, v10
    v_mul_u32_u24 v9, 80, v9
    v_add_u32_e64 v7, v7, v9
    v_lshl_add_u32 v7, v8, 4, v7
    s_mul_i32 s37, s24, 30720
    s_mul_i32 s38, s28, 160
    s_add_u32 s37, s37, s38
    v_add_u32 v202, s37, v7
    s_mul_i32 s31, s5, 245760
    s_add_u32 s32, s31, 3840
    s_add_u32 s33, s31, 7680
    s_add_u32 s34, s31, 11520
    s_mul_i32 s36, s24, 3840
    s_add_u32 s36, s36, 49152
    v_lshlrev_b32 v204, 4, v1
    s_waitcnt lgkmcnt(0)
    s_mul_i32 s37, s27, 163840
    s_add_u32 s8, s44, s37
    s_addc_u32 s9, s45, 0
    s_and_b32 s9, s9, 0xffff
    s_mov_b32 s10, 163840
    s_mov_b32 s11, 0x20000
    s_mov_b32 s12, s46
    s_nop 0
    s_and_b32 s13, s47, 0xffff
    s_mov_b32 s14, 2457600
    s_mov_b32 s15, 0x20000
    s_add_u32 m0, s35, 0
    s_nop 0
    buffer_load_dwordx4 v200, s[8:11], s30 offen lds
    s_add_u32 m0, s35, 1024
    s_nop 0
    s_nop 0
    buffer_load_dwordx4 v201, s[8:11], s30 offen lds
    s_add_u32 s5, s5, 1
    s_cmp_eq_u32 s5, 10
    s_cselect_b32 s5, 0, s5
    s_lshl_b32 s30, s5, 7
    s_add_u32 m0, s36, 0
    s_nop 0
    s_mov_b32 exec_hi, 0x0fffffff
    buffer_load_dwordx4 v202, s[12:15], s31 offen lds
    s_mov_b32 exec_hi, -1
    s_nop 0
    s_add_u32 m0, s36, 960
    s_mov_b32 exec_hi, 0x0fffffff
    buffer_load_dwordx4 v202, s[12:15], s32 offen lds
    s_mov_b32 exec_hi, -1
    s_nop 0
    s_add_u32 m0, s36, 1920
    s_mov_b32 exec_hi, 0x0fffffff
    buffer_load_dwordx4 v202, s[12:15], s33 offen lds
    s_mov_b32 exec_hi, -1
    s_nop 0
    s_add_u32 m0, s36, 2880
    s_mov_b32 exec_hi, 0x0fffffff
    buffer_load_dwordx4 v202, s[12:15], s34 offen lds
    s_mov_b32 exec_hi, -1
    s_nop 0
    s_mul_i32 s31, s5, 245760
    s_add_u32 s32, s31, 3840
    s_add_u32 s33, s31, 7680
    s_add_u32 s34, s31, 11520
    s_mul_i32 s37, s28, 3200
    s_add_u32 s16, s48, s37
    s_addc_u32 s17, s49, 0
    s_and_b32 s17, s17, 0xffff
    s_mov_b32 s18, 3200
    s_mov_b32 s19, 0x20000
    s_lshl_b32 s37, s24, 10
    s_cmp_lt_u32 s24, 4
    s_cbranch_scc0 KF_NOMISC
    s_nop 0
    s_add_u32 m0, s37, 147456
    s_nop 0
    s_nop 0
    buffer_load_dwordx4 v204, s[16:19], s37 offen lds
KF_NOMISC:
    s_add_u32 m0, s35, 16384
    s_nop 0
    s_nop 0
    buffer_load_dwordx4 v200, s[8:11], s30 offen lds
    s_add_u32 m0, s35, 17408
    s_nop 0
    s_nop 0
    buffer_load_dwordx4 v201, s[8:11], s30 offen lds
    s_add_u32 s5, s5, 1
    s_cmp_eq_u32 s5, 10
    s_cselect_b32 s5, 0, s5
    s_lshl_b32 s30, s5, 7
    s_add_u32 m0, s36, 32768
    s_mov_b32 exec_hi, 0x0fffffff
    buffer_load_dwordx4 v202, s[12:15], s31 offen lds
    s_mov_b32 exec_hi, -1
    s_nop 0
    s_add_u32 m0, s36, 33728
    s_mov_b32 exec_hi, 0x0fffffff
    buffer_load_dwordx4 v202, s[12:15], s32 offen lds
    s_mov_b32 exec_hi, -1
    s_nop 0
    s_add_u32 m0, s36, 34688
    s_mov_b32 exec_hi, 0x0fffffff
    buffer_load_dwordx4 v202, s[12:15], s33 offen lds
    s_mov_b32 exec_hi, -1
    s_nop 0
    s_add_u32 m0, s36, 35648
    s_mov_b32 exec_hi, 0x0fffffff
    buffer_load_dwordx4 v202, s[12:15], s34 offen lds
    s_mov_b32 exec_hi, -1
    s_nop 0
    s_mul_i32 s31, s5, 245760
    s_add_u32 s32, s31, 3840
    s_add_u32 s33, s31, 7680
    s_add_u32 s34, s31, 11520
    s_mov_b32 s20, s62
    s_nop 0
    s_and_b32 s21, s63, 0xffff
    s_mov_b32 s22, 23396352
    s_mov_b32 s23, 0x20000
    s_lshl_b32 s37, s27, 7
    s_nop 0
    s_add_u32 s37, s37, 23330816
    s_and_b32 s38, s29, 7
    s_lshl_b32 s38, s38, 7
    s_add_u32 s38, s38, 23332864
    v_mov_b32 v212, s37
    v_subrev_u32 v7, 0, v1
    v_cmp_gt_u32 vcc, 8, v7
    v_lshlrev_b32 v7, 2, v7
    v_add_u32 v7, s37, v7
    v_cndmask_b32 v212, v212, v7, vcc
    v_subrev_u32 v7, 8, v1
    v_cmp_gt_u32 vcc, 16, v7
    v_lshlrev_b32 v7, 2, v7
    v_add_u32 v7, s38, v7
    v_cndmask_b32 v212, v212, v7, vcc
    v_lshrrev_b32 v2, 5, v1
    v_bfe_u32 v3, v1, 4, 1
    v_bfe_u32 v4, v1, 2, 2
    v_and_b32 v5, 3, v1
    v_and_b32 v6, 31, v1
    s_lshl_b32 s37, s25, 12
    v_lshlrev_b32 v7, 7, v6
    v_add_u32_e64 v7, s37, v7
    v_bfe_u32 v8, v6, 1, 3
    v_xor_b32_e64 v8, v8, v2
    v_lshl_add_u32 v180, v8, 4, v7
    v_xor_b32 v181, 32, v180
    v_xor_b32 v182, 64, v180
    v_xor_b32 v183, 96, v180
    v_and_b32 v7, 1, v5
    v_lshrrev_b32 v8, 1, v5
    v_lshl_add_u32 v8, v3, 1, v8
    v_lshlrev_b32_e64 v9, 3, v2
    v_lshl_add_u32 v9, v4, 1, v9
    v_mul_u32_u24 v9, 480, v9
    s_mul_i32 s37, s26, 240
    s_add_u32 s37, s37, 49152
    v_add_u32_e64 v9, s37, v9
    v_lshl_add_u32 v10, v7, 2, v8
    v_add_u32_e64 v10, 1, v10
    v_lshl_add_u32 v184, v10, 3, v9
    v_mul_u32_u24 v10, 10, v8
    v_mul_u32_u24 v11, 9, v7
    v_add_u32 v10, v10, v11
    v_add_u32 v11, 6, v7
    v_cmp_eq_u32 vcc, 3, v8
    s_nop 1
    v_cndmask_b32 v10, v10, v11, vcc
    s_nop 0
    v_lshl_add_u32 v187, v10, 3, v9
    v_add_u32 v188, 0x10000, v184
    v_add_u32 v191, 0x10000, v187
    s_waitcnt vmcnt(6)
    s_waitcnt lgkmcnt(0)
    s_barrier
    ds_read_b128 v[144:147], v180 offset:0
    ds_read_b64_tr_b16 v[128:129], v184 offset:0
    ds_read_b64_tr_b16 v[130:131], v184 offset:480
    ds_read_b64_tr_b16 v[132:133], v184 offset:80
    ds_read_b64_tr_b16 v[134:135], v184 offset:560
    ds_read_b64_tr_b16 v[136:137], v184 offset:160
    ds_read_b64_tr_b16 v[138:139], v184 offset:640
    ds_read_b64_tr_b16 v[140:141], v187 offset:0
    ds_read_b64_tr_b16 v[142:143], v187 offset:480
    s_waitcnt lgkmcnt(6)
    v_mfma_f32_32x32x16_bf16 v[64:79], v[128:131], v[144:147], 0
    ds_read_b128 v[164:167], v181 offset:0
    ds_read_b64_tr_b16 v[148:149], v184 offset:7680
    ds_read_b64_tr_b16 v[150:151], v184 offset:8160
    s_add_u32 m0, s35, 32768
    s_nop 0
    buffer_load_dwordx4 v200, s[8:11], s30 offen lds
    s_waitcnt lgkmcnt(7)
    v_mfma_f32_32x32x16_bf16 v[80:95], v[132:135], v[144:147], 0
    ds_read_b64_tr_b16 v[152:153], v184 offset:7760
    ds_read_b64_tr_b16 v[154:155], v184 offset:8240
    s_waitcnt lgkmcnt(7)
    v_mfma_f32_32x32x16_bf16 v[96:111], v[136:139], v[144:147], 0
    ds_read_b64_tr_b16 v[156:157], v184 offset:7840
    ds_read_b64_tr_b16 v[158:159], v184 offset:8320
    s_add_u32 m0, s35, 33792
    s_nop 0
    buffer_load_dwordx4 v201, s[8:11], s30 offen lds
    s_add_u32 s5, s5, 1
    s_cmp_eq_u32 s5, 10
    s_cselect_b32 s5, 0, s5
    s_lshl_b32 s30, s5, 7
    s_waitcnt lgkmcnt(7)
    v_mfma_f32_32x32x16_bf16 v[112:127], v[140:143], v[144:147], 0
    ds_read_b64_tr_b16 v[160:161], v187 offset:7680
    ds_read_b64_tr_b16 v[162:163], v187 offset:8160
    s_waitcnt lgkmcnt(6)
    v_mfma_f32_32x32x16_bf16 v[64:79], v[148:151], v[164:167], v[64:79]
    ds_read_b128 v[144:147], v182 offset:0
    ds_read_b64_tr_b16 v[128:129], v184 offset:15360
    ds_read_b64_tr_b16 v[130:131], v184 offset:15840
    s_add_u32 m0, s36, 65536
    s_mov_b32 exec_hi, 0x0fffffff
    buffer_load_dwordx4 v202, s[12:15], s31 offen lds
    s_mov_b32 exec_hi, -1
    s_waitcnt lgkmcnt(7)
    v_mfma_f32_32x32x16_bf16 v[80:95], v[152:155], v[164:167], v[80:95]
    ds_read_b64_tr_b16 v[132:133], v184 offset:15440
    ds_read_b64_tr_b16 v[134:135], v184 offset:15920
    s_waitcnt lgkmcnt(7)
    v_mfma_f32_32x32x16_bf16 v[96:111], v[156:159], v[164:167], v[96:111]
    ds_read_b64_tr_b16 v[136:137], v184 offset:15520
    ds_read_b64_tr_b16 v[138:139], v184 offset:16000
    s_add_u32 m0, s36, 66496
    s_mov_b32 exec_hi, 0x0fffffff
    buffer_load_dwordx4 v202, s[12:15], s32 offen lds
    s_mov_b32 exec_hi, -1
    s_waitcnt lgkmcnt(7)
    v_mfma_f32_32x32x16_bf16 v[112:127], v[160:163], v[164:167], v[112:127]
    ds_read_b64_tr_b16 v[140:141], v187 offset:15360
    ds_read_b64_tr_b16 v[142:143], v187 offset:15840
    s_waitcnt lgkmcnt(6)
    v_mfma_f32_32x32x16_bf16 v[64:79], v[128:131], v[144:147], v[64:79]
    ds_read_b128 v[164:167], v183 offset:0
    ds_read_b64_tr_b16 v[148:149], v184 offset:23040
    ds_read_b64_tr_b16 v[150:151], v184 offset:23520
    ds_read_b64_tr_b16 v[152:153], v184 offset:23120
    ds_read_b64_tr_b16 v[154:155], v184 offset:23600
    s_add_u32 m0, s36, 67456
    s_mov_b32 exec_hi, 0x0fffffff
    buffer_load_dwordx4 v202, s[12:15], s33 offen lds
    s_mov_b32 exec_hi, -1
    s_waitcnt lgkmcnt(9)
    v_mfma_f32_32x32x16_bf16 v[80:95], v[132:135], v[144:147], v[80:95]
    ds_read_b64_tr_b16 v[156:157], v184 offset:23200
    ds_read_b64_tr_b16 v[158:159], v184 offset:23680
    s_waitcnt lgkmcnt(9)
    v_mfma_f32_32x32x16_bf16 v[96:111], v[136:139], v[144:147], v[96:111]
    ds_read_b64_tr_b16 v[160:161], v187 offset:23040
    ds_read_b64_tr_b16 v[162:163], v187 offset:23520
    s_add_u32 m0, s36, 68416
    s_mov_b32 exec_hi, 0x0fffffff
    buffer_load_dwordx4 v202, s[12:15], s34 offen lds
    s_mov_b32 exec_hi, -1
    s_mul_i32 s31, s5, 245760
    s_add_u32 s32, s31, 3840
    s_add_u32 s33, s31, 7680
    s_add_u32 s34, s31, 11520
    s_waitcnt lgkmcnt(9)
    v_mfma_f32_32x32x16_bf16 v[112:127], v[140:143], v[144:147], v[112:127]
    s_waitcnt lgkmcnt(0)
    s_waitcnt vmcnt(6)
    s_barrier
    v_mov_b32_e64 v213, 0
    global_load_dword v213, v213, s[60:61] sc1
    v_mfma_f32_32x32x16_bf16 v[64:79], v[148:151], v[164:167], v[64:79]
    ds_read_b128 v[144:147], v180 offset:16384
    ds_read_b64_tr_b16 v[128:129], v184 offset:32768
    ds_read_b64_tr_b16 v[130:131], v184 offset:33248
    s_add_u32 m0, s35, 0
    s_nop 0
    buffer_load_dwordx4 v200, s[8:11], s30 offen lds
    v_mfma_f32_32x32x16_bf16 v[80:95], v[152:155], v[164:167], v[80:95]
    ds_read_b64_tr_b16 v[132:133], v184 offset:32848
    ds_read_b64_tr_b16 v[134:135], v184 offset:33328
    v_mfma_f32_32x32x16_bf16 v[96:111], v[156:159], v[164:167], v[96:111]
    ds_read_b64_tr_b16 v[136:137], v184 offset:32928
    ds_read_b64_tr_b16 v[138:139], v184 offset:33408
    s_add_u32 m0, s35, 1024
    s_nop 0
    buffer_load_dwordx4 v201, s[8:11], s30 offen lds
    s_add_u32 s5, s5, 1
    s_cmp_eq_u32 s5, 10
    s_cselect_b32 s5, 0, s5
    s_lshl_b32 s30, s5, 7
    v_mfma_f32_32x32x16_bf16 v[112:127], v[160:163], v[164:167], v[112:127]
    ds_read_b64_tr_b16 v[140:141], v187 offset:32768
    ds_read_b64_tr_b16 v[142:143], v187 offset:33248
    s_waitcnt lgkmcnt(6)
    v_mfma_f32_32x32x16_bf16 v[64:79], v[128:131], v[144:147], v[64:79]
    ds_read_b128 v[164:167], v181 offset:16384
    ds_read_b64_tr_b16 v[148:149], v184 offset:40448
    ds_read_b64_tr_b16 v[150:151], v184 offset:40928
    s_add_u32 m0, s36, 0
    s_mov_b32 exec_hi, 0x0fffffff
    buffer_load_dwordx4 v202, s[12:15], s31 offen lds
    s_mov_b32 exec_hi, -1
    s_waitcnt lgkmcnt(7)
    v_mfma_f32_32x32x16_bf16 v[80:95], v[132:135], v[144:147], v[80:95]
    ds_read_b64_tr_b16 v[152:153], v184 offset:40528
    ds_read_b64_tr_b16 v[154:155], v184 offset:41008
    s_waitcnt lgkmcnt(7)
    v_mfma_f32_32x32x16_bf16 v[96:111], v[136:139], v[144:147], v[96:111]
    ds_read_b64_tr_b16 v[156:157], v184 offset:40608
    ds_read_b64_tr_b16 v[158:159], v184 offset:41088
    s_add_u32 m0, s36, 960
    s_mov_b32 exec_hi, 0x0fffffff
    buffer_load_dwordx4 v202, s[12:15], s32 offen lds
    s_mov_b32 exec_hi, -1
    s_waitcnt lgkmcnt(7)
    v_mfma_f32_32x32x16_bf16 v[112:127], v[140:143], v[144:147], v[112:127]
    ds_read_b64_tr_b16 v[160:161], v187 offset:40448
    ds_read_b64_tr_b16 v[162:163], v187 offset:40928
    s_waitcnt lgkmcnt(6)
    v_mfma_f32_32x32x16_bf16 v[64:79], v[148:151], v[164:167], v[64:79]
    ds_read_b128 v[144:147], v182 offset:16384
    ds_read_b64_tr_b16 v[128:129], v184 offset:48128
    ds_read_b64_tr_b16 v[130:131], v184 offset:48608
    s_add_u32 m0, s36, 1920
    s_mov_b32 exec_hi, 0x0fffffff
    buffer_load_dwordx4 v202, s[12:15], s33 offen lds
    s_mov_b32 exec_hi, -1
    s_waitcnt lgkmcnt(7)
    v_mfma_f32_32x32x16_bf16 v[80:95], v[152:155], v[164:167], v[80:95]
    ds_read_b64_tr_b16 v[132:133], v184 offset:48208
    ds_read_b64_tr_b16 v[134:135], v184 offset:48688
    s_waitcnt lgkmcnt(7)
    v_mfma_f32_32x32x16_bf16 v[96:111], v[156:159], v[164:167], v[96:111]
    ds_read_b64_tr_b16 v[136:137], v184 offset:48288
    ds_read_b64_tr_b16 v[138:139], v184 offset:48768
    s_waitcnt lgkmcnt(7)
    v_mfma_f32_32x32x16_bf16 v[112:127], v[160:163], v[164:167], v[112:127]
    ds_read_b64_tr_b16 v[140:141], v187 offset:48128
    ds_read_b64_tr_b16 v[142:143], v187 offset:48608
    s_waitcnt lgkmcnt(6)
    v_mfma_f32_32x32x16_bf16 v[64:79], v[128:131], v[144:147], v[64:79]
    ds_read_b128 v[164:167], v183 offset:16384
    ds_read_b64_tr_b16 v[148:149], v184 offset:55808
    ds_read_b64_tr_b16 v[150:151], v184 offset:56288
    ds_read_b64_tr_b16 v[152:153], v184 offset:55888
    ds_read_b64_tr_b16 v[154:155], v184 offset:56368
    s_add_u32 m0, s36, 2880
    s_mov_b32 exec_hi, 0x0fffffff
    buffer_load_dwordx4 v202, s[12:15], s34 offen lds
    s_mov_b32 exec_hi, -1
    s_mul_i32 s31, s5, 245760
    s_add_u32 s32, s31, 3840
    s_add_u32 s33, s31, 7680
    s_add_u32 s34, s31, 11520
    s_waitcnt lgkmcnt(9)
    v_mfma_f32_32x32x16_bf16 v[80:95], v[132:135], v[144:147], v[80:95]
    ds_read_b64_tr_b16 v[156:157], v184 offset:55968
    ds_read_b64_tr_b16 v[158:159], v184 offset:56448
    s_waitcnt lgkmcnt(9)
    v_mfma_f32_32x32x16_bf16 v[96:111], v[136:139], v[144:147], v[96:111]
    ds_read_b64_tr_b16 v[160:161], v187 offset:55808
    ds_read_b64_tr_b16 v[162:163], v187 offset:56288
    s_waitcnt lgkmcnt(9)
    v_mfma_f32_32x32x16_bf16 v[112:127], v[140:143], v[144:147], v[112:127]
    s_waitcnt lgkmcnt(0)
    s_waitcnt vmcnt(6)
KF_NON_AN:
    v_readfirstlane_b32 s4, v213
    s_nop 0
    s_cmp_lg_u32 s4, 0
    s_cbranch_scc1 KF_NOK_AN
    s_sleep 8
    v_mov_b32 v213, 0
    global_load_dword v213, v213, s[60:61] sc1
    s_waitcnt vmcnt(0)
    s_branch KF_NON_AN
KF_NOK_AN:
    s_barrier
    v_mfma_f32_32x32x16_bf16 v[64:79], v[148:151], v[164:167], v[64:79]
    ds_read_b128 v[144:147], v180 offset:32768
    ds_read_b64_tr_b16 v[128:129], v188 offset:0
    ds_read_b64_tr_b16 v[130:131], v188 offset:480
    s_add_u32 m0, s35, 16384
    s_nop 0
    buffer_load_dwordx4 v200, s[8:11], s30 offen lds
    v_mfma_f32_32x32x16_bf16 v[80:95], v[152:155], v[164:167], v[80:95]
    ds_read_b64_tr_b16 v[132:133], v188 offset:80
    ds_read_b64_tr_b16 v[134:135], v188 offset:560
    v_mfma_f32_32x32x16_bf16 v[96:111], v[156:159], v[164:167], v[96:111]
    ds_read_b64_tr_b16 v[136:137], v188 offset:160
    ds_read_b64_tr_b16 v[138:139], v188 offset:640
    s_add_u32 m0, s35, 17408
    s_nop 0
    buffer_load_dwordx4 v201, s[8:11], s30 offen lds
    s_add_u32 s5, s5, 1
    s_cmp_eq_u32 s5, 10
    s_cselect_b32 s5, 0, s5
    s_lshl_b32 s30, s5, 7
    v_mfma_f32_32x32x16_bf16 v[112:127], v[160:163], v[164:167], v[112:127]
    ds_read_b64_tr_b16 v[140:141], v191 offset:0
    ds_read_b64_tr_b16 v[142:143], v191 offset:480
    s_waitcnt lgkmcnt(6)
    v_mfma_f32_32x32x16_bf16 v[64:79], v[128:131], v[144:147], v[64:79]
    ds_read_b128 v[164:167], v181 offset:32768
    ds_read_b64_tr_b16 v[148:149], v188 offset:7680
    ds_read_b64_tr_b16 v[150:151], v188 offset:8160
    s_add_u32 m0, s36, 32768
    s_mov_b32 exec_hi, 0x0fffffff
    buffer_load_dwordx4 v202, s[12:15], s31 offen lds
    s_mov_b32 exec_hi, -1
    s_waitcnt lgkmcnt(7)
    v_mfma_f32_32x32x16_bf16 v[80:95], v[132:135], v[144:147], v[80:95]
    ds_read_b64_tr_b16 v[152:153], v188 offset:7760
    ds_read_b64_tr_b16 v[154:155], v188 offset:8240
    s_waitcnt lgkmcnt(7)
    v_mfma_f32_32x32x16_bf16 v[96:111], v[136:139], v[144:147], v[96:111]
    ds_read_b64_tr_b16 v[156:157], v188 offset:7840
    ds_read_b64_tr_b16 v[158:159], v188 offset:8320
    s_add_u32 m0, s36, 33728
    s_mov_b32 exec_hi, 0x0fffffff
    buffer_load_dwordx4 v202, s[12:15], s32 offen lds
    s_mov_b32 exec_hi, -1
    s_waitcnt lgkmcnt(7)
    v_mfma_f32_32x32x16_bf16 v[112:127], v[140:143], v[144:147], v[112:127]
    ds_read_b64_tr_b16 v[160:161], v191 offset:7680
    ds_read_b64_tr_b16 v[162:163], v191 offset:8160
    s_waitcnt lgkmcnt(6)
    v_mfma_f32_32x32x16_bf16 v[64:79], v[148:151], v[164:167], v[64:79]
    ds_read_b128 v[144:147], v182 offset:32768
    ds_read_b64_tr_b16 v[128:129], v188 offset:15360
    ds_read_b64_tr_b16 v[130:131], v188 offset:15840
    s_add_u32 m0, s36, 34688
    s_mov_b32 exec_hi, 0x0fffffff
    buffer_load_dwordx4 v202, s[12:15], s33 offen lds
    s_mov_b32 exec_hi, -1
    s_waitcnt lgkmcnt(7)
    v_mfma_f32_32x32x16_bf16 v[80:95], v[152:155], v[164:167], v[80:95]
    ds_read_b64_tr_b16 v[132:133], v188 offset:15440
    ds_read_b64_tr_b16 v[134:135], v188 offset:15920
    s_waitcnt lgkmcnt(7)
    v_mfma_f32_32x32x16_bf16 v[96:111], v[156:159], v[164:167], v[96:111]
    ds_read_b64_tr_b16 v[136:137], v188 offset:15520
    ds_read_b64_tr_b16 v[138:139], v188 offset:16000
    s_waitcnt lgkmcnt(7)
    v_mfma_f32_32x32x16_bf16 v[112:127], v[160:163], v[164:167], v[112:127]
    ds_read_b64_tr_b16 v[140:141], v191 offset:15360
    ds_read_b64_tr_b16 v[142:143], v191 offset:15840
    s_waitcnt lgkmcnt(6)
    v_mfma_f32_32x32x16_bf16 v[64:79], v[128:131], v[144:147], v[64:79]
    ds_read_b128 v[164:167], v183 offset:32768
    ds_read_b64_tr_b16 v[148:149], v188 offset:23040
    ds_read_b64_tr_b16 v[150:151], v188 offset:23520
    ds_read_b64_tr_b16 v[152:153], v188 offset:23120
    ds_read_b64_tr_b16 v[154:155], v188 offset:23600
    s_add_u32 m0, s36, 35648
    s_mov_b32 exec_hi, 0x0fffffff
    buffer_load_dwordx4 v202, s[12:15], s34 offen lds
    s_mov_b32 exec_hi, -1
    s_mul_i32 s31, s5, 245760
    s_add_u32 s32, s31, 3840
    s_add_u32 s33, s31, 7680
    s_add_u32 s34, s31, 11520
    s_waitcnt lgkmcnt(9)
    v_mfma_f32_32x32x16_bf16 v[80:95], v[132:135], v[144:147], v[80:95]
    ds_read_b64_tr_b16 v[156:157], v188 offset:23200
    ds_read_b64_tr_b16 v[158:159], v188 offset:23680
    s_waitcnt lgkmcnt(9)
    v_mfma_f32_32x32x16_bf16 v[96:111], v[136:139], v[144:147], v[96:111]
    ds_read_b64_tr_b16 v[160:161], v191 offset:23040
    ds_read_b64_tr_b16 v[162:163], v191 offset:23520
    s_waitcnt lgkmcnt(9)
    v_mfma_f32_32x32x16_bf16 v[112:127], v[140:143], v[144:147], v[112:127]
    s_waitcnt lgkmcnt(0)
    s_waitcnt vmcnt(6)
    s_barrier
    v_mfma_f32_32x32x16_bf16 v[64:79], v[148:151], v[164:167], v[64:79]
    ds_read_b128 v[144:147], v180 offset:0
    ds_read_b64_tr_b16 v[128:129], v184 offset:0
    ds_read_b64_tr_b16 v[130:131], v184 offset:480
    s_add_u32 m0, s35, 32768
    s_nop 0
    buffer_load_dwordx4 v200, s[8:11], s30 offen lds
    v_mfma_f32_32x32x16_bf16 v[80:95], v[152:155], v[164:167], v[80:95]
    ds_read_b64_tr_b16 v[132:133], v184 offset:80
    ds_read_b64_tr_b16 v[134:135], v184 offset:560
    v_mfma_f32_32x32x16_bf16 v[96:111], v[156:159], v[164:167], v[96:111]
    ds_read_b64_tr_b16 v[136:137], v184 offset:160
    ds_read_b64_tr_b16 v[138:139], v184 offset:640
    s_add_u32 m0, s35, 33792
    s_nop 0
    buffer_load_dwordx4 v201, s[8:11], s30 offen lds
    s_add_u32 s5, s5, 1
    s_cmp_eq_u32 s5, 10
    s_cselect_b32 s5, 0, s5
    s_lshl_b32 s30, s5, 7
    v_mfma_f32_32x32x16_bf16 v[112:127], v[160:163], v[164:167], v[112:127]
    ds_read_b64_tr_b16 v[140:141], v187 offset:0
    ds_read_b64_tr_b16 v[142:143], v187 offset:480
    s_waitcnt lgkmcnt(6)
    v_mfma_f32_32x32x16_bf16 v[64:79], v[128:131], v[144:147], v[64:79]
    ds_read_b128 v[164:167], v181 offset:0
    ds_read_b64_tr_b16 v[148:149], v184 offset:7680
    ds_read_b64_tr_b16 v[150:151], v184 offset:8160
    s_add_u32 m0, s36, 65536
    s_mov_b32 exec_hi, 0x0fffffff
    buffer_load_dwordx4 v202, s[12:15], s31 offen lds
    s_mov_b32 exec_hi, -1
    s_waitcnt lgkmcnt(7)
    v_mfma_f32_32x32x16_bf16 v[80:95], v[132:135], v[144:147], v[80:95]
    ds_read_b64_tr_b16 v[152:153], v184 offset:7760
    ds_read_b64_tr_b16 v[154:155], v184 offset:8240
    s_waitcnt lgkmcnt(7)
    v_mfma_f32_32x32x16_bf16 v[96:111], v[136:139], v[144:147], v[96:111]
    ds_read_b64_tr_b16 v[156:157], v184 offset:7840
    ds_read_b64_tr_b16 v[158:159], v184 offset:8320
    s_add_u32 m0, s36, 66496
    s_mov_b32 exec_hi, 0x0fffffff
    buffer_load_dwordx4 v202, s[12:15], s32 offen lds
    s_mov_b32 exec_hi, -1
    s_waitcnt lgkmcnt(7)
    v_mfma_f32_32x32x16_bf16 v[112:127], v[140:143], v[144:147], v[112:127]
    ds_read_b64_tr_b16 v[160:161], v187 offset:7680
    ds_read_b64_tr_b16 v[162:163], v187 offset:8160
    s_waitcnt lgkmcnt(6)
    v_mfma_f32_32x32x16_bf16 v[64:79], v[148:151], v[164:167], v[64:79]
    ds_read_b128 v[144:147], v182 offset:0
    ds_read_b64_tr_b16 v[128:129], v184 offset:15360
    ds_read_b64_tr_b16 v[130:131], v184 offset:15840
    s_add_u32 m0, s36, 67456
    s_mov_b32 exec_hi, 0x0fffffff
    buffer_load_dwordx4 v202, s[12:15], s33 offen lds
    s_mov_b32 exec_hi, -1
    s_waitcnt lgkmcnt(7)
    v_mfma_f32_32x32x16_bf16 v[80:95], v[152:155], v[164:167], v[80:95]
    ds_read_b64_tr_b16 v[132:133], v184 offset:15440
    ds_read_b64_tr_b16 v[134:135], v184 offset:15920
    s_waitcnt lgkmcnt(7)
    v_mfma_f32_32x32x16_bf16 v[96:111], v[156:159], v[164:167], v[96:111]
    ds_read_b64_tr_b16 v[136:137], v184 offset:15520
    ds_read_b64_tr_b16 v[138:139], v184 offset:16000
    s_waitcnt lgkmcnt(7)
    v_mfma_f32_32x32x16_bf16 v[112:127], v[160:163], v[164:167], v[112:127]
    ds_read_b64_tr_b16 v[140:141], v187 offset:15360
    ds_read_b64_tr_b16 v[142:143], v187 offset:15840
    s_waitcnt lgkmcnt(6)
    v_mfma_f32_32x32x16_bf16 v[64:79], v[128:131], v[144:147], v[64:79]
    ds_read_b128 v[164:167], v183 offset:0
    ds_read_b64_tr_b16 v[148:149], v184 offset:23040
    ds_read_b64_tr_b16 v[150:151], v184 offset:23520
    ds_read_b64_tr_b16 v[152:153], v184 offset:23120
    ds_read_b64_tr_b16 v[154:155], v184 offset:23600
    s_add_u32 m0, s36, 68416
    s_mov_b32 exec_hi, 0x0fffffff
    buffer_load_dwordx4 v202, s[12:15], s34 offen lds
    s_mov_b32 exec_hi, -1
    s_mul_i32 s31, s5, 245760
    s_add_u32 s32, s31, 3840
    s_add_u32 s33, s31, 7680
    s_add_u32 s34, s31, 11520
    s_waitcnt lgkmcnt(9)
    v_mfma_f32_32x32x16_bf16 v[80:95], v[132:135], v[144:147], v[80:95]
    ds_read_b64_tr_b16 v[156:157], v184 offset:23200
    ds_read_b64_tr_b16 v[158:159], v184 offset:23680
    s_waitcnt lgkmcnt(9)
    v_mfma_f32_32x32x16_bf16 v[96:111], v[136:139], v[144:147], v[96:111]
    ds_read_b64_tr_b16 v[160:161], v187 offset:23040
    ds_read_b64_tr_b16 v[162:163], v187 offset:23520
    s_waitcnt lgkmcnt(9)
    v_mfma_f32_32x32x16_bf16 v[112:127], v[140:143], v[144:147], v[112:127]
    s_waitcnt lgkmcnt(0)
    s_waitcnt vmcnt(6)
    s_barrier
    v_mfma_f32_32x32x16_bf16 v[64:79], v[148:151], v[164:167], v[64:79]
    ds_read_b128 v[144:147], v180 offset:16384
    ds_read_b64_tr_b16 v[128:129], v184 offset:32768
    ds_read_b64_tr_b16 v[130:131], v184 offset:33248
    s_add_u32 m0, s35, 0
    s_nop 0
    buffer_load_dwordx4 v200, s[8:11], s30 offen lds
    v_mfma_f32_32x32x16_bf16 v[80:95], v[152:155], v[164:167], v[80:95]
    ds_read_b64_tr_b16 v[132:133], v184 offset:32848
    ds_read_b64_tr_b16 v[134:135], v184 offset:33328
    v_mfma_f32_32x32x16_bf16 v[96:111], v[156:159], v[164:167], v[96:111]
    ds_read_b64_tr_b16 v[136:137], v184 offset:32928
    ds_read_b64_tr_b16 v[138:139], v184 offset:33408
    s_add_u32 m0, s35, 1024
    s_nop 0
    buffer_load_dwordx4 v201, s[8:11], s30 offen lds
    s_add_u32 s5, s5, 1
    s_cmp_eq_u32 s5, 10
    s_cselect_b32 s5, 0, s5
    s_lshl_b32 s30, s5, 7
    v_mfma_f32_32x32x16_bf16 v[112:127], v[160:163], v[164:167], v[112:127]
    ds_read_b64_tr_b16 v[140:141], v187 offset:32768
    ds_read_b64_tr_b16 v[142:143], v187 offset:33248
    s_waitcnt lgkmcnt(6)
    v_mfma_f32_32x32x16_bf16 v[64:79], v[128:131], v[144:147], v[64:79]
    ds_read_b128 v[164:167], v181 offset:16384
    ds_read_b64_tr_b16 v[148:149], v184 offset:40448
    ds_read_b64_tr_b16 v[150:151], v184 offset:40928
    s_add_u32 m0, s36, 0
    s_mov_b32 exec_hi, 0x0fffffff
    buffer_load_dwordx4 v202, s[12:15], s31 offen lds
    s_mov_b32 exec_hi, -1
    s_waitcnt lgkmcnt(7)
    v_mfma_f32_32x32x16_bf16 v[80:95], v[132:135], v[144:147], v[80:95]
    ds_read_b64_tr_b16 v[152:153], v184 offset:40528
    ds_read_b64_tr_b16 v[154:155], v184 offset:41008
    s_waitcnt lgkmcnt(7)
    v_mfma_f32_32x32x16_bf16 v[96:111], v[136:139], v[144:147], v[96:111]
    ds_read_b64_tr_b16 v[156:157], v184 offset:40608
    ds_read_b64_tr_b16 v[158:159], v184 offset:41088
    s_add_u32 m0, s36, 960
    s_mov_b32 exec_hi, 0x0fffffff
    buffer_load_dwordx4 v202, s[12:15], s32 offen lds
    s_mov_b32 exec_hi, -1
    s_waitcnt lgkmcnt(7)
    v_mfma_f32_32x32x16_bf16 v[112:127], v[140:143], v[144:147], v[112:127]
    ds_read_b64_tr_b16 v[160:161], v187 offset:40448
    ds_read_b64_tr_b16 v[162:163], v187 offset:40928
    s_waitcnt lgkmcnt(6)
    v_mfma_f32_32x32x16_bf16 v[64:79], v[148:151], v[164:167], v[64:79]
    ds_read_b128 v[144:147], v182 offset:16384
    ds_read_b64_tr_b16 v[128:129], v184 offset:48128
    ds_read_b64_tr_b16 v[130:131], v184 offset:48608
    s_add_u32 m0, s36, 1920
    s_mov_b32 exec_hi, 0x0fffffff
    buffer_load_dwordx4 v202, s[12:15], s33 offen lds
    s_mov_b32 exec_hi, -1
    s_waitcnt lgkmcnt(7)
    v_mfma_f32_32x32x16_bf16 v[80:95], v[152:155], v[164:167], v[80:95]
    ds_read_b64_tr_b16 v[132:133], v184 offset:48208
    ds_read_b64_tr_b16 v[134:135], v184 offset:48688
    s_waitcnt lgkmcnt(7)
    v_mfma_f32_32x32x16_bf16 v[96:111], v[156:159], v[164:167], v[96:111]
    ds_read_b64_tr_b16 v[136:137], v184 offset:48288
    ds_read_b64_tr_b16 v[138:139], v184 offset:48768
    s_waitcnt lgkmcnt(7)
    v_mfma_f32_32x32x16_bf16 v[112:127], v[160:163], v[164:167], v[112:127]
    ds_read_b64_tr_b16 v[140:141], v187 offset:48128
    ds_read_b64_tr_b16 v[142:143], v187 offset:48608
    s_waitcnt lgkmcnt(6)
    v_mfma_f32_32x32x16_bf16 v[64:79], v[128:131], v[144:147], v[64:79]
    ds_read_b128 v[164:167], v183 offset:16384
    ds_read_b64_tr_b16 v[148:149], v184 offset:55808
    ds_read_b64_tr_b16 v[150:151], v184 offset:56288
    ds_read_b64_tr_b16 v[152:153], v184 offset:55888
    ds_read_b64_tr_b16 v[154:155], v184 offset:56368
    s_add_u32 m0, s36, 2880
    s_mov_b32 exec_hi, 0x0fffffff
    buffer_load_dwordx4 v202, s[12:15], s34 offen lds
    s_mov_b32 exec_hi, -1
    s_mul_i32 s31, s5, 245760
    s_add_u32 s32, s31, 3840
    s_add_u32 s33, s31, 7680
    s_add_u32 s34, s31, 11520
    s_waitcnt lgkmcnt(9)
    v_mfma_f32_32x32x16_bf16 v[80:95], v[132:135], v[144:147], v[80:95]
    ds_read_b64_tr_b16 v[156:157], v184 offset:55968
    ds_read_b64_tr_b16 v[158:159], v184 offset:56448
    s_waitcnt lgkmcnt(9)
    v_mfma_f32_32x32x16_bf16 v[96:111], v[136:139], v[144:147], v[96:111]
    ds_read_b64_tr_b16 v[160:161], v187 offset:55808
    ds_read_b64_tr_b16 v[162:163], v187 offset:56288
    s_waitcnt lgkmcnt(9)
    v_mfma_f32_32x32x16_bf16 v[112:127], v[140:143], v[144:147], v[112:127]
    s_waitcnt lgkmcnt(0)
    s_waitcnt vmcnt(6)
    s_barrier
    v_mfma_f32_32x32x16_bf16 v[64:79], v[148:151], v[164:167], v[64:79]
    ds_read_b128 v[144:147], v180 offset:32768
    ds_read_b64_tr_b16 v[128:129], v188 offset:0
    ds_read_b64_tr_b16 v[130:131], v188 offset:480
    s_add_u32 m0, s35, 16384
    s_nop 0
    buffer_load_dwordx4 v200, s[8:11], s30 offen lds
    v_mfma_f32_32x32x16_bf16 v[80:95], v[152:155], v[164:167], v[80:95]
    ds_read_b64_tr_b16 v[132:133], v188 offset:80
    ds_read_b64_tr_b16 v[134:135], v188 offset:560
    v_mfma_f32_32x32x16_bf16 v[96:111], v[156:159], v[164:167], v[96:111]
    ds_read_b64_tr_b16 v[136:137], v188 offset:160
    ds_read_b64_tr_b16 v[138:139], v188 offset:640
    s_add_u32 m0, s35, 17408
    s_nop 0
    buffer_load_dwordx4 v201, s[8:11], s30 offen lds
    s_add_u32 s5, s5, 1
    s_cmp_eq_u32 s5, 10
    s_cselect_b32 s5, 0, s5
    s_lshl_b32 s30, s5, 7
    v_mfma_f32_32x32x16_bf16 v[112:127], v[160:163], v[164:167], v[112:127]
    ds_read_b64_tr_b16 v[140:141], v191 offset:0
    ds_read_b64_tr_b16 v[142:143], v191 offset:480
    s_waitcnt lgkmcnt(6)
    v_mfma_f32_32x32x16_bf16 v[64:79], v[128:131], v[144:147], v[64:79]
    ds_read_b128 v[164:167], v181 offset:32768
    ds_read_b64_tr_b16 v[148:149], v188 offset:7680
    ds_read_b64_tr_b16 v[150:151], v188 offset:8160
    s_add_u32 m0, s36, 32768
    s_mov_b32 exec_hi, 0x0fffffff
    buffer_load_dwordx4 v202, s[12:15], s31 offen lds
    s_mov_b32 exec_hi, -1
    s_waitcnt lgkmcnt(7)
    v_mfma_f32_32x32x16_bf16 v[80:95], v[132:135], v[144:147], v[80:95]
    ds_read_b64_tr_b16 v[152:153], v188 offset:7760
    ds_read_b64_tr_b16 v[154:155], v188 offset:8240
    s_waitcnt lgkmcnt(7)
    v_mfma_f32_32x32x16_bf16 v[96:111], v[136:139], v[144:147], v[96:111]
    ds_read_b64_tr_b16 v[156:157], v188 offset:7840
    ds_read_b64_tr_b16 v[158:159], v188 offset:8320
    s_add_u32 m0, s36, 33728
    s_mov_b32 exec_hi, 0x0fffffff
    buffer_load_dwordx4 v202, s[12:15], s32 offen lds
    s_mov_b32 exec_hi, -1
    s_waitcnt lgkmcnt(7)
    v_mfma_f32_32x32x16_bf16 v[112:127], v[140:143], v[144:147], v[112:127]
    ds_read_b64_tr_b16 v[160:161], v191 offset:7680
    ds_read_b64_tr_b16 v[162:163], v191 offset:8160
    s_waitcnt lgkmcnt(6)
    v_mfma_f32_32x32x16_bf16 v[64:79], v[148:151], v[164:167], v[64:79]
    ds_read_b128 v[144:147], v182 offset:32768
    ds_read_b64_tr_b16 v[128:129], v188 offset:15360
    ds_read_b64_tr_b16 v[130:131], v188 offset:15840
    s_add_u32 m0, s36, 34688
    s_mov_b32 exec_hi, 0x0fffffff
    buffer_load_dwordx4 v202, s[12:15], s33 offen lds
    s_mov_b32 exec_hi, -1
    s_waitcnt lgkmcnt(7)
    v_mfma_f32_32x32x16_bf16 v[80:95], v[152:155], v[164:167], v[80:95]
    ds_read_b64_tr_b16 v[132:133], v188 offset:15440
    ds_read_b64_tr_b16 v[134:135], v188 offset:15920
    s_waitcnt lgkmcnt(7)
    v_mfma_f32_32x32x16_bf16 v[96:111], v[156:159], v[164:167], v[96:111]
    ds_read_b64_tr_b16 v[136:137], v188 offset:15520
    ds_read_b64_tr_b16 v[138:139], v188 offset:16000
    s_waitcnt lgkmcnt(7)
    v_mfma_f32_32x32x16_bf16 v[112:127], v[160:163], v[164:167], v[112:127]
    ds_read_b64_tr_b16 v[140:141], v191 offset:15360
    ds_read_b64_tr_b16 v[142:143], v191 offset:15840
    s_waitcnt lgkmcnt(6)
    v_mfma_f32_32x32x16_bf16 v[64:79], v[128:131], v[144:147], v[64:79]
    ds_read_b128 v[164:167], v183 offset:32768
    ds_read_b64_tr_b16 v[148:149], v188 offset:23040
    ds_read_b64_tr_b16 v[150:151], v188 offset:23520
    ds_read_b64_tr_b16 v[152:153], v188 offset:23120
    ds_read_b64_tr_b16 v[154:155], v188 offset:23600
    s_add_u32 m0, s36, 35648
    s_mov_b32 exec_hi, 0x0fffffff
    buffer_load_dwordx4 v202, s[12:15], s34 offen lds
    s_mov_b32 exec_hi, -1
    s_mul_i32 s31, s5, 245760
    s_add_u32 s32, s31, 3840
    s_add_u32 s33, s31, 7680
    s_add_u32 s34, s31, 11520
    s_waitcnt lgkmcnt(9)
    v_mfma_f32_32x32x16_bf16 v[80:95], v[132:135], v[144:147], v[80:95]
    ds_read_b64_tr_b16 v[156:157], v188 offset:23200
    ds_read_b64_tr_b16 v[158:159], v188 offset:23680
    s_waitcnt lgkmcnt(9)
    v_mfma_f32_32x32x16_bf16 v[96:111], v[136:139], v[144:147], v[96:111]
    ds_read_b64_tr_b16 v[160:161], v191 offset:23040
    ds_read_b64_tr_b16 v[162:163], v191 offset:23520
    s_waitcnt lgkmcnt(9)
    v_mfma_f32_32x32x16_bf16 v[112:127], v[140:143], v[144:147], v[112:127]
    s_waitcnt lgkmcnt(0)
    s_waitcnt vmcnt(6)
    s_barrier
    v_mfma_f32_32x32x16_bf16 v[64:79], v[148:151], v[164:167], v[64:79]
    ds_read_b128 v[144:147], v180 offset:0
    ds_read_b64_tr_b16 v[128:129], v184 offset:0
    ds_read_b64_tr_b16 v[130:131], v184 offset:480
    s_add_u32 m0, s35, 32768
    s_nop 0
    buffer_load_dwordx4 v200, s[8:11], s30 offen lds
    v_mfma_f32_32x32x16_bf16 v[80:95], v[152:155], v[164:167], v[80:95]
    ds_read_b64_tr_b16 v[132:133], v184 offset:80
    ds_read_b64_tr_b16 v[134:135], v184 offset:560
    v_mfma_f32_32x32x16_bf16 v[96:111], v[156:159], v[164:167], v[96:111]
    ds_read_b64_tr_b16 v[136:137], v184 offset:160
    ds_read_b64_tr_b16 v[138:139], v184 offset:640
    s_add_u32 m0, s35, 33792
    s_nop 0
    buffer_load_dwordx4 v201, s[8:11], s30 offen lds
    s_add_u32 s5, s5, 1
    s_cmp_eq_u32 s5, 10
    s_cselect_b32 s5, 0, s5
    s_lshl_b32 s30, s5, 7
    v_mfma_f32_32x32x16_bf16 v[112:127], v[160:163], v[164:167], v[112:127]
    ds_read_b64_tr_b16 v[140:141], v187 offset:0
    ds_read_b64_tr_b16 v[142:143], v187 offset:480
    s_waitcnt lgkmcnt(6)
    v_mfma_f32_32x32x16_bf16 v[64:79], v[128:131], v[144:147], v[64:79]
    ds_read_b128 v[164:167], v181 offset:0
    ds_read_b64_tr_b16 v[148:149], v184 offset:7680
    ds_read_b64_tr_b16 v[150:151], v184 offset:8160
    s_add_u32 m0, s36, 65536
    s_mov_b32 exec_hi, 0x0fffffff
    buffer_load_dwordx4 v202, s[12:15], s31 offen lds
    s_mov_b32 exec_hi, -1
    s_waitcnt lgkmcnt(7)
    v_mfma_f32_32x32x16_bf16 v[80:95], v[132:135], v[144:147], v[80:95]
    ds_read_b64_tr_b16 v[152:153], v184 offset:7760
    ds_read_b64_tr_b16 v[154:155], v184 offset:8240
    s_waitcnt lgkmcnt(7)
    v_mfma_f32_32x32x16_bf16 v[96:111], v[136:139], v[144:147], v[96:111]
    ds_read_b64_tr_b16 v[156:157], v184 offset:7840
    ds_read_b64_tr_b16 v[158:159], v184 offset:8320
    s_add_u32 m0, s36, 66496
    s_mov_b32 exec_hi, 0x0fffffff
    buffer_load_dwordx4 v202, s[12:15], s32 offen lds
    s_mov_b32 exec_hi, -1
    s_waitcnt lgkmcnt(7)
    v_mfma_f32_32x32x16_bf16 v[112:127], v[140:143], v[144:147], v[112:127]
    ds_read_b64_tr_b16 v[160:161], v187 offset:7680
    ds_read_b64_tr_b16 v[162:163], v187 offset:8160
    s_waitcnt lgkmcnt(6)
    v_mfma_f32_32x32x16_bf16 v[64:79], v[148:151], v[164:167], v[64:79]
    ds_read_b128 v[144:147], v182 offset:0
    ds_read_b64_tr_b16 v[128:129], v184 offset:15360
    ds_read_b64_tr_b16 v[130:131], v184 offset:15840
    s_add_u32 m0, s36, 67456
    s_mov_b32 exec_hi, 0x0fffffff
    buffer_load_dwordx4 v202, s[12:15], s33 offen lds
    s_mov_b32 exec_hi, -1
    s_waitcnt lgkmcnt(7)
    v_mfma_f32_32x32x16_bf16 v[80:95], v[152:155], v[164:167], v[80:95]
    ds_read_b64_tr_b16 v[132:133], v184 offset:15440
    ds_read_b64_tr_b16 v[134:135], v184 offset:15920
    s_waitcnt lgkmcnt(7)
    v_mfma_f32_32x32x16_bf16 v[96:111], v[156:159], v[164:167], v[96:111]
    ds_read_b64_tr_b16 v[136:137], v184 offset:15520
    ds_read_b64_tr_b16 v[138:139], v184 offset:16000
    s_waitcnt lgkmcnt(7)
    v_mfma_f32_32x32x16_bf16 v[112:127], v[160:163], v[164:167], v[112:127]
    ds_read_b64_tr_b16 v[140:141], v187 offset:15360
    ds_read_b64_tr_b16 v[142:143], v187 offset:15840
    s_waitcnt lgkmcnt(6)
    v_mfma_f32_32x32x16_bf16 v[64:79], v[128:131], v[144:147], v[64:79]
    ds_read_b128 v[164:167], v183 offset:0
    ds_read_b64_tr_b16 v[148:149], v184 offset:23040
    ds_read_b64_tr_b16 v[150:151], v184 offset:23520
    ds_read_b64_tr_b16 v[152:153], v184 offset:23120
    ds_read_b64_tr_b16 v[154:155], v184 offset:23600
    s_add_u32 m0, s36, 68416
    s_mov_b32 exec_hi, 0x0fffffff
    buffer_load_dwordx4 v202, s[12:15], s34 offen lds
    s_mov_b32 exec_hi, -1
    s_mul_i32 s31, s5, 245760
    s_add_u32 s32, s31, 3840
    s_add_u32 s33, s31, 7680
    s_add_u32 s34, s31, 11520
    s_waitcnt lgkmcnt(9)
    v_mfma_f32_32x32x16_bf16 v[80:95], v[132:135], v[144:147], v[80:95]
    ds_read_b64_tr_b16 v[156:157], v184 offset:23200
    ds_read_b64_tr_b16 v[158:159], v184 offset:23680
    s_waitcnt lgkmcnt(9)
    v_mfma_f32_32x32x16_bf16 v[96:111], v[136:139], v[144:147], v[96:111]
    ds_read_b64_tr_b16 v[160:161], v187 offset:23040
    ds_read_b64_tr_b16 v[162:163], v187 offset:23520
    s_waitcnt lgkmcnt(9)
    v_mfma_f32_32x32x16_bf16 v[112:127], v[140:143], v[144:147], v[112:127]
    s_waitcnt lgkmcnt(0)
    s_waitcnt vmcnt(6)
    s_barrier
    v_mfma_f32_32x32x16_bf16 v[64:79], v[148:151], v[164:167], v[64:79]
    ds_read_b128 v[144:147], v180 offset:16384
    ds_read_b64_tr_b16 v[128:129], v184 offset:32768
    ds_read_b64_tr_b16 v[130:131], v184 offset:33248
    s_add_u32 m0, s35, 0
    s_nop 0
    buffer_load_dwordx4 v200, s[8:11], s30 offen lds
    v_mfma_f32_32x32x16_bf16 v[80:95], v[152:155], v[164:167], v[80:95]
    ds_read_b64_tr_b16 v[132:133], v184 offset:32848
    ds_read_b64_tr_b16 v[134:135], v184 offset:33328
    v_mfma_f32_32x32x16_bf16 v[96:111], v[156:159], v[164:167], v[96:111]
    ds_read_b64_tr_b16 v[136:137], v184 offset:32928
    ds_read_b64_tr_b16 v[138:139], v184 offset:33408
    s_add_u32 m0, s35, 1024
    s_nop 0
    buffer_load_dwordx4 v201, s[8:11], s30 offen lds
    s_add_u32 s5, s5, 1
    s_cmp_eq_u32 s5, 10
    s_cselect_b32 s5, 0, s5
    s_lshl_b32 s30, s5, 7
    v_mfma_f32_32x32x16_bf16 v[112:127], v[160:163], v[164:167], v[112:127]
    ds_read_b64_tr_b16 v[140:141], v187 offset:32768
    ds_read_b64_tr_b16 v[142:143], v187 offset:33248
    s_waitcnt lgkmcnt(6)
    v_mfma_f32_32x32x16_bf16 v[64:79], v[128:131], v[144:147], v[64:79]
    ds_read_b128 v[164:167], v181 offset:16384
    ds_read_b64_tr_b16 v[148:149], v184 offset:40448
    ds_read_b64_tr_b16 v[150:151], v184 offset:40928
    s_add_u32 m0, s36, 0
    s_mov_b32 exec_hi, 0x0fffffff
    buffer_load_dwordx4 v202, s[12:15], s31 offen lds
    s_mov_b32 exec_hi, -1
    s_waitcnt lgkmcnt(7)
    v_mfma_f32_32x32x16_bf16 v[80:95], v[132:135], v[144:147], v[80:95]
    ds_read_b64_tr_b16 v[152:153], v184 offset:40528
    ds_read_b64_tr_b16 v[154:155], v184 offset:41008
    s_waitcnt lgkmcnt(7)
    v_mfma_f32_32x32x16_bf16 v[96:111], v[136:139], v[144:147], v[96:111]
    ds_read_b64_tr_b16 v[156:157], v184 offset:40608
    ds_read_b64_tr_b16 v[158:159], v184 offset:41088
    s_add_u32 m0, s36, 960
    s_mov_b32 exec_hi, 0x0fffffff
    buffer_load_dwordx4 v202, s[12:15], s32 offen lds
    s_mov_b32 exec_hi, -1
    s_waitcnt lgkmcnt(7)
    v_mfma_f32_32x32x16_bf16 v[112:127], v[140:143], v[144:147], v[112:127]
    ds_read_b64_tr_b16 v[160:161], v187 offset:40448
    ds_read_b64_tr_b16 v[162:163], v187 offset:40928
    s_waitcnt lgkmcnt(6)
    v_mfma_f32_32x32x16_bf16 v[64:79], v[148:151], v[164:167], v[64:79]
    ds_read_b128 v[144:147], v182 offset:16384
    ds_read_b64_tr_b16 v[128:129], v184 offset:48128
    ds_read_b64_tr_b16 v[130:131], v184 offset:48608
    s_add_u32 m0, s36, 1920
    s_mov_b32 exec_hi, 0x0fffffff
    buffer_load_dwordx4 v202, s[12:15], s33 offen lds
    s_mov_b32 exec_hi, -1
    s_waitcnt lgkmcnt(7)
    v_mfma_f32_32x32x16_bf16 v[80:95], v[152:155], v[164:167], v[80:95]
    ds_read_b64_tr_b16 v[132:133], v184 offset:48208
    ds_read_b64_tr_b16 v[134:135], v184 offset:48688
    s_waitcnt lgkmcnt(7)
    v_mfma_f32_32x32x16_bf16 v[96:111], v[156:159], v[164:167], v[96:111]
    ds_read_b64_tr_b16 v[136:137], v184 offset:48288
    ds_read_b64_tr_b16 v[138:139], v184 offset:48768
    s_waitcnt lgkmcnt(7)
    v_mfma_f32_32x32x16_bf16 v[112:127], v[160:163], v[164:167], v[112:127]
    ds_read_b64_tr_b16 v[140:141], v187 offset:48128
    ds_read_b64_tr_b16 v[142:143], v187 offset:48608
    s_waitcnt lgkmcnt(6)
    v_mfma_f32_32x32x16_bf16 v[64:79], v[128:131], v[144:147], v[64:79]
    ds_read_b128 v[164:167], v183 offset:16384
    ds_read_b64_tr_b16 v[148:149], v184 offset:55808
    ds_read_b64_tr_b16 v[150:151], v184 offset:56288
    ds_read_b64_tr_b16 v[152:153], v184 offset:55888
    ds_read_b64_tr_b16 v[154:155], v184 offset:56368
    s_add_u32 m0, s36, 2880
    s_mov_b32 exec_hi, 0x0fffffff
    buffer_load_dwordx4 v202, s[12:15], s34 offen lds
    s_mov_b32 exec_hi, -1
    s_mul_i32 s31, s5, 245760
    s_add_u32 s32, s31, 3840
    s_add_u32 s33, s31, 7680
    s_add_u32 s34, s31, 11520
    s_waitcnt lgkmcnt(9)
    v_mfma_f32_32x32x16_bf16 v[80:95], v[132:135], v[144:147], v[80:95]
    ds_read_b64_tr_b16 v[156:157], v184 offset:55968
    ds_read_b64_tr_b16 v[158:159], v184 offset:56448
    s_waitcnt lgkmcnt(9)
    v_mfma_f32_32x32x16_bf16 v[96:111], v[136:139], v[144:147], v[96:111]
    ds_read_b64_tr_b16 v[160:161], v187 offset:55808
    ds_read_b64_tr_b16 v[162:163], v187 offset:56288
    s_waitcnt lgkmcnt(9)
    v_mfma_f32_32x32x16_bf16 v[112:127], v[140:143], v[144:147], v[112:127]
    s_waitcnt lgkmcnt(0)
    s_waitcnt vmcnt(6)
    s_barrier
    global_load_dword v213, v212, s[62:63] sc1
    v_mfma_f32_32x32x16_bf16 v[64:79], v[148:151], v[164:167], v[64:79]
    ds_read_b128 v[144:147], v180 offset:32768
    ds_read_b64_tr_b16 v[128:129], v188 offset:0
    ds_read_b64_tr_b16 v[130:131], v188 offset:480
    v_mfma_f32_32x32x16_bf16 v[80:95], v[152:155], v[164:167], v[80:95]
    ds_read_b64_tr_b16 v[132:133], v188 offset:80
    ds_read_b64_tr_b16 v[134:135], v188 offset:560
    v_mfma_f32_32x32x16_bf16 v[96:111], v[156:159], v[164:167], v[96:111]
    ds_read_b64_tr_b16 v[136:137], v188 offset:160
    ds_read_b64_tr_b16 v[138:139], v188 offset:640
    v_mfma_f32_32x32x16_bf16 v[112:127], v[160:163], v[164:167], v[112:127]
    ds_read_b64_tr_b16 v[140:141], v191 offset:0
    ds_read_b64_tr_b16 v[142:143], v191 offset:480
    s_waitcnt lgkmcnt(6)
    v_mfma_f32_32x32x16_bf16 v[64:79], v[128:131], v[144:147], v[64:79]
    ds_read_b128 v[164:167], v181 offset:32768
    ds_read_b64_tr_b16 v[148:149], v188 offset:7680
    ds_read_b64_tr_b16 v[150:151], v188 offset:8160
    s_waitcnt lgkmcnt(7)
    v_mfma_f32_32x32x16_bf16 v[80:95], v[132:135], v[144:147], v[80:95]
    ds_read_b64_tr_b16 v[152:153], v188 offset:7760
    ds_read_b64_tr_b16 v[154:155], v188 offset:8240
    s_waitcnt lgkmcnt(7)
    v_mfma_f32_32x32x16_bf16 v[96:111], v[136:139], v[144:147], v[96:111]
    ds_read_b64_tr_b16 v[156:157], v188 offset:7840
    ds_read_b64_tr_b16 v[158:159], v188 offset:8320
    s_waitcnt lgkmcnt(7)
    v_mfma_f32_32x32x16_bf16 v[112:127], v[140:143], v[144:147], v[112:127]
    ds_read_b64_tr_b16 v[160:161], v191 offset:7680
    ds_read_b64_tr_b16 v[162:163], v191 offset:8160
    s_waitcnt lgkmcnt(6)
    v_mfma_f32_32x32x16_bf16 v[64:79], v[148:151], v[164:167], v[64:79]
    ds_read_b128 v[144:147], v182 offset:32768
    ds_read_b64_tr_b16 v[128:129], v188 offset:15360
    ds_read_b64_tr_b16 v[130:131], v188 offset:15840
    s_waitcnt lgkmcnt(7)
    v_mfma_f32_32x32x16_bf16 v[80:95], v[152:155], v[164:167], v[80:95]
    ds_read_b64_tr_b16 v[132:133], v188 offset:15440
    ds_read_b64_tr_b16 v[134:135], v188 offset:15920
    s_waitcnt lgkmcnt(7)
    v_mfma_f32_32x32x16_bf16 v[96:111], v[156:159], v[164:167], v[96:111]
    ds_read_b64_tr_b16 v[136:137], v188 offset:15520
    ds_read_b64_tr_b16 v[138:139], v188 offset:16000
    s_waitcnt lgkmcnt(7)
    v_mfma_f32_32x32x16_bf16 v[112:127], v[160:163], v[164:167], v[112:127]
    ds_read_b64_tr_b16 v[140:141], v191 offset:15360
    ds_read_b64_tr_b16 v[142:143], v191 offset:15840
    s_waitcnt lgkmcnt(6)
    v_mfma_f32_32x32x16_bf16 v[64:79], v[128:131], v[144:147], v[64:79]
    ds_read_b128 v[164:167], v183 offset:32768
    ds_read_b64_tr_b16 v[148:149], v188 offset:23040
    ds_read_b64_tr_b16 v[150:151], v188 offset:23520
    ds_read_b64_tr_b16 v[152:153], v188 offset:23120
    ds_read_b64_tr_b16 v[154:155], v188 offset:23600
    s_waitcnt lgkmcnt(9)
    v_mfma_f32_32x32x16_bf16 v[80:95], v[132:135], v[144:147], v[80:95]
    ds_read_b64_tr_b16 v[156:157], v188 offset:23200
    ds_read_b64_tr_b16 v[158:159], v188 offset:23680
    s_waitcnt lgkmcnt(9)
    v_mfma_f32_32x32x16_bf16 v[96:111], v[136:139], v[144:147], v[96:111]
    ds_read_b64_tr_b16 v[160:161], v191 offset:23040
    ds_read_b64_tr_b16 v[162:163], v191 offset:23520
    s_waitcnt lgkmcnt(9)
    v_mfma_f32_32x32x16_bf16 v[112:127], v[140:143], v[144:147], v[112:127]
    s_waitcnt lgkmcnt(0)
    s_waitcnt vmcnt(0)
    s_cmp_lg_u32 s24, 0
    s_cbranch_scc1 KF_FSKIP_A
KF_P_AF:
    v_cmp_eq_u32 vcc, s4, v213
    s_nop 0
    s_and_b32 s37, vcc_lo, 0xffffff
    s_cmp_eq_u32 s37, 0xffffff
    s_cbranch_scc1 KF_POK_AF
    s_sleep 16
    global_load_dword v213, v212, s[62:63] sc1
    s_waitcnt vmcnt(0)
    s_branch KF_P_AF
KF_POK_AF:
KF_FSKIP_A:
    s_barrier
    s_lshl_b32 s37, s27, 7
    s_lshl_b32 s38, s25, 5
    s_add_u32 s37, s37, s38
    v_add_u32 v7, s37, v6
    v_lshlrev_b32_e64 v7, 3, v7
    global_load_dwordx2 v[14:15], v7, s[62:63] sc1
    s_cmp_lg_u32 s24, 7
    s_cbranch_scc1 KF_NOCSL_A
    v_lshlrev_b32 v7, 4, v1
    s_lshl_b32 s37, s29, 14
    s_add_u32 s37, s37, 23068672
    buffer_load_dwordx4 v[216:219], v7, s[20:23], s37 offen sc1
    s_add_u32 s37, s37, 1024
    buffer_load_dwordx4 v[220:223], v7, s[20:23], s37 offen sc1
    s_add_u32 s37, s37, 1024
    buffer_load_dwordx4 v[224:227], v7, s[20:23], s37 offen sc1
    s_add_u32 s37, s37, 1024
    buffer_load_dwordx4 v[228:231], v7, s[20:23], s37 offen sc1
    s_add_u32 s37, s37, 1024
    buffer_load_dwordx4 v[232:235], v7, s[20:23], s37 offen sc1
    s_add_u32 s37, s37, 1024
    buffer_load_dwordx4 v[236:239], v7, s[20:23], s37 offen sc1
    s_add_u32 s37, s37, 1024
    buffer_load_dwordx4 v[240:243], v7, s[20:23], s37 offen sc1
    s_add_u32 s37, s37, 1024
    buffer_load_dwordx4 v[244:247], v7, s[20:23], s37 offen sc1
    s_add_u32 s37, s37, 1024
    buffer_load_dwordx4 v[248:251], v7, s[20:23], s37 offen sc1
    s_add_u32 s37, s37, 1024
    buffer_load_dwordx4 v[252:255], v7, s[20:23], s37 offen sc1
    s_add_u32 s37, s37, 1024
    buffer_load_dwordx4 v[40:43], v7, s[20:23], s37 offen sc1
    s_add_u32 s37, s37, 1024
    buffer_load_dwordx4 v[44:47], v7, s[20:23], s37 offen sc1
    s_add_u32 s37, s37, 1024
    buffer_load_dwordx4 v[48:51], v7, s[20:23], s37 offen sc1
    s_add_u32 s37, s37, 1024
    buffer_load_dwordx4 v[52:55], v7, s[20:23], s37 offen sc1
    s_add_u32 s37, s37, 1024
    buffer_load_dwordx4 v[56:59], v7, s[20:23], s37 offen sc1
    s_add_u32 s37, s37, 1024
    buffer_load_dwordx4 v[60:63], v7, s[20:23], s37 offen sc1
KF_NOCSL_A:
    v_mfma_f32_32x32x16_bf16 v[64:79], v[148:151], v[164:167], v[64:79]
    ds_read_b128 v[144:147], v180 offset:0
    ds_read_b64_tr_b16 v[128:129], v184 offset:0
    ds_read_b64_tr_b16 v[130:131], v184 offset:480
    v_lshrrev_b32 v7, 2, v6
    v_and_b32 v8, 3, v6
    v_and_b32 v9, 1, v7
    v_lshrrev_b32 v10, 1, v7
    v_lshl_add_u32 v11, v9, 2, v10
    v_add_u32_e64 v11, 1, v11
    v_mfma_f32_32x32x16_bf16 v[80:95], v[152:155], v[164:167], v[80:95]
    ds_read_b64_tr_b16 v[132:133], v184 offset:80
    ds_read_b64_tr_b16 v[134:135], v184 offset:560
    v_mul_u32_u24 v12, 10, v10
    v_mul_u32_u24 v13, 9, v9
    v_add_u32 v12, v12, v13
    v_add_u32 v13, 6, v9
    v_cmp_eq_u32 vcc, 3, v10
    s_nop 1
    v_mfma_f32_32x32x16_bf16 v[96:111], v[156:159], v[164:167], v[96:111]
    ds_read_b64_tr_b16 v[136:137], v184 offset:160
    ds_read_b64_tr_b16 v[138:139], v184 offset:640
    v_cndmask_b32 v12, v12, v13, vcc
    s_mul_i32 s37, s26, 30
    v_add_u32 v11, s37, v11
    v_add_u32 v12, s37, v12
    v_lshl_add_u32 v11, v11, 2, v8
    v_lshl_add_u32 v12, v12, 2, v8
    v_mfma_f32_32x32x16_bf16 v[112:127], v[160:163], v[164:167], v[112:127]
    ds_read_b64_tr_b16 v[140:141], v187 offset:0
    ds_read_b64_tr_b16 v[142:143], v187 offset:480
    v_lshlrev_b32 v11, 2, v11
    v_lshlrev_b32 v12, 2, v12
    v_add_u32 v208, 151552, v11
    v_add_u32 v209, 151552, v12
    s_waitcnt lgkmcnt(6)
    v_mfma_f32_32x32x16_bf16 v[64:79], v[128:131], v[144:147], v[64:79]
    ds_read_b128 v[164:167], v181 offset:0
    ds_read_b64_tr_b16 v[148:149], v184 offset:7680
    ds_read_b64_tr_b16 v[150:151], v184 offset:8160
    s_waitcnt lgkmcnt(7)
    v_mfma_f32_32x32x16_bf16 v[80:95], v[132:135], v[144:147], v[80:95]
    ds_read_b64_tr_b16 v[152:153], v184 offset:7760
    ds_read_b64_tr_b16 v[154:155], v184 offset:8240
    s_waitcnt lgkmcnt(7)
    v_mfma_f32_32x32x16_bf16 v[96:111], v[136:139], v[144:147], v[96:111]
    ds_read_b64_tr_b16 v[156:157], v184 offset:7840
    ds_read_b64_tr_b16 v[158:159], v184 offset:8320
    s_waitcnt lgkmcnt(7)
    v_mfma_f32_32x32x16_bf16 v[112:127], v[140:143], v[144:147], v[112:127]
    ds_read_b64_tr_b16 v[160:161], v187 offset:7680
    ds_read_b64_tr_b16 v[162:163], v187 offset:8160
    s_waitcnt lgkmcnt(6)
    v_mfma_f32_32x32x16_bf16 v[64:79], v[148:151], v[164:167], v[64:79]
    ds_read_b128 v[144:147], v182 offset:0
    ds_read_b64_tr_b16 v[128:129], v184 offset:15360
    ds_read_b64_tr_b16 v[130:131], v184 offset:15840
    v_and_b32 v9, 1, v5
    v_lshrrev_b32_e64 v10, 1, v5
    v_lshl_add_u32 v10, v3, 1, v10
    s_lshl_b32 s37, s26, 1
    v_add_u32 v11, s37, v2
    v_mul_u32_u24 v11, 800, v11
    s_waitcnt lgkmcnt(7)
    v_mfma_f32_32x32x16_bf16 v[80:95], v[152:155], v[164:167], v[80:95]
    ds_read_b64_tr_b16 v[132:133], v184 offset:15440
    ds_read_b64_tr_b16 v[134:135], v184 offset:15920
    v_mul_u32_u24 v12, 40, v4
    v_add_u32_e64 v11, v11, v12
    v_lshl_add_u32 v11, v10, 3, v11
    v_add_u32 v11, 147456, v11
    v_cmp_eq_u32 vcc, 0, v2
    v_mov_b32 v12, 160
    s_waitcnt lgkmcnt(7)
    v_mfma_f32_32x32x16_bf16 v[96:111], v[156:159], v[164:167], v[96:111]
    ds_read_b64_tr_b16 v[136:137], v184 offset:15520
    ds_read_b64_tr_b16 v[138:139], v184 offset:16000
    s_nop 0
    v_cndmask_b32 v13, 0, v12, vcc
    v_add_u32_e64 v214, v11, v13
    v_mov_b32 v12, 640
    v_cndmask_b32 v13, v12, 0, vcc
    v_add_u32 v215, v11, v13
    s_waitcnt lgkmcnt(7)
    v_mfma_f32_32x32x16_bf16 v[112:127], v[160:163], v[164:167], v[112:127]
    ds_read_b64_tr_b16 v[140:141], v187 offset:15360
    ds_read_b64_tr_b16 v[142:143], v187 offset:15840
    v_cmp_eq_u32 vcc, v9, v2
    v_mov_b32 v12, 150656
    s_nop 0
    v_cndmask_b32 v214, v12, v214, vcc
    v_cndmask_b32 v215, v12, v215, vcc
    s_waitcnt lgkmcnt(6)
    v_mfma_f32_32x32x16_bf16 v[64:79], v[128:131], v[144:147], v[64:79]
    ds_read_b128 v[164:167], v183 offset:0
    ds_read_b64_tr_b16 v[148:149], v184 offset:23040
    ds_read_b64_tr_b16 v[150:151], v184 offset:23520
    s_waitcnt lgkmcnt(7)
    v_mfma_f32_32x32x16_bf16 v[80:95], v[132:135], v[144:147], v[80:95]
    ds_read_b64_tr_b16 v[152:153], v184 offset:23120
    ds_read_b64_tr_b16 v[154:155], v184 offset:23600
    s_waitcnt lgkmcnt(7)
    v_mfma_f32_32x32x16_bf16 v[96:111], v[136:139], v[144:147], v[96:111]
    ds_read_b64_tr_b16 v[156:157], v184 offset:23200
    ds_read_b64_tr_b16 v[158:159], v184 offset:23680
    s_waitcnt lgkmcnt(7)
    v_mfma_f32_32x32x16_bf16 v[112:127], v[140:143], v[144:147], v[112:127]
    ds_read_b64_tr_b16 v[160:161], v187 offset:23040
    ds_read_b64_tr_b16 v[162:163], v187 offset:23520
    s_waitcnt lgkmcnt(6)
    v_mfma_f32_32x32x16_bf16 v[64:79], v[148:151], v[164:167], v[64:79]
    ds_read_b64_tr_b16 v[16:17], v214 offset:0
    ds_read_b64_tr_b16 v[18:19], v214 offset:160
    ds_read_b64_tr_b16 v[20:21], v214 offset:320
    ds_read_b64_tr_b16 v[22:23], v214 offset:480
    ds_read_b64_tr_b16 v[24:25], v215 offset:0
    s_waitcnt lgkmcnt(9)
    v_mfma_f32_32x32x16_bf16 v[80:95], v[152:155], v[164:167], v[80:95]
    s_cmp_lg_u32 s24, 7
    s_cbranch_scc1 KF_NOCSA_A
    s_waitcnt vmcnt(0)
    v_add_f32 v216, v216, v220
    v_add_f32 v217, v217, v221
    v_add_f32 v218, v218, v222
    v_add_f32 v219, v219, v223
    v_add_f32 v216, v216, v224
    v_add_f32 v217, v217, v225
    v_add_f32 v218, v218, v226
    v_add_f32 v219, v219, v227
    v_add_f32 v216, v216, v228
    v_add_f32 v217, v217, v229
    v_add_f32 v218, v218, v230
    v_add_f32 v219, v219, v231
    v_add_f32 v216, v216, v232
    v_add_f32 v217, v217, v233
    v_add_f32 v218, v218, v234
    v_add_f32 v219, v219, v235
    v_add_f32 v216, v216, v236
    v_add_f32 v217, v217, v237
    v_add_f32 v218, v218, v238
    v_add_f32 v219, v219, v239
    v_add_f32 v216, v216, v240
    v_add_f32 v217, v217, v241
    v_add_f32 v218, v218, v242
    v_add_f32 v219, v219, v243
    v_add_f32 v216, v216, v244
    v_add_f32 v217, v217, v245
    v_add_f32 v218, v218, v246
    v_add_f32 v219, v219, v247
    v_add_f32 v216, v216, v248
    v_add_f32 v217, v217, v249
    v_add_f32 v218, v218, v250
    v_add_f32 v219, v219, v251
    v_add_f32 v216, v216, v252
    v_add_f32 v217, v217, v253
    v_add_f32 v218, v218, v254
    v_add_f32 v219, v219, v255
    v_add_f32 v216, v216, v40
    v_add_f32 v217, v217, v41
    v_add_f32 v218, v218, v42
    v_add_f32 v219, v219, v43
    v_add_f32 v216, v216, v44
    v_add_f32 v217, v217, v45
    v_add_f32 v218, v218, v46
    v_add_f32 v219, v219, v47
    v_add_f32 v216, v216, v48
    v_add_f32 v217, v217, v49
    v_add_f32 v218, v218, v50
    v_add_f32 v219, v219, v51
    v_add_f32 v216, v216, v52
    v_add_f32 v217, v217, v53
    v_add_f32 v218, v218, v54
    v_add_f32 v219, v219, v55
    v_add_f32 v216, v216, v56
    v_add_f32 v217, v217, v57
    v_add_f32 v218, v218, v58
    v_add_f32 v219, v219, v59
    v_add_f32 v216, v216, v60
    v_add_f32 v217, v217, v61
    v_add_f32 v218, v218, v62
    v_add_f32_e64 v219, v219, v63
KF_NOCSA_A:
    ds_read_b64_tr_b16 v[28:29], v214 offset:32
    ds_read_b64_tr_b16 v[30:31], v214 offset:192
    ds_read_b64_tr_b16 v[32:33], v214 offset:352
    ds_read_b64_tr_b16 v[34:35], v214 offset:512
    ds_read_b64_tr_b16 v[36:37], v215 offset:32
    s_waitcnt lgkmcnt(12)
    v_mfma_f32_32x32x16_bf16 v[96:111], v[156:159], v[164:167], v[96:111]
    s_waitcnt lgkmcnt(10)
    v_mfma_f32_32x32x16_bf16 v[112:127], v[160:163], v[164:167], v[112:127]
    s_waitcnt vmcnt(0)
    s_cmp_lg_u32 s24, 7
    s_cbranch_scc1 KF_NOCSS_A
    v_lshlrev_b32 v7, 4, v1
    v_add_u32 v7, 151552, v7
    ds_write_b128 v7, v[216:219]
    s_waitcnt lgkmcnt(0)
KF_NOCSS_A:
    s_barrier
    ds_read_b32 v204, v208 offset:0
    ds_read_b32 v205, v208 offset:160
    ds_read_b32 v206, v208 offset:320
    ds_read_b32 v207, v209
    s_waitcnt lgkmcnt(0)
    v_sub_f32 v7, 0, v14
    v_cvt_pk_bf16_f32 v8, v7, v7
    v_lshlrev_b32 v9, 16, v8
    v_sub_f32 v9, v7, v9
    v_cvt_pk_bf16_f32 v232, v7, v9
    v_and_b32 v233, 0xffff, v8
    v_mov_b32 v234, 0
    v_mov_b32 v235, 0
    v_cmp_gt_u32 vcc, 32, v1
    v_mov_b32 v210, 0
    s_nop 0
    v_cndmask_b32 v204, 0, v204, vcc
    v_cvt_pk_bf16_f32 v216, v204, v204
    v_lshlrev_b32 v211, 16, v216
    v_sub_f32 v211, v204, v211
    v_cvt_pk_bf16_f32 v217, v211, v210
    v_mov_b32 v218, 0
    v_mov_b32 v219, 0
    v_cndmask_b32 v205, 0, v205, vcc
    s_nop 0
    v_cvt_pk_bf16_f32 v220, v205, v205
    v_lshlrev_b32 v211, 16, v220
    v_sub_f32 v211, v205, v211
    v_cvt_pk_bf16_f32 v221, v211, v210
    v_mov_b32 v222, 0
    v_mov_b32 v223, 0
    v_cndmask_b32 v206, 0, v206, vcc
    s_nop 0
    v_cvt_pk_bf16_f32 v224, v206, v206
    v_lshlrev_b32 v211, 16, v224
    v_sub_f32 v211, v206, v211
    v_cvt_pk_bf16_f32 v225, v211, v210
    v_mov_b32 v226, 0
    v_mov_b32 v227, 0
    v_cndmask_b32 v207, 0, v207, vcc
    s_nop 0
    v_cvt_pk_bf16_f32 v228, v207, v207
    v_lshlrev_b32 v211, 16, v228
    v_sub_f32 v211, v207, v211
    v_cvt_pk_bf16_f32 v229, v211, v210
    v_mov_b32 v230, 0
    v_mov_b32 v231, 0
    v_mfma_f32_32x32x16_bf16 v[64:79], v[216:219], v[232:235], v[64:79]
    s_nop 0
    s_nop 0
    v_mfma_f32_32x32x16_bf16 v[112:127], v[228:231], v[232:235], v[112:127]
    v_mfma_f32_32x32x16_bf16 v[80:95], v[220:223], v[232:235], v[80:95]
    v_mfma_f32_32x32x16_bf16 v[96:111], v[224:227], v[232:235], v[96:111]
    v_mov_b32 v26, 0
    v_mov_b32 v27, 0
    v_mov_b32 v38, 0
    v_mov_b32 v39, 0
    v_mov_b32 v162, 0
    v_mov_b32 v163, 0
    v_mov_b32 v174, 0
    v_mov_b32 v175, 0
    v_mul_f32 v12, 0x3fb8aa3b, v15
    s_lshl_b32 s37, s26, 1
    v_add_u32 v9, s37, v2
    v_lshlrev_b32 v9, 14, v9
    s_lshl_b32 s37, s25, 12
    s_add_u32 s37, s37, 81920
    v_add_u32_e64 v9, s37, v9
    v_lshl_add_u32 v9, v6, 7, v9
    v_bfe_u32 v10, v6, 1, 1
    v_lshlrev_b32_e64 v10, 2, v10
    v_bfe_u32 v11, v6, 2, 1
    v_lshl_or_b32 v10, v11, 1, v10
    v_and_b32 v11, 1, v6
    v_or_b32 v10, v10, v11
    v_lshl_add_u32 v13, v10, 4, v9
    v_cvt_pk_bf16_f32 v164, v64, v65
    v_cvt_pk_bf16_f32 v165, v66, v67
    v_cvt_pk_bf16_f32 v166, v68, v69
    v_cvt_pk_bf16_f32 v167, v70, v71
    v_cvt_pk_bf16_f32 v168, v72, v73
    v_cvt_pk_bf16_f32 v169, v74, v75
    v_cvt_pk_bf16_f32 v170, v76, v77
    v_cvt_pk_bf16_f32 v171, v78, v79
    v_cvt_pk_bf16_f32 v172, v112, v113
    v_cvt_pk_bf16_f32 v173, v114, v115
    v_mfma_f32_32x32x16_bf16 v[224:239], v[16:19], v[164:167], 0
    v_cvt_pk_bf16_f32 v152, v80, v81
    v_cvt_pk_bf16_f32 v153, v82, v83
    v_cvt_pk_bf16_f32 v154, v84, v85
    v_cvt_pk_bf16_f32 v155, v86, v87
    v_cvt_pk_bf16_f32 v156, v88, v89
    v_mfma_f32_32x32x16_bf16 v[224:239], v[20:23], v[168:171], v[224:239]
    v_cvt_pk_bf16_f32 v157, v90, v91
    v_cvt_pk_bf16_f32 v158, v92, v93
    v_cvt_pk_bf16_f32 v159, v94, v95
    v_cvt_pk_bf16_f32 v160, v116, v117
    v_cvt_pk_bf16_f32 v161, v118, v119
    v_mfma_f32_32x32x16_bf16 v[224:239], v[24:27], v[172:175], v[224:239]
    v_mul_f32 v96, v96, v15
    v_mul_f32 v97, v97, v15
    v_mul_f32 v98, v98, v15
    v_mul_f32 v99, v99, v15
    v_mul_f32_e64 v100, v100, v15
    v_mfma_f32_32x32x16_bf16 v[240:255], v[28:31], v[164:167], 0
    v_mul_f32 v101, v101, v15
    v_mul_f32 v102, v102, v15
    v_mul_f32 v103, v103, v15
    v_mul_f32 v104, v104, v15
    v_mul_f32_e64 v105, v105, v15
    v_mfma_f32_32x32x16_bf16 v[240:255], v[32:35], v[168:171], v[240:255]
    v_mul_f32 v106, v106, v15
    v_mul_f32 v107, v107, v15
    v_mul_f32 v108, v108, v15
    v_mul_f32 v109, v109, v15
    v_mul_f32_e64 v110, v110, v15
    v_mfma_f32_32x32x16_bf16 v[240:255], v[36:39], v[172:175], v[240:255]
    v_mul_f32 v111, v111, v15
    v_mul_f32 v120, v120, v15
    v_mul_f32 v121, v121, v15
    v_mul_f32 v122, v122, v15
    v_mul_f32_e64 v123, v123, v15
    v_mfma_f32_32x32x16_bf16 v[192:207], v[16:19], v[152:155], 0
    v_cvt_pk_bf16_f32 v176, v96, v97
    v_cvt_pk_bf16_f32 v177, v98, v99
    v_mfma_f32_32x32x16_bf16 v[192:207], v[20:23], v[156:159], v[192:207]
    v_cvt_pk_bf16_f32 v178, v100, v101
    v_cvt_pk_bf16_f32 v179, v102, v103
    v_mfma_f32_32x32x16_bf16 v[192:207], v[24:27], v[160:163], v[192:207]
    v_cvt_pk_bf16_f32 v180, v104, v105
    v_cvt_pk_bf16_f32 v181, v106, v107
    v_mfma_f32_32x32x16_bf16 v[208:223], v[28:31], v[152:155], 0
    v_cvt_pk_bf16_f32 v182, v108, v109
    v_cvt_pk_bf16_f32 v183, v110, v111
    v_mfma_f32_32x32x16_bf16 v[208:223], v[32:35], v[156:159], v[208:223]
    v_cvt_pk_bf16_f32 v184, v120, v121
    v_cvt_pk_bf16_f32 v185, v122, v123
    v_mfma_f32_32x32x16_bf16 v[208:223], v[36:39], v[160:163], v[208:223]
    v_mov_b32 v186, 0x3f80
    v_mov_b32_e64 v187, 0
    v_xor_b32 v10, 80, v13
    ds_write_b128 v10, v[176:179]
    v_xor_b32 v10, 96, v13
    ds_write_b128 v10, v[180:183]
    v_xor_b32 v10, 112, v13
    ds_write_b128 v10, v[184:187]
    v_mul_f32 v224, v224, v12
    v_mul_f32 v225, v225, v12
    v_mul_f32 v226, v226, v12
    v_mul_f32 v227, v227, v12
    v_mul_f32 v228, v228, v12
    v_mul_f32 v229, v229, v12
    v_mul_f32 v230, v230, v12
    v_mul_f32 v231, v231, v12
    v_mul_f32 v232, v232, v12
    v_mul_f32 v233, v233, v12
    v_mul_f32 v234, v234, v12
    v_mul_f32 v235, v235, v12
    v_mul_f32 v236, v236, v12
    v_mul_f32 v237, v237, v12
    v_mul_f32 v238, v238, v12
    v_mul_f32 v239, v239, v12
    v_mul_f32 v240, v240, v12
    v_mul_f32 v241, v241, v12
    v_mul_f32 v242, v242, v12
    v_mul_f32 v243, v243, v12
    s_lshl_b32 s37, s28, 2
    s_lshl_b32 s38, s26, 1
    s_add_u32 s37, s37, s38
    v_add_u32 v9, s37, v2
    s_mov_b32 s39, 163840
    v_mul_lo_u32 v9, v9, s39
    v_lshl_add_u32 v9, v6, 4, v9
    s_lshl_b32 s37, s27, 2
    s_add_u32 s37, s37, s25
    s_mul_i32 s37, s37, 2560
    s_add_u32 s37, s37, 14680064
    buffer_store_dwordx4 v[224:227], v9, s[20:23], s37 offen offset:0 sc1
    buffer_store_dwordx4 v[228:231], v9, s[20:23], s37 offen offset:512 sc1
    buffer_store_dwordx4 v[232:235], v9, s[20:23], s37 offen offset:1024 sc1
    buffer_store_dwordx4 v[236:239], v9, s[20:23], s37 offen offset:1536 sc1
    buffer_store_dwordx4 v[240:243], v9, s[20:23], s37 offen offset:2048 sc1
    s_lshr_b32 s37, s42, 1
    s_lshl_b32 s37, s37, 7
    s_add_u32 s37, s37, 23333888
    s_mov_b32 s38, 23337984
    v_mov_b32 v40, s37
    v_subrev_u32 v7, 0, v1
    v_cmp_gt_u32 vcc, 7, v7
    v_lshlrev_b32 v7, 2, v7
    v_add_u32 v7, s37, v7
    v_cndmask_b32 v40, v40, v7, vcc
    v_subrev_u32 v7, 8, v1
    v_cmp_gt_u32 vcc, 16, v7
    v_lshlrev_b32 v7, 2, v7
    v_add_u32 v7, s38, v7
    v_cndmask_b32 v40, v40, v7, vcc
    s_nop 0
    global_load_dword v41, v40, s[62:63] sc1
    v_max3_f32 v84, v192, v193, v194
    v_min3_f32 v85, v192, v193, v194
    v_max3_f32 v86, v202, v203, v204
    v_min3_f32 v87, v202, v203, v204
    v_max3_f32 v84, v84, v195, v196
    v_min3_f32 v85, v85, v195, v196
    v_max3_f32 v86, v86, v205, v206
    v_min3_f32 v87, v87, v205, v206
    v_max3_f32 v84, v84, v197, v198
    v_min3_f32 v85, v85, v197, v198
    v_max3_f32 v86, v86, v207, v208
    v_min3_f32 v87, v87, v207, v208
    v_max3_f32 v84, v84, v199, v200
    v_min3_f32 v85, v85, v199, v200
    v_max3_f32 v86, v86, v209, v210
    v_min3_f32 v87, v87, v209, v210
    v_max3_f32 v84, v84, v201, v211
    v_min3_f32 v85, v85, v201, v211
    v_max_f32 v84, v84, v86
    v_min_f32 v85, v85, v87
    v_mul_f32 v88, v84, v12
    v_mul_f32 v89, v85, v12
    v_fma_f32 v64, -v192, v12, v89
    v_fma_f32 v192, v192, v12, -v88
    v_fma_f32 v65, -v193, v12, v89
    v_fma_f32 v193, v193, v12, -v88
    v_fma_f32 v66, -v194, v12, v89
    v_fma_f32 v194, v194, v12, -v88
    v_fma_f32 v67, -v195, v12, v89
    v_fma_f32 v195, v195, v12, -v88
    v_fma_f32 v68, -v196, v12, v89
    v_fma_f32 v196, v196, v12, -v88
    v_fma_f32 v69, -v197, v12, v89
    v_fma_f32 v197, v197, v12, -v88
    v_fma_f32 v70, -v198, v12, v89
    v_fma_f32 v198, v198, v12, -v88
    v_fma_f32 v71, -v199, v12, v89
    v_fma_f32 v199, v199, v12, -v88
    v_fma_f32 v72, -v200, v12, v89
    v_fma_f32 v200, v200, v12, -v88
    v_fma_f32 v73, -v201, v12, v89
    v_fma_f32 v201, v201, v12, -v88
    v_fma_f32 v74, -v202, v12, v89
    v_fma_f32 v202, v202, v12, -v88
    v_fma_f32 v75, -v203, v12, v89
    v_fma_f32 v203, v203, v12, -v88
    v_fma_f32 v76, -v204, v12, v89
    v_fma_f32 v204, v204, v12, -v88
    v_fma_f32 v77, -v205, v12, v89
    v_fma_f32 v205, v205, v12, -v88
    v_fma_f32 v78, -v206, v12, v89
    v_fma_f32 v206, v206, v12, -v88
    v_fma_f32 v79, -v207, v12, v89
    v_fma_f32 v207, v207, v12, -v88
    v_fma_f32 v80, -v208, v12, v89
    v_fma_f32 v208, v208, v12, -v88
    v_fma_f32 v81, -v209, v12, v89
    v_fma_f32 v209, v209, v12, -v88
    v_fma_f32 v82, -v210, v12, v89
    v_fma_f32 v210, v210, v12, -v88
    v_fma_f32 v83, -v211, v12, v89
    v_fma_f32 v211, v211, v12, -v88
    v_exp_f32 v64, v64
    v_exp_f32 v192, v192
    v_exp_f32 v65, v65
    v_exp_f32 v193, v193
    v_exp_f32 v66, v66
    v_exp_f32 v194, v194
    v_mov_b32 v91, v64
    v_mov_b32 v90, v192
    v_exp_f32 v67, v67
    v_exp_f32 v195, v195
    v_mov_b32 v93, v65
    v_mov_b32 v92, v193
    v_exp_f32 v68, v68
    v_exp_f32 v196, v196
    v_add_f32 v91, v91, v66
    v_add_f32 v90, v90, v194
    v_exp_f32 v69, v69
    v_exp_f32 v197, v197
    v_add_f32 v93, v93, v67
    v_add_f32 v92, v92, v195
    v_exp_f32 v70, v70
    v_exp_f32 v198, v198
    v_add_f32 v91, v91, v68
    v_add_f32 v90, v90, v196
    v_exp_f32 v71, v71
    v_exp_f32 v199, v199
    v_add_f32 v93, v93, v69
    v_add_f32 v92, v92, v197
    v_exp_f32 v72, v72
    v_exp_f32 v200, v200
    v_add_f32 v91, v91, v70
    v_add_f32 v90, v90, v198
    v_exp_f32 v73, v73
    v_exp_f32 v201, v201
    v_add_f32 v93, v93, v71
    v_add_f32 v92, v92, v199
    v_exp_f32 v74, v74
    v_exp_f32 v202, v202
    v_add_f32 v91, v91, v72
    v_add_f32 v90, v90, v200
    v_exp_f32 v75, v75
    v_exp_f32 v203, v203
    v_add_f32 v93, v93, v73
    v_add_f32 v92, v92, v201
    v_exp_f32 v76, v76
    v_exp_f32 v204, v204
    v_add_f32 v91, v91, v74
    v_add_f32 v90, v90, v202
    v_exp_f32 v77, v77
    v_exp_f32 v205, v205
    v_add_f32 v93, v93, v75
    v_add_f32 v92, v92, v203
    v_exp_f32 v78, v78
    v_exp_f32 v206, v206
    v_add_f32 v91, v91, v76
    v_add_f32 v90, v90, v204
    v_exp_f32 v79, v79
    v_exp_f32 v207, v207
    v_add_f32 v93, v93, v77
    v_add_f32 v92, v92, v205
    v_exp_f32 v80, v80
    v_exp_f32 v208, v208
    v_add_f32 v91, v91, v78
    v_add_f32 v90, v90, v206
    v_exp_f32 v81, v81
    v_exp_f32 v209, v209
    v_add_f32 v93, v93, v79
    v_add_f32 v92, v92, v207
    v_exp_f32 v82, v82
    v_exp_f32 v210, v210
    v_add_f32 v91, v91, v80
    v_add_f32 v90, v90, v208
    v_exp_f32 v83, v83
    v_exp_f32 v211, v211
    v_add_f32 v93, v93, v81
    v_add_f32 v92, v92, v209
    v_add_f32 v91, v91, v82
    v_add_f32 v90, v90, v210
    v_add_f32 v93, v93, v83
    v_add_f32 v92, v92, v211
    v_add_f32 v90, v90, v92
    v_add_f32 v91, v91, v93
    v_rcp_f32 v90, v90
    v_rcp_f32 v91, v91
    v_mul_f32 v192, v192, v90
    v_mul_f32 v193, v193, v90
    v_mul_f32 v64, v64, v91
    v_mul_f32 v65, v65, v91
    v_mul_f32 v194, v194, v90
    v_mul_f32 v195, v195, v90
    v_mul_f32 v66, v66, v91
    v_mul_f32 v67, v67, v91
    v_cvt_pk_bf16_f32 v128, v192, v193
    v_cvt_pk_bf16_f32 v138, v64, v65
    v_mul_f32 v196, v196, v90
    v_mul_f32 v197, v197, v90
    v_mul_f32 v68, v68, v91
    v_mul_f32 v69, v69, v91
    v_cvt_pk_bf16_f32 v129, v194, v195
    v_cvt_pk_bf16_f32 v139, v66, v67
    v_mul_f32 v198, v198, v90
    v_mul_f32 v199, v199, v90
    v_mul_f32 v70, v70, v91
    v_mul_f32 v71, v71, v91
    v_cvt_pk_bf16_f32 v130, v196, v197
    v_cvt_pk_bf16_f32 v140, v68, v69
    v_mul_f32 v200, v200, v90
    v_mul_f32 v201, v201, v90
    v_mul_f32 v72, v72, v91
    v_mul_f32 v73, v73, v91
    v_cvt_pk_bf16_f32 v131, v198, v199
    v_cvt_pk_bf16_f32 v141, v70, v71
    v_mul_f32 v202, v202, v90
    v_mul_f32 v203, v203, v90
    v_mul_f32 v74, v74, v91
    v_mul_f32 v75, v75, v91
    v_cvt_pk_bf16_f32 v132, v200, v201
    v_cvt_pk_bf16_f32 v142, v72, v73
    v_mul_f32 v204, v204, v90
    v_mul_f32 v205, v205, v90
    v_mul_f32 v76, v76, v91
    v_mul_f32 v77, v77, v91
    v_cvt_pk_bf16_f32 v133, v202, v203
    v_cvt_pk_bf16_f32 v143, v74, v75
    v_mul_f32 v206, v206, v90
    v_mul_f32 v207, v207, v90
    v_mul_f32 v78, v78, v91
    v_mul_f32 v79, v79, v91
    v_cvt_pk_bf16_f32 v134, v204, v205
    v_cvt_pk_bf16_f32 v144, v76, v77
    v_mul_f32 v208, v208, v90
    v_mul_f32 v209, v209, v90
    v_mul_f32 v80, v80, v91
    v_mul_f32 v81, v81, v91
    v_cvt_pk_bf16_f32 v135, v206, v207
    v_cvt_pk_bf16_f32 v145, v78, v79
    v_mul_f32 v210, v210, v90
    v_mul_f32 v211, v211, v90
    v_mul_f32 v82, v82, v91
    v_mul_f32 v83, v83, v91
    v_cvt_pk_bf16_f32 v136, v208, v209
    v_cvt_pk_bf16_f32 v146, v80, v81
    v_cvt_pk_bf16_f32 v137, v210, v211
    v_cvt_pk_bf16_f32 v147, v82, v83
    v_xor_b32_e64 v10, 0, v13
    ds_write_b128 v10, v[128:131]
    v_xor_b32_e64 v10, 16, v13
    ds_write_b128 v10, v[132:135]
    v_xor_b32_e64 v10, 32, v13
    ds_write_b128 v10, v[136:139]
    v_xor_b32_e64 v10, 48, v13
    ds_write_b128 v10, v[140:143]
    v_xor_b32_e64 v10, 64, v13
    ds_write_b128 v10, v[144:147]
    s_waitcnt vmcnt(0) lgkmcnt(0)
    s_barrier
    s_cmp_lt_u32 s24, 4
    s_cbranch_scc0 KF_ATT_X
    s_cmp_lg_u32 s25, 0
    s_cbranch_scc1 KF_GN_GA
KF_P_GA:
    v_cmp_eq_u32 vcc, s4, v41
    s_nop 0
    s_and_b32 s37, vcc_lo, 0xffff03
    s_cmp_eq_u32 s37, 0xffff03
    s_cbranch_scc1 KF_POK_GA
    s_sleep 1
    global_load_dword v41, v40, s[62:63] sc1
    s_waitcnt vmcnt(0)
    s_branch KF_P_GA
KF_POK_GA:
    v_mov_b32 v10, 159744
    v_mov_b32_e64 v11, 1
    ds_write_b32 v10, v11 offset:20
    s_branch KF_GD_GA
KF_GN_GA:
    v_cmp_eq_u32 vcc, s4, v41
    s_nop 0
    s_nop 0
    s_and_b32 s37, vcc_lo, 0xffff03
    s_cmp_eq_u32 s37, 0xffff03
    s_cbranch_scc1 KF_GD_GA
    s_nop 0
    v_mov_b32 v10, 159744
KF_GL_GA_W:
    ds_read_b32 v11, v10 offset:20
    s_waitcnt lgkmcnt(0)
    v_readfirstlane_b32 s37, v11
    s_nop 0
    s_cmp_eq_u32 s37, 1
    s_cbranch_scc1 KF_GL_GA_D
    s_sleep 3
    s_branch KF_GL_GA_W
KF_GL_GA_D:
KF_GD_GA:
    s_branch KF_Y
KF_ATT_X:
    s_setprio 3
    s_nop 0
    v_lshl_add_u32 v9, v2, 3, v4
    v_lshlrev_b32 v9, 7, v9
    s_lshl_b32 s39, s25, 14
    s_add_u32 s39, s39, 81920
    v_add_u32 v9, s39, v9
    v_and_b32 v10, 1, v5
    v_lshl_add_u32 v9, v10, 3, v9
    v_lshrrev_b32_e64 v10, 1, v5
    v_lshl_add_u32 v10, v3, 1, v10
    v_add_u32_e64 v10, 4, v10
    v_bfe_u32 v11, v4, 1, 1
    v_lshlrev_b32 v11, 2, v11
    v_and_b32 v13, 1, v4
    v_or_b32 v11, v11, v13
    v_xor_b32 v10, v10, v11
    v_lshl_add_u32 v160, v10, 4, v9
    v_xor_b32 v161, 32, v160
    v_xor_b32 v162, 64, v160
    v_xor_b32_e64 v163, 64, v161
    ds_read_b64_tr_b16 v[64:65], v160 offset:0
    ds_read_b64_tr_b16 v[66:67], v161 offset:512
    ds_read_b64_tr_b16 v[96:97], v162 offset:0
    ds_read_b64_tr_b16 v[98:99], v163 offset:512
    ds_read_b64_tr_b16 v[68:69], v160 offset:2048
    ds_read_b64_tr_b16 v[70:71], v161 offset:2560
    ds_read_b64_tr_b16 v[100:101], v162 offset:2048
    ds_read_b64_tr_b16 v[102:103], v163 offset:2560
    ds_read_b64_tr_b16 v[72:73], v160 offset:4096
    ds_read_b64_tr_b16 v[74:75], v161 offset:4608
    ds_read_b64_tr_b16 v[104:105], v162 offset:4096
    ds_read_b64_tr_b16 v[106:107], v163 offset:4608
    s_waitcnt lgkmcnt(8)
    s_nop 0
    v_mfma_f32_32x32x16_bf16 v[128:143], v[64:67], v[96:99], 0
    v_mfma_f32_32x32x16_bf16 v[144:159], v[64:67], v[64:67], 0
    ds_read_b64_tr_b16 v[76:77], v160 offset:6144
    ds_read_b64_tr_b16 v[78:79], v161 offset:6656
    ds_read_b64_tr_b16 v[108:109], v162 offset:6144
    ds_read_b64_tr_b16 v[110:111], v163 offset:6656
    s_waitcnt lgkmcnt(8)
    s_nop 0
    v_mfma_f32_32x32x16_bf16 v[128:143], v[68:71], v[100:103], v[128:143]
    v_mfma_f32_32x32x16_bf16 v[144:159], v[68:71], v[68:71], v[144:159]
    ds_read_b64_tr_b16 v[80:81], v160 offset:8192
    ds_read_b64_tr_b16 v[82:83], v161 offset:8704
    ds_read_b64_tr_b16 v[112:113], v162 offset:8192
    ds_read_b64_tr_b16 v[114:115], v163 offset:8704
    s_waitcnt lgkmcnt(8)
    s_nop 0
    v_mfma_f32_32x32x16_bf16 v[128:143], v[72:75], v[104:107], v[128:143]
    v_mfma_f32_32x32x16_bf16 v[144:159], v[72:75], v[72:75], v[144:159]
    ds_read_b64_tr_b16 v[84:85], v160 offset:10240
    ds_read_b64_tr_b16 v[86:87], v161 offset:10752
    ds_read_b64_tr_b16 v[116:117], v162 offset:10240
    ds_read_b64_tr_b16 v[118:119], v163 offset:10752
    s_waitcnt lgkmcnt(8)
    s_nop 0
    v_mfma_f32_32x32x16_bf16 v[128:143], v[76:79], v[108:111], v[128:143]
    v_mfma_f32_32x32x16_bf16 v[144:159], v[76:79], v[76:79], v[144:159]
    ds_read_b64_tr_b16 v[88:89], v160 offset:12288
    ds_read_b64_tr_b16 v[90:91], v161 offset:12800
    ds_read_b64_tr_b16 v[120:121], v162 offset:12288
    ds_read_b64_tr_b16 v[122:123], v163 offset:12800
    s_waitcnt lgkmcnt(8)
    s_nop 0
    v_mfma_f32_32x32x16_bf16 v[128:143], v[80:83], v[112:115], v[128:143]
    v_mfma_f32_32x32x16_bf16 v[144:159], v[80:83], v[80:83], v[144:159]
    ds_read_b64_tr_b16 v[92:93], v160 offset:14336
    ds_read_b64_tr_b16 v[94:95], v161 offset:14848
    ds_read_b64_tr_b16 v[124:125], v162 offset:14336
    ds_read_b64_tr_b16 v[126:127], v163 offset:14848
    s_waitcnt lgkmcnt(8)
    s_nop 0
    v_mfma_f32_32x32x16_bf16 v[128:143], v[84:87], v[116:119], v[128:143]
    v_mfma_f32_32x32x16_bf16 v[144:159], v[84:87], v[84:87], v[144:159]
    s_waitcnt lgkmcnt(4)
    s_nop 0
    v_mfma_f32_32x32x16_bf16 v[128:143], v[88:91], v[120:123], v[128:143]
    v_mfma_f32_32x32x16_bf16 v[144:159], v[88:91], v[88:91], v[144:159]
    s_waitcnt lgkmcnt(0)
    s_nop 0
    v_mfma_f32_32x32x16_bf16 v[128:143], v[92:95], v[124:127], v[128:143]
    v_mfma_f32_32x32x16_bf16 v[144:159], v[92:95], v[92:95], v[144:159]
    s_lshl_b32 s39, s28, 2
    s_add_u32 s39, s39, s25
    s_mul_i32 s39, s39, 3840
    s_mul_i32 s40, s27, 122880
    s_add_u32 s39, s39, s40
    s_nop 0
    s_add_u32 s39, s39, 20971520
    v_lshlrev_b32_e64 v9, 4, v1
    v_lshl_add_u32 v11, v2, 3, v6
    v_lshlrev_b32_e64 v11, 4, v11
    v_add_u32 v11, 3072, v11
    v_mov_b32 v10, 0x40000000
    v_cmp_gt_u32 vcc, 8, v6
    s_nop 1
    v_cndmask_b32 v11, v10, v11, vcc
    buffer_store_dwordx4 v[132:135], v9, s[20:23], s39 offen offset:0 sc1
    buffer_store_dwordx4 v[136:139], v9, s[20:23], s39 offen offset:1024 sc1
    buffer_store_dwordx4 v[140:143], v9, s[20:23], s39 offen offset:2048 sc1
    buffer_store_dwordx4 v[148:151], v11, s[20:23], s39 offen offset:0 sc1
    buffer_store_dwordx4 v[152:155], v11, s[20:23], s39 offen offset:256 sc1
    buffer_store_dwordx4 v[156:159], v11, s[20:23], s39 offen offset:512 sc1
    s_waitcnt vmcnt(0)
    s_nop 0
    v_mov_b32 v8, 159744
    v_mov_b32 v9, 1
    s_mov_b64 exec, 1
    ds_add_rtn_u32 v9, v8, v9 offset:16
    s_waitcnt lgkmcnt(0)
    s_mov_b64 exec, -1
    v_readfirstlane_b32 s37, v9
    s_nop 0
    s_cmp_eq_u32 s37, 3
    s_cbranch_scc0 KF_ARR_AX
    s_lshl_b32 s37, s28, 7
    s_lshl_b32 s38, s27, 2
    s_add_u32 s37, s37, s38
    s_nop 0
    s_add_u32 s37, s37, 23335936
    v_mov_b32 v8, s37
    v_mov_b32 v9, s4
    s_mov_b64 exec, 1
    s_nop 0
    global_store_dword v8, v9, s[62:63] sc1
    s_mov_b64 exec, -1
KF_ARR_AX:
    s_branch KF_X
KF_FFN:
    v_lshrrev_b32 v7, 3, v1
    s_lshl_b32 s37, s24, 4
    v_add_u32_e64 v7, s37, v7
    v_mul_u32_u24 v7, 1280, v7
    v_lshrrev_b32 v8, 4, v1
    v_xor_b32 v8, v8, v1
    v_and_b32_e64 v8, 7, v8
    v_lshl_add_u32 v200, v8, 4, v7
    v_xor_b32_e64 v8, 4, v8
    v_lshl_add_u32 v201, v8, 4, v7
    v_add_u32 v201, 10240, v201
    s_lshl_b32 s35, s24, 11
    s_lshr_b32 s5, s27, 2
    s_mul_i32 s5, s5, 5
    s_lshr_b32 s5, s5, 1
    s_lshl_b32 s30, s5, 7
    v_lshrrev_b32 v7, 5, v1
    v_and_b32 v8, 31, v1
    v_lshlrev_b32 v9, 2, v7
    v_xor_b32_e64 v8, v8, v9
    v_mul_u32_u24 v7, 3456, v7
    s_mul_i32 s37, s24, 27648
    s_lshl_b32 s38, s28, 9
    s_add_u32 s37, s37, s38
    v_add_u32_e64 v7, s37, v7
    v_lshl_add_u32 v202, v8, 4, v7
    v_xor_b32_e64 v8, 8, v8
    v_lshl_add_u32 v203, v8, 4, v7
    s_mul_i32 s31, s5, 221184
    s_add_u32 s32, s31, 6912
    s_add_u32 s33, s31, 13824
    s_add_u32 s34, s31, 20736
    s_lshl_b32 s36, s24, 12
    s_nop 0
    s_add_u32 s36, s36, 49152
    s_sub_u32 s41, s29, 8
    v_and_b32 v7, 7, v1
    s_lshl_b32 s37, s24, 3
    v_add_u32 v7, s37, v7
    v_lshrrev_b32_e64 v8, 3, v1
    v_mul_u32_u24 v53, 3456, v8
    v_lshl_add_u32 v53, v7, 3, v53
    s_lshl_b32 s37, s41, 9
    v_add_u32 v53, s37, v53
    v_cmp_le_u32 vcc, 30, v7
    s_nop 1
    v_cndmask_b32 v9, 0, 1, vcc
    v_mul_u32_u24 v10, 30, v9
    v_sub_u32 v10, v7, v10
    v_mul_u32_u24 v11, 26, v10
    v_lshrrev_b32 v11, 8, v11
    v_mul_u32_u24 v52, 10, v11
    v_sub_u32 v10, v10, v52
    v_mul_u32_u24 v52, 1280, v11
    v_lshl_add_u32 v52, v10, 3, v52
    v_mul_u32_u24 v9, 80, v9
    v_add_u32_e64 v52, v52, v9
    v_mul_u32_u24 v9, 3840, v8
    v_add_u32_e64 v52, v52, v9
    s_mul_i32 s37, s41, 160
    v_add_u32 v52, s37, v52
    v_mov_b32 v9, 0x40000000
    v_cmp_gt_u32 vcc, 60, v7
    s_nop 1
    v_cndmask_b32 v52, v9, v52, vcc
    v_lshrrev_b32 v10, 5, v1
    v_mul_u32_u24 v10, 1280, v10
    v_and_b32_e64 v11, 31, v1
    v_lshl_add_u32 v50, v11, 4, v10
    v_cmp_gt_u32 vcc, 16, v11
    s_nop 1
    v_cndmask_b32 v51, v9, v50, vcc
    v_lshlrev_b32 v204, 4, v1
    s_waitcnt lgkmcnt(0)
    s_nop 0
    s_mul_i32 s37, s27, 163840
    s_add_u32 s8, s44, s37
    s_addc_u32 s9, s45, 0
    s_and_b32 s9, s9, 0xffff
    s_mov_b32 s10, 163840
    s_mov_b32 s11, 0x20000
    s_mov_b32 s12, s54
    s_nop 0
    s_and_b32 s13, s55, 0xffff
    s_mov_b32 s14, 2211840
    s_mov_b32 s15, 0x20000
    s_mov_b32 s64, s46
    s_nop 0
    s_and_b32 s65, s47, 0xffff
    s_mov_b32 s66, 2457600
    s_mov_b32 s67, 0x20000
    s_mov_b32 s68, s54
    s_nop 0
    s_and_b32 s69, s55, 0xffff
    s_mov_b32 s70, 2211840
    s_mov_b32 s71, 0x20000
    s_add_u32 m0, s35, 0
    s_nop 0
    buffer_load_dwordx4 v200, s[8:11], s30 offen lds
    s_add_u32 m0, s35, 1024
    s_nop 0
    s_nop 0
    buffer_load_dwordx4 v201, s[8:11], s30 offen lds
    s_add_u32 s5, s5, 1
    s_cmp_eq_u32 s5, 10
    s_cselect_b32 s5, 0, s5
    s_lshl_b32 s30, s5, 7
    s_add_u32 m0, s36, 0
    s_nop 0
    buffer_load_dwordx4 v202, s[12:15], s31 offen lds
    s_add_u32 m0, s36, 1024
    s_nop 0
    s_nop 0
    buffer_load_dwordx4 v203, s[12:15], s32 offen lds
    s_add_u32 m0, s36, 2048
    s_nop 0
    s_nop 0
    buffer_load_dwordx4 v202, s[12:15], s33 offen lds
    s_add_u32 m0, s36, 3072
    s_nop 0
    s_nop 0
    buffer_load_dwordx4 v203, s[12:15], s34 offen lds
    s_mul_i32 s31, s5, 221184
    s_add_u32 s32, s31, 6912
    s_add_u32 s33, s31, 13824
    s_add_u32 s34, s31, 20736
    s_add_u32 m0, s35, 16384
    s_nop 0
    s_nop 0
    buffer_load_dwordx4 v200, s[8:11], s30 offen lds
    s_add_u32 m0, s35, 17408
    s_nop 0
    s_nop 0
    buffer_load_dwordx4 v201, s[8:11], s30 offen lds
    s_add_u32 s5, s5, 1
    s_cmp_eq_u32 s5, 10
    s_cselect_b32 s5, 0, s5
    s_lshl_b32 s30, s5, 7
    s_add_u32 m0, s36, 32768
    s_nop 0
    s_nop 0
    buffer_load_dwordx4 v202, s[12:15], s31 offen lds
    s_add_u32 m0, s36, 33792
    s_nop 0
    s_nop 0
    buffer_load_dwordx4 v203, s[12:15], s32 offen lds
    s_add_u32 m0, s36, 34816
    s_nop 0
    s_nop 0
    buffer_load_dwordx4 v202, s[12:15], s33 offen lds
    s_add_u32 m0, s36, 35840
    s_nop 0
    s_nop 0
    buffer_load_dwordx4 v203, s[12:15], s34 offen lds
    s_mul_i32 s31, s5, 221184
    s_add_u32 s32, s31, 6912
    s_add_u32 s33, s31, 13824
    s_add_u32 s34, s31, 20736
    s_mov_b32 s20, s62
    s_nop 0
    s_and_b32 s21, s63, 0xffff
    s_mov_b32 s22, 23396352
    s_mov_b32 s23, 0x20000
    s_lshl_b32 s37, s27, 7
    s_nop 0
    s_add_u32 s37, s37, 23330816
    s_and_b32 s38, s29, 7
    s_lshl_b32 s38, s38, 7
    s_add_u32 s38, s38, 23332864
    v_mov_b32 v212, s37
    v_subrev_u32 v7, 0, v1
    v_cmp_gt_u32 vcc, 8, v7
    v_lshlrev_b32 v7, 2, v7
    v_add_u32 v7, s37, v7
    v_cndmask_b32 v212, v212, v7, vcc
    v_subrev_u32 v7, 8, v1
    v_cmp_gt_u32 vcc, 16, v7
    v_lshlrev_b32 v7, 2, v7
    v_add_u32 v7, s38, v7
    v_cndmask_b32 v212, v212, v7, vcc
    v_lshrrev_b32 v2, 5, v1
    v_bfe_u32 v3, v1, 4, 1
    v_bfe_u32 v4, v1, 2, 2
    v_and_b32 v5, 3, v1
    v_and_b32 v6, 31, v1
    s_lshl_b32 s37, s25, 12
    v_lshlrev_b32 v7, 7, v6
    v_add_u32_e64 v7, s37, v7
    v_bfe_u32 v8, v6, 1, 3
    v_xor_b32_e64 v8, v8, v2
    v_lshl_add_u32 v180, v8, 4, v7
    v_xor_b32 v181, 32, v180
    v_xor_b32 v182, 64, v180
    v_xor_b32 v183, 96, v180
    s_and_b32 s25, s24, 1
    s_lshr_b32 s26, s24, 1
    s_lshl_b32 s37, s25, 13
    v_lshlrev_b32 v7, 7, v6
    v_add_u32_e64 v7, s37, v7
    v_bfe_u32 v8, v6, 1, 3
    v_xor_b32_e64 v8, v8, v2
    v_lshl_add_u32 v180, v8, 4, v7
    v_xor_b32 v181, 32, v180
    v_xor_b32 v182, 64, v180
    v_xor_b32 v183, 96, v180
    v_and_b32_e64 v7, 1, v5
    v_lshl_add_u32 v7, v3, 1, v7
    v_lshrrev_b32_e64 v8, 1, v5
    v_lshl_add_u32 v9, v2, 3, v4
    v_lshlrev_b32_e64 v9, 9, v9
    v_lshl_add_u32 v9, v8, 3, v9
    v_add_u32 v9, 49152, v9
    s_lshl_b32 s37, s26, 3
    v_add_u32 v7, s37, v7
    v_lshlrev_b32 v10, 2, v4
    v_add_u32 v11, 0, v7
    v_xor_b32_e64 v11, v11, v10
    v_lshl_add_u32 v184, v11, 4, v9
    v_add_u32 v188, 0x10000, v184
    v_add_u32 v11, 4, v7
    v_xor_b32 v11, v11, v10
    v_lshl_add_u32 v185, v11, 4, v9
    v_add_u32 v189, 0x10000, v185
    s_waitcnt vmcnt(6)
    s_waitcnt lgkmcnt(0)
    s_barrier
    ds_read_b128 v[136:139], v180 offset:0
    ds_read_b64_tr_b16 v[128:129], v184 offset:0
    ds_read_b64_tr_b16 v[130:131], v184 offset:2048
    ds_read_b64_tr_b16 v[132:133], v185 offset:0
    ds_read_b64_tr_b16 v[134:135], v185 offset:2048
    ds_read_b128 v[140:143], v180 offset:4096
    s_waitcnt lgkmcnt(3)
    v_mfma_f32_32x32x16_bf16 v[64:79], v[128:131], v[136:139], 0
    ds_read_b128 v[156:159], v181 offset:0
    ds_read_b64_tr_b16 v[148:149], v184 offset:8192
    ds_read_b64_tr_b16 v[150:151], v184 offset:10240
    s_add_u32 m0, s35, 32768
    s_nop 0
    buffer_load_dwordx4 v200, s[8:11], s30 offen lds
    s_waitcnt lgkmcnt(4)
    v_mfma_f32_32x32x16_bf16 v[80:95], v[132:135], v[136:139], 0
    ds_read_b64_tr_b16 v[152:153], v185 offset:8192
    ds_read_b64_tr_b16 v[154:155], v185 offset:10240
    s_waitcnt lgkmcnt(5)
    v_mfma_f32_32x32x16_bf16 v[96:111], v[128:131], v[140:143], 0
    ds_read_b128 v[160:163], v181 offset:4096
    s_add_u32 m0, s35, 33792
    s_nop 0
    buffer_load_dwordx4 v201, s[8:11], s30 offen lds
    s_add_u32 s5, s5, 1
    s_cmp_eq_u32 s5, 10
    s_cselect_b32 s5, 0, s5
    s_lshl_b32 s30, s5, 7
    v_mfma_f32_32x32x16_bf16 v[112:127], v[132:135], v[140:143], 0
    s_waitcnt lgkmcnt(3)
    v_mfma_f32_32x32x16_bf16 v[64:79], v[148:151], v[156:159], v[64:79]
    ds_read_b128 v[136:139], v182 offset:0
    ds_read_b64_tr_b16 v[128:129], v184 offset:16384
    ds_read_b64_tr_b16 v[130:131], v184 offset:18432
    s_add_u32 m0, s36, 65536
    s_nop 0
    buffer_load_dwordx4 v202, s[12:15], s31 offen lds
    s_waitcnt lgkmcnt(4)
    v_mfma_f32_32x32x16_bf16 v[80:95], v[152:155], v[156:159], v[80:95]
    ds_read_b64_tr_b16 v[132:133], v185 offset:16384
    ds_read_b64_tr_b16 v[134:135], v185 offset:18432
    s_waitcnt lgkmcnt(5)
    v_mfma_f32_32x32x16_bf16 v[96:111], v[148:151], v[160:163], v[96:111]
    ds_read_b128 v[140:143], v182 offset:4096
    s_add_u32 m0, s36, 66560
    s_nop 0
    buffer_load_dwordx4 v203, s[12:15], s32 offen lds
    v_mfma_f32_32x32x16_bf16 v[112:127], v[152:155], v[160:163], v[112:127]
    s_waitcnt lgkmcnt(3)
    v_mfma_f32_32x32x16_bf16 v[64:79], v[128:131], v[136:139], v[64:79]
    ds_read_b128 v[156:159], v183 offset:0
    ds_read_b64_tr_b16 v[148:149], v184 offset:24576
    ds_read_b64_tr_b16 v[150:151], v184 offset:26624
    ds_read_b64_tr_b16 v[152:153], v185 offset:24576
    ds_read_b64_tr_b16 v[154:155], v185 offset:26624
    ds_read_b128 v[160:163], v183 offset:4096
    s_add_u32 m0, s36, 67584
    s_nop 0
    buffer_load_dwordx4 v202, s[12:15], s33 offen lds
    s_waitcnt lgkmcnt(7)
    v_mfma_f32_32x32x16_bf16 v[80:95], v[132:135], v[136:139], v[80:95]
    s_waitcnt lgkmcnt(6)
    v_mfma_f32_32x32x16_bf16 v[96:111], v[128:131], v[140:143], v[96:111]
    s_add_u32 m0, s36, 68608
    s_nop 0
    buffer_load_dwordx4 v203, s[12:15], s34 offen lds
    s_mul_i32 s31, s5, 221184
    s_add_u32 s32, s31, 6912
    s_add_u32 s33, s31, 13824
    s_add_u32 s34, s31, 20736
    v_mfma_f32_32x32x16_bf16 v[112:127], v[132:135], v[140:143], v[112:127]
    s_waitcnt lgkmcnt(0)
    s_waitcnt vmcnt(6)
    s_barrier
    v_mov_b32 v213, 0
    global_load_dword v213, v213, s[60:61] sc1
    s_lshl_b32 s37, s41, 4
    s_lshl_b32 s38, s24, 1
    s_add_u32 s37, s37, s38
    s_mul_i32 s37, s37, 1280
    buffer_load_dwordx4 v[16:19], v50, s[8:11], s37 offen
    buffer_load_dwordx4 v[20:23], v50, s[8:11], s37 offen offset:512
    buffer_load_dwordx4 v[24:27], v51, s[8:11], s37 offen offset:1024
    s_mul_i32 s37, s27, 153600
    buffer_load_dwordx2 v[28:29], v52, s[64:67], s37 offen
    s_add_u32 s37, s37, 30720
    buffer_load_dwordx2 v[30:31], v52, s[64:67], s37 offen
    s_add_u32 s37, s37, 30720
    buffer_load_dwordx2 v[32:33], v52, s[64:67], s37 offen
    s_add_u32 s37, s37, 30720
    buffer_load_dwordx2 v[34:35], v52, s[64:67], s37 offen
    s_add_u32 s37, s37, 30720
    buffer_load_dwordx2 v[36:37], v52, s[64:67], s37 offen
    s_mul_i32 s37, s27, 138240
    buffer_load_dwordx2 v[38:39], v53, s[68:71], s37 offen
    s_add_u32 s37, s37, 27648
    buffer_load_dwordx2 v[40:41], v53, s[68:71], s37 offen
    s_add_u32 s37, s37, 27648
    buffer_load_dwordx2 v[42:43], v53, s[68:71], s37 offen
    s_add_u32 s37, s37, 27648
    buffer_load_dwordx2 v[44:45], v53, s[68:71], s37 offen
    s_add_u32 s37, s37, 27648
    buffer_load_dwordx2 v[46:47], v53, s[68:71], s37 offen
    v_mfma_f32_32x32x16_bf16 v[64:79], v[148:151], v[156:159], v[64:79]
    ds_read_b128 v[136:139], v180 offset:16384
    ds_read_b64_tr_b16 v[128:129], v184 offset:32768
    ds_read_b64_tr_b16 v[130:131], v184 offset:34816
    s_add_u32 m0, s35, 0
    s_nop 0
    buffer_load_dwordx4 v200, s[8:11], s30 offen lds
    v_mfma_f32_32x32x16_bf16 v[80:95], v[152:155], v[156:159], v[80:95]
    ds_read_b64_tr_b16 v[132:133], v185 offset:32768
    ds_read_b64_tr_b16 v[134:135], v185 offset:34816
    v_mfma_f32_32x32x16_bf16 v[96:111], v[148:151], v[160:163], v[96:111]
    ds_read_b128 v[140:143], v180 offset:20480
    s_add_u32 m0, s35, 1024
    s_nop 0
    buffer_load_dwordx4 v201, s[8:11], s30 offen lds
    s_add_u32 s5, s5, 1
    s_cmp_eq_u32 s5, 10
    s_cselect_b32 s5, 0, s5
    s_lshl_b32 s30, s5, 7
    v_mfma_f32_32x32x16_bf16 v[112:127], v[152:155], v[160:163], v[112:127]
    s_waitcnt lgkmcnt(3)
    v_mfma_f32_32x32x16_bf16 v[64:79], v[128:131], v[136:139], v[64:79]
    ds_read_b128 v[156:159], v181 offset:16384
    ds_read_b64_tr_b16 v[148:149], v184 offset:40960
    ds_read_b64_tr_b16 v[150:151], v184 offset:43008
    s_add_u32 m0, s36, 0
    s_nop 0
    buffer_load_dwordx4 v202, s[12:15], s31 offen lds
    s_waitcnt lgkmcnt(4)
    v_mfma_f32_32x32x16_bf16 v[80:95], v[132:135], v[136:139], v[80:95]
    ds_read_b64_tr_b16 v[152:153], v185 offset:40960
    ds_read_b64_tr_b16 v[154:155], v185 offset:43008
    s_waitcnt lgkmcnt(5)
    v_mfma_f32_32x32x16_bf16 v[96:111], v[128:131], v[140:143], v[96:111]
    ds_read_b128 v[160:163], v181 offset:20480
    s_add_u32 m0, s36, 1024
    s_nop 0
    buffer_load_dwordx4 v203, s[12:15], s32 offen lds
    v_mfma_f32_32x32x16_bf16 v[112:127], v[132:135], v[140:143], v[112:127]
    s_waitcnt lgkmcnt(3)
    v_mfma_f32_32x32x16_bf16 v[64:79], v[148:151], v[156:159], v[64:79]
    ds_read_b128 v[136:139], v182 offset:16384
    ds_read_b64_tr_b16 v[128:129], v184 offset:49152
    ds_read_b64_tr_b16 v[130:131], v184 offset:51200
    s_add_u32 m0, s36, 2048
    s_nop 0
    buffer_load_dwordx4 v202, s[12:15], s33 offen lds
    s_waitcnt lgkmcnt(4)
    v_mfma_f32_32x32x16_bf16 v[80:95], v[152:155], v[156:159], v[80:95]
    ds_read_b64_tr_b16 v[132:133], v185 offset:49152
    ds_read_b64_tr_b16 v[134:135], v185 offset:51200
    s_waitcnt lgkmcnt(5)
    v_mfma_f32_32x32x16_bf16 v[96:111], v[148:151], v[160:163], v[96:111]
    ds_read_b128 v[140:143], v182 offset:20480
    v_mfma_f32_32x32x16_bf16 v[112:127], v[152:155], v[160:163], v[112:127]
    s_waitcnt lgkmcnt(3)
    v_mfma_f32_32x32x16_bf16 v[64:79], v[128:131], v[136:139], v[64:79]
    ds_read_b128 v[156:159], v183 offset:16384
    ds_read_b64_tr_b16 v[148:149], v184 offset:57344
    ds_read_b64_tr_b16 v[150:151], v184 offset:59392
    ds_read_b64_tr_b16 v[152:153], v185 offset:57344
    ds_read_b64_tr_b16 v[154:155], v185 offset:59392
    ds_read_b128 v[160:163], v183 offset:20480
    s_add_u32 m0, s36, 3072
    s_nop 0
    buffer_load_dwordx4 v203, s[12:15], s34 offen lds
    s_mul_i32 s31, s5, 221184
    s_add_u32 s32, s31, 6912
    s_add_u32 s33, s31, 13824
    s_add_u32 s34, s31, 20736
    s_waitcnt lgkmcnt(7)
    v_mfma_f32_32x32x16_bf16 v[80:95], v[132:135], v[136:139], v[80:95]
    s_waitcnt lgkmcnt(6)
    v_mfma_f32_32x32x16_bf16 v[96:111], v[128:131], v[140:143], v[96:111]
    v_mfma_f32_32x32x16_bf16 v[112:127], v[132:135], v[140:143], v[112:127]
    s_waitcnt lgkmcnt(0)
    s_waitcnt vmcnt(19)
KF_NON_FN:
    v_readfirstlane_b32 s4, v213
    s_nop 0
    s_cmp_lg_u32 s4, 0
    s_cbranch_scc1 KF_NOK_FN
    s_sleep 8
    v_mov_b32 v213, 0
    global_load_dword v213, v213, s[60:61] sc1
    s_waitcnt vmcnt(0)
    s_branch KF_NON_FN
KF_NOK_FN:
    s_barrier
    s_waitcnt vmcnt(6)
    v_mfma_f32_32x32x16_bf16 v[64:79], v[148:151], v[156:159], v[64:79]
    ds_read_b128 v[136:139], v180 offset:32768
    ds_read_b64_tr_b16 v[128:129], v188 offset:0
    ds_read_b64_tr_b16 v[130:131], v188 offset:2048
    s_add_u32 m0, s35, 16384
    s_nop 0
    buffer_load_dwordx4 v200, s[8:11], s30 offen lds
    v_lshlrev_b32 v216, 16, v16
    v_lshlrev_b32 v246, 16, v28
    v_lshlrev_b32 v48, 16, v38
    v_and_b32 v217, 0xffff0000, v16
    v_and_b32 v247, 0xffff0000, v28
    v_and_b32 v49, 0xffff0000, v38
    v_lshlrev_b32 v218, 16, v17
    v_lshlrev_b32 v248, 16, v29
    v_lshlrev_b32_e64 v50, 16, v39
    v_and_b32 v219, 0xffff0000, v17
    v_and_b32 v249, 0xffff0000, v29
    v_and_b32 v51, 0xffff0000, v39
    v_lshlrev_b32_e64 v220, 16, v18
    v_mfma_f32_32x32x16_bf16 v[80:95], v[152:155], v[156:159], v[80:95]
    ds_read_b64_tr_b16 v[132:133], v189 offset:0
    ds_read_b64_tr_b16 v[134:135], v189 offset:2048
    v_lshlrev_b32 v250, 16, v30
    v_lshlrev_b32 v52, 16, v40
    v_and_b32 v221, 0xffff0000, v18
    v_and_b32 v251, 0xffff0000, v30
    v_and_b32 v53, 0xffff0000, v40
    v_lshlrev_b32 v222, 16, v19
    v_lshlrev_b32 v252, 16, v31
    v_lshlrev_b32_e64 v54, 16, v41
    v_and_b32 v223, 0xffff0000, v19
    v_and_b32 v253, 0xffff0000, v31
    v_and_b32 v55, 0xffff0000, v41
    v_lshlrev_b32 v224, 16, v20
    v_add_f32 v246, v246, v250
    v_mfma_f32_32x32x16_bf16 v[96:111], v[148:151], v[160:163], v[96:111]
    ds_read_b128 v[140:143], v180 offset:36864
    s_add_u32 m0, s35, 17408
    s_nop 0
    buffer_load_dwordx4 v201, s[8:11], s30 offen lds
    s_add_u32 s5, s5, 1
    s_cmp_eq_u32 s5, 10
    s_cselect_b32 s5, 0, s5
    s_lshl_b32 s30, s5, 7
    v_add_f32 v48, v48, v52
    v_and_b32 v225, 0xffff0000, v20
    v_add_f32 v247, v247, v251
    v_add_f32 v49, v49, v53
    v_lshlrev_b32 v226, 16, v21
    v_add_f32 v248, v248, v252
    v_add_f32_e64 v50, v50, v54
    v_and_b32 v227, 0xffff0000, v21
    v_add_f32 v249, v249, v253
    v_add_f32 v51, v51, v55
    v_lshlrev_b32 v228, 16, v22
    v_lshlrev_b32 v250, 16, v32
    v_lshlrev_b32_e64 v52, 16, v42
    v_mfma_f32_32x32x16_bf16 v[112:127], v[152:155], v[160:163], v[112:127]
    v_and_b32 v229, 0xffff0000, v22
    v_and_b32 v251, 0xffff0000, v32
    v_and_b32 v53, 0xffff0000, v42
    v_lshlrev_b32 v230, 16, v23
    v_lshlrev_b32 v252, 16, v33
    v_lshlrev_b32_e64 v54, 16, v43
    v_and_b32 v231, 0xffff0000, v23
    v_and_b32 v253, 0xffff0000, v33
    v_and_b32 v55, 0xffff0000, v43
    v_lshlrev_b32 v232, 16, v24
    v_add_f32 v246, v246, v250
    s_waitcnt lgkmcnt(3)
    v_mfma_f32_32x32x16_bf16 v[64:79], v[128:131], v[136:139], v[64:79]
    ds_read_b128 v[156:159], v181 offset:32768
    ds_read_b64_tr_b16 v[148:149], v188 offset:8192
    ds_read_b64_tr_b16 v[150:151], v188 offset:10240
    s_add_u32 m0, s36, 32768
    s_nop 0
    buffer_load_dwordx4 v202, s[12:15], s31 offen lds
    v_add_f32_e64 v48, v48, v52
    v_and_b32 v233, 0xffff0000, v24
    v_add_f32 v247, v247, v251
    v_add_f32 v49, v49, v53
    v_lshlrev_b32 v234, 16, v25
    v_add_f32 v248, v248, v252
    v_add_f32_e64 v50, v50, v54
    v_and_b32 v235, 0xffff0000, v25
    v_add_f32 v249, v249, v253
    v_add_f32 v51, v51, v55
    v_lshlrev_b32 v236, 16, v26
    v_lshlrev_b32 v250, 16, v34
    v_lshlrev_b32 v52, 16, v44
    s_waitcnt lgkmcnt(4)
    v_mfma_f32_32x32x16_bf16 v[80:95], v[132:135], v[136:139], v[80:95]
    ds_read_b64_tr_b16 v[152:153], v189 offset:8192
    ds_read_b64_tr_b16 v[154:155], v189 offset:10240
    v_and_b32 v237, 0xffff0000, v26
    v_and_b32 v251, 0xffff0000, v34
    v_and_b32 v53, 0xffff0000, v44
    v_lshlrev_b32 v238, 16, v27
    v_lshlrev_b32 v252, 16, v35
    v_lshlrev_b32_e64 v54, 16, v45
    v_and_b32 v239, 0xffff0000, v27
    v_and_b32 v253, 0xffff0000, v35
    v_and_b32 v55, 0xffff0000, v45
    v_add_f32 v240, v216, v217
    v_add_f32 v246, v246, v250
    v_add_f32 v48, v48, v52
    v_add_f32 v241, v218, v219
    s_waitcnt lgkmcnt(5)
    v_mfma_f32_32x32x16_bf16 v[96:111], v[128:131], v[140:143], v[96:111]
    ds_read_b128 v[160:163], v181 offset:36864
    s_add_u32 m0, s36, 33792
    s_nop 0
    buffer_load_dwordx4 v203, s[12:15], s32 offen lds
    v_add_f32 v247, v247, v251
    v_add_f32 v49, v49, v53
    v_add_f32 v240, v240, v220
    v_add_f32 v248, v248, v252
    v_add_f32 v50, v50, v54
    v_add_f32 v241, v241, v221
    v_add_f32 v249, v249, v253
    v_add_f32 v51, v51, v55
    v_add_f32 v240, v240, v222
    v_lshlrev_b32 v250, 16, v36
    v_lshlrev_b32 v52, 16, v46
    v_add_f32 v241, v241, v223
    v_and_b32 v251, 0xffff0000, v36
    v_mfma_f32_32x32x16_bf16 v[112:127], v[132:135], v[140:143], v[112:127]
    v_and_b32 v53, 0xffff0000, v46
    v_add_f32 v240, v240, v224
    v_lshlrev_b32 v252, 16, v37
    v_lshlrev_b32 v54, 16, v47
    v_add_f32 v241, v241, v225
    v_and_b32 v253, 0xffff0000, v37
    v_and_b32 v55, 0xffff0000, v47
    v_add_f32 v240, v240, v226
    v_add_f32 v246, v246, v250
    v_add_f32 v48, v48, v52
    v_add_f32 v241, v241, v227
    s_waitcnt lgkmcnt(3)
    v_mfma_f32_32x32x16_bf16 v[64:79], v[148:151], v[156:159], v[64:79]
    ds_read_b128 v[136:139], v182 offset:32768
    ds_read_b64_tr_b16 v[128:129], v188 offset:16384
    ds_read_b64_tr_b16 v[130:131], v188 offset:18432
    s_add_u32 m0, s36, 34816
    s_nop 0
    buffer_load_dwordx4 v202, s[12:15], s33 offen lds
    v_add_f32 v247, v247, v251
    v_add_f32 v49, v49, v53
    v_add_f32 v240, v240, v228
    v_add_f32 v248, v248, v252
    v_add_f32 v50, v50, v54
    v_add_f32 v241, v241, v229
    v_add_f32 v249, v249, v253
    v_add_f32 v51, v51, v55
    v_add_f32_e64 v240, v240, v230
    v_add_f32_dpp v246, v246, v246 row_ror:8 row_mask:0xf bank_mask:0xf
    v_add_f32_dpp v48, v48, v48 row_ror:8 row_mask:0xf bank_mask:0xf
    v_add_f32_e64 v241, v241, v231
    v_add_f32_dpp v247, v247, v247 row_ror:8 row_mask:0xf bank_mask:0xf
    s_waitcnt lgkmcnt(4)
    v_mfma_f32_32x32x16_bf16 v[80:95], v[152:155], v[156:159], v[80:95]
    ds_read_b64_tr_b16 v[132:133], v189 offset:16384
    ds_read_b64_tr_b16 v[134:135], v189 offset:18432
    v_add_f32_dpp v49, v49, v49 row_ror:8 row_mask:0xf bank_mask:0xf
    v_add_f32 v240, v240, v232
    v_add_f32_dpp v248, v248, v248 row_ror:8 row_mask:0xf bank_mask:0xf
    v_add_f32_dpp v50, v50, v50 row_ror:8 row_mask:0xf bank_mask:0xf
    v_add_f32_e64 v241, v241, v233
    v_add_f32_dpp v249, v249, v249 row_ror:8 row_mask:0xf bank_mask:0xf
    v_add_f32_dpp v51, v51, v51 row_ror:8 row_mask:0xf bank_mask:0xf
    v_add_f32 v240, v240, v234
    v_mov_b32 v250, v246
    v_mov_b32 v52, v48
    v_add_f32 v241, v241, v235
    v_mov_b32 v251, v247
    v_mov_b32 v53, v49
    s_waitcnt lgkmcnt(5)
    v_mfma_f32_32x32x16_bf16 v[96:111], v[148:151], v[160:163], v[96:111]
    ds_read_b128 v[140:143], v182 offset:36864
    v_add_f32 v240, v240, v236
    v_mov_b32 v252, v248
    v_mov_b32 v54, v50
    v_add_f32 v241, v241, v237
    v_mov_b32 v253, v249
    v_mov_b32 v55, v51
    v_add_f32 v240, v240, v238
    v_permlane16_swap_b32 v246, v250
    v_permlane16_swap_b32 v48, v52
    v_add_f32 v241, v241, v239
    v_permlane16_swap_b32 v247, v251
    v_permlane16_swap_b32 v49, v53
    v_add_f32 v240, v240, v241
    v_mfma_f32_32x32x16_bf16 v[112:127], v[152:155], v[160:163], v[112:127]
    v_permlane16_swap_b32 v248, v252
    v_permlane16_swap_b32 v50, v54
    v_add_f32_dpp v240, v240, v240 quad_perm:[1,0,3,2] row_mask:0xf bank_mask:0xf
    v_permlane16_swap_b32 v249, v253
    v_permlane16_swap_b32 v51, v55
    v_add_f32_dpp v240, v240, v240 quad_perm:[2,3,0,1] row_mask:0xf bank_mask:0xf
    v_add_f32 v246, v246, v250
    v_add_f32 v48, v48, v52
    v_add_f32_dpp v240, v240, v240 row_half_mirror row_mask:0xf bank_mask:0xf
    v_add_f32 v247, v247, v251
    v_add_f32 v49, v49, v53
    s_waitcnt lgkmcnt(3)
    v_mfma_f32_32x32x16_bf16 v[64:79], v[128:131], v[136:139], v[64:79]
    ds_read_b128 v[156:159], v183 offset:32768
    ds_read_b64_tr_b16 v[148:149], v188 offset:24576
    ds_read_b64_tr_b16 v[150:151], v188 offset:26624
    ds_read_b64_tr_b16 v[152:153], v189 offset:24576
    ds_read_b64_tr_b16 v[154:155], v189 offset:26624
    ds_read_b128 v[160:163], v183 offset:36864
    s_add_u32 m0, s36, 35840
    s_nop 0
    buffer_load_dwordx4 v203, s[12:15], s34 offen lds
    s_mul_i32 s31, s5, 221184
    s_add_u32 s32, s31, 6912
    s_add_u32 s33, s31, 13824
    s_add_u32 s34, s31, 20736
    v_add_f32_dpp v240, v240, v240 row_mirror row_mask:0xf bank_mask:0xf
    v_add_f32 v248, v248, v252
    v_add_f32 v50, v50, v54
    v_mov_b32 v241, v240
    v_add_f32 v249, v249, v253
    v_add_f32 v51, v51, v55
    v_permlane16_swap_b32 v240, v241
    v_mov_b32 v250, v246
    v_mov_b32 v52, v48
    v_add_f32 v240, v240, v241
    v_mov_b32 v251, v247
    v_mov_b32_e64 v53, v49
    v_mul_f32 v242, 0x3acccccd, v240
    s_waitcnt lgkmcnt(7)
    v_mfma_f32_32x32x16_bf16 v[80:95], v[132:135], v[136:139], v[80:95]
    v_mov_b32 v252, v248
    v_mov_b32 v54, v50
    v_sub_f32 v216, v216, v242
    v_mov_b32 v253, v249
    v_mov_b32 v55, v51
    v_sub_f32 v217, v217, v242
    v_permlane32_swap_b32 v246, v250
    v_permlane32_swap_b32 v48, v52
    v_sub_f32 v218, v218, v242
    v_permlane32_swap_b32 v247, v251
    v_permlane32_swap_b32 v49, v53
    v_sub_f32 v219, v219, v242
    v_permlane32_swap_b32 v248, v252
    s_waitcnt lgkmcnt(6)
    v_mfma_f32_32x32x16_bf16 v[96:111], v[128:131], v[140:143], v[96:111]
    v_permlane32_swap_b32 v50, v54
    v_sub_f32 v220, v220, v242
    v_permlane32_swap_b32 v249, v253
    v_permlane32_swap_b32 v51, v55
    v_sub_f32 v221, v221, v242
    v_add_f32 v246, v246, v250
    v_add_f32 v48, v48, v52
    v_sub_f32 v222, v222, v242
    v_add_f32 v247, v247, v251
    v_add_f32 v49, v49, v53
    v_sub_f32 v223, v223, v242
    v_add_f32 v248, v248, v252
    v_add_f32 v50, v50, v54
    v_mfma_f32_32x32x16_bf16 v[112:127], v[132:135], v[140:143], v[112:127]
    v_sub_f32 v224, v224, v242
    v_add_f32 v249, v249, v253
    v_add_f32 v51, v51, v55
    v_sub_f32 v225, v225, v242
    v_sub_f32 v226, v226, v242
    v_sub_f32 v227, v227, v242
    v_sub_f32 v228, v228, v242
    v_sub_f32 v229, v229, v242
    v_sub_f32 v230, v230, v242
    v_sub_f32 v231, v231, v242
    v_sub_f32 v232, v232, v242
    s_waitcnt lgkmcnt(0)
    s_waitcnt vmcnt(6)
    s_barrier
    v_mfma_f32_32x32x16_bf16 v[64:79], v[148:151], v[156:159], v[64:79]
    ds_read_b128 v[136:139], v180 offset:0
    ds_read_b64_tr_b16 v[128:129], v184 offset:0
    ds_read_b64_tr_b16 v[130:131], v184 offset:2048
    s_add_u32 m0, s35, 32768
    s_nop 0
    buffer_load_dwordx4 v200, s[8:11], s30 offen lds
    v_sub_f32 v233, v233, v242
    v_sub_f32 v234, v234, v242
    v_sub_f32 v235, v235, v242
    v_sub_f32 v236, v236, v242
    v_sub_f32 v237, v237, v242
    v_sub_f32 v238, v238, v242
    v_sub_f32 v239, v239, v242
    v_mul_f32 v240, v216, v216
    v_mul_f32 v241, v217, v217
    v_fma_f32 v240, v218, v218, v240
    v_fma_f32 v241, v219, v219, v241
    v_fma_f32 v240, v220, v220, v240
    v_mfma_f32_32x32x16_bf16 v[80:95], v[152:155], v[156:159], v[80:95]
    ds_read_b64_tr_b16 v[132:133], v185 offset:0
    ds_read_b64_tr_b16 v[134:135], v185 offset:2048
    v_fma_f32 v241, v221, v221, v241
    v_fma_f32 v240, v222, v222, v240
    v_fma_f32 v241, v223, v223, v241
    v_fma_f32 v240, v224, v224, v240
    v_fma_f32 v241, v225, v225, v241
    v_fma_f32 v240, v226, v226, v240
    v_fma_f32 v241, v227, v227, v241
    v_fma_f32 v240, v228, v228, v240
    v_fma_f32 v241, v229, v229, v241
    v_fma_f32 v240, v230, v230, v240
    v_fma_f32 v241, v231, v231, v241
    v_mul_f32_e64 v244, v232, v232
    v_mfma_f32_32x32x16_bf16 v[96:111], v[148:151], v[160:163], v[96:111]
    ds_read_b128 v[140:143], v180 offset:4096
    s_add_u32 m0, s35, 33792
    s_nop 0
    buffer_load_dwordx4 v201, s[8:11], s30 offen lds
    s_add_u32 s5, s5, 1
    s_cmp_eq_u32 s5, 10
    s_cselect_b32 s5, 0, s5
    s_lshl_b32 s30, s5, 7
    v_mul_f32 v245, v233, v233
    v_fma_f32 v244, v234, v234, v244
    v_fma_f32 v245, v235, v235, v245
    v_fma_f32 v244, v236, v236, v244
    v_fma_f32 v245, v237, v237, v245
    v_fma_f32 v244, v238, v238, v244
    v_fma_f32 v245, v239, v239, v245
    v_add_f32_e64 v244, v244, v245
    v_bfe_u32 v245, v1, 4, 1
    v_xor_b32 v245, 1, v245
    v_cvt_f32_u32 v245, v245
    v_add_f32_e64 v240, v240, v241
    v_mfma_f32_32x32x16_bf16 v[112:127], v[152:155], v[160:163], v[112:127]
    v_fma_f32 v240, v244, v245, v240
    s_nop 1
    v_add_f32_dpp v240, v240, v240 quad_perm:[1,0,3,2] row_mask:0xf bank_mask:0xf
    s_nop 1
    v_add_f32_dpp v240, v240, v240 quad_perm:[2,3,0,1] row_mask:0xf bank_mask:0xf
    s_nop 1
    v_add_f32_dpp v240, v240, v240 row_half_mirror row_mask:0xf bank_mask:0xf
    s_nop 1
    v_add_f32_dpp v240, v240, v240 row_mirror row_mask:0xf bank_mask:0xf
    v_mov_b32 v241, v240
    s_nop 1
    v_permlane16_swap_b32 v240, v241
    v_add_f32 v240, v240, v241
    v_mov_b32 v243, 0x3727c5ac
    v_fmac_f32 v243, 0x3acccccd, v240
    v_rsq_f32 v243, v243
    v_lshlrev_b32 v7, 4, v1
    v_mov_b32 v8, 0x40000000
    v_cmp_gt_u32 vcc, 8, v1
    s_nop 1
    v_cndmask_b32 v7, v8, v7, vcc
    s_sub_u32 s41, s29, 8
    s_add_u32 s37, s41, 0
    s_lshl_b32 s37, s37, 4
    s_add_u32 s37, s37, s27
    s_lshl_b32 s37, s37, 10
    s_lshl_b32 s38, s24, 7
    s_add_u32 s37, s37, s38
    s_add_u32 s37, s37, 23068672
    buffer_store_dwordx4 v[246:249], v7, s[20:23], s37 offen sc1
    s_add_u32 s37, s41, 8
    s_lshl_b32 s37, s37, 4
    s_add_u32 s37, s37, s27
    s_lshl_b32 s37, s37, 10
    s_lshl_b32 s38, s24, 7
    s_add_u32 s37, s37, s38
    s_add_u32 s37, s37, 23068672
    buffer_store_dwordx4 v[48:51], v7, s[20:23], s37 offen sc1
    s_lshl_b32 s37, s27, 7
    s_lshl_b32 s38, s41, 4
    s_add_u32 s37, s37, s38
    s_lshl_b32 s38, s24, 1
    s_add_u32 s37, s37, s38
    s_lshl_b32 s37, s37, 3
    v_lshrrev_b32 v7, 5, v1
    v_lshlrev_b32 v7, 3, v7
    v_and_b32 v9, 31, v1
    v_cmp_eq_u32 vcc, 0, v9
    s_nop 1
    v_cndmask_b32 v7, v8, v7, vcc
    buffer_store_dwordx2 v[242:243], v7, s[20:23], s37 offen sc1
    s_waitcnt lgkmcnt(3)
    v_mfma_f32_32x32x16_bf16 v[64:79], v[128:131], v[136:139], v[64:79]
    ds_read_b128 v[156:159], v181 offset:0
    ds_read_b64_tr_b16 v[148:149], v184 offset:8192
    ds_read_b64_tr_b16 v[150:151], v184 offset:10240
    s_add_u32 m0, s36, 65536
    s_nop 0
    buffer_load_dwordx4 v202, s[12:15], s31 offen lds
    s_waitcnt lgkmcnt(4)
    v_mfma_f32_32x32x16_bf16 v[80:95], v[132:135], v[136:139], v[80:95]
    ds_read_b64_tr_b16 v[152:153], v185 offset:8192
    ds_read_b64_tr_b16 v[154:155], v185 offset:10240
    s_waitcnt lgkmcnt(5)
    v_mfma_f32_32x32x16_bf16 v[96:111], v[128:131], v[140:143], v[96:111]
    ds_read_b128 v[160:163], v181 offset:4096
    s_add_u32 m0, s36, 66560
    s_nop 0
    buffer_load_dwordx4 v203, s[12:15], s32 offen lds
    v_mfma_f32_32x32x16_bf16 v[112:127], v[132:135], v[140:143], v[112:127]
    s_waitcnt lgkmcnt(3)
    v_mfma_f32_32x32x16_bf16 v[64:79], v[148:151], v[156:159], v[64:79]
    ds_read_b128 v[136:139], v182 offset:0
    ds_read_b64_tr_b16 v[128:129], v184 offset:16384
    ds_read_b64_tr_b16 v[130:131], v184 offset:18432
    s_add_u32 m0, s36, 67584
    s_nop 0
    buffer_load_dwordx4 v202, s[12:15], s33 offen lds
    s_waitcnt lgkmcnt(4)
    v_mfma_f32_32x32x16_bf16 v[80:95], v[152:155], v[156:159], v[80:95]
    ds_read_b64_tr_b16 v[132:133], v185 offset:16384
    ds_read_b64_tr_b16 v[134:135], v185 offset:18432
    s_waitcnt lgkmcnt(5)
    v_mfma_f32_32x32x16_bf16 v[96:111], v[148:151], v[160:163], v[96:111]
    ds_read_b128 v[140:143], v182 offset:4096
    v_mfma_f32_32x32x16_bf16 v[112:127], v[152:155], v[160:163], v[112:127]
    s_waitcnt lgkmcnt(3)
    v_mfma_f32_32x32x16_bf16 v[64:79], v[128:131], v[136:139], v[64:79]
    ds_read_b128 v[156:159], v183 offset:0
    ds_read_b64_tr_b16 v[148:149], v184 offset:24576
    ds_read_b64_tr_b16 v[150:151], v184 offset:26624
    ds_read_b64_tr_b16 v[152:153], v185 offset:24576
    ds_read_b64_tr_b16 v[154:155], v185 offset:26624
    ds_read_b128 v[160:163], v183 offset:4096
    s_add_u32 m0, s36, 68608
    s_nop 0
    buffer_load_dwordx4 v203, s[12:15], s34 offen lds
    s_mul_i32 s31, s5, 221184
    s_add_u32 s32, s31, 6912
    s_add_u32 s33, s31, 13824
    s_add_u32 s34, s31, 20736
    s_waitcnt lgkmcnt(7)
    v_mfma_f32_32x32x16_bf16 v[80:95], v[132:135], v[136:139], v[80:95]
    s_waitcnt lgkmcnt(6)
    v_mfma_f32_32x32x16_bf16 v[96:111], v[128:131], v[140:143], v[96:111]
    v_mfma_f32_32x32x16_bf16 v[112:127], v[132:135], v[140:143], v[112:127]
    s_waitcnt lgkmcnt(0)
    s_waitcnt vmcnt(4)
    s_barrier
    s_cmp_lg_u32 s24, 0
    s_cbranch_scc1 KF_NOPUB_F
    s_sub_u32 s38, s29, 8
    s_lshl_b32 s37, s27, 7
    s_lshl_b32 s39, s38, 2
    s_add_u32 s37, s37, s39
    s_add_u32 s37, s37, 23330816
    v_mov_b32 v8, s37
    v_mov_b32 v9, s4
    s_mov_b64 exec, 1
    global_store_dword v8, v9, s[62:63] sc1
    s_mov_b64 exec, -1
    s_lshl_b32 s37, s38, 7
    s_lshl_b32 s39, s27, 2
    s_add_u32 s37, s37, s39
    s_add_u32 s37, s37, 23332864
    v_mov_b32 v8, s37
    v_mov_b32 v9, s4
    s_mov_b64 exec, 1
    global_store_dword v8, v9, s[62:63] sc1
    s_mov_b64 exec, -1
KF_NOPUB_F:
    v_mfma_f32_32x32x16_bf16 v[64:79], v[148:151], v[156:159], v[64:79]
    ds_read_b128 v[136:139], v180 offset:16384
    ds_read_b64_tr_b16 v[128:129], v184 offset:32768
    ds_read_b64_tr_b16 v[130:131], v184 offset:34816
    s_add_u32 m0, s35, 0
    s_nop 0
    buffer_load_dwordx4 v200, s[8:11], s30 offen lds
    v_mfma_f32_32x32x16_bf16 v[80:95], v[152:155], v[156:159], v[80:95]
    ds_read_b64_tr_b16 v[132:133], v185 offset:32768
    ds_read_b64_tr_b16 v[134:135], v185 offset:34816
    v_mfma_f32_32x32x16_bf16 v[96:111], v[148:151], v[160:163], v[96:111]
    ds_read_b128 v[140:143], v180 offset:20480
    s_add_u32 m0, s35, 1024
    s_nop 0
    buffer_load_dwordx4 v201, s[8:11], s30 offen lds
    s_add_u32 s5, s5, 1
    s_cmp_eq_u32 s5, 10
    s_cselect_b32 s5, 0, s5
    s_lshl_b32 s30, s5, 7
    v_mfma_f32_32x32x16_bf16 v[112:127], v[152:155], v[160:163], v[112:127]
    s_waitcnt lgkmcnt(3)
    v_mfma_f32_32x32x16_bf16 v[64:79], v[128:131], v[136:139], v[64:79]
    ds_read_b128 v[156:159], v181 offset:16384
    ds_read_b64_tr_b16 v[148:149], v184 offset:40960
    ds_read_b64_tr_b16 v[150:151], v184 offset:43008
    s_add_u32 m0, s36, 0
    s_nop 0
    buffer_load_dwordx4 v202, s[12:15], s31 offen lds
    s_waitcnt lgkmcnt(4)
    v_mfma_f32_32x32x16_bf16 v[80:95], v[132:135], v[136:139], v[80:95]
    ds_read_b64_tr_b16 v[152:153], v185 offset:40960
    ds_read_b64_tr_b16 v[154:155], v185 offset:43008
    s_waitcnt lgkmcnt(5)
    v_mfma_f32_32x32x16_bf16 v[96:111], v[128:131], v[140:143], v[96:111]
    ds_read_b128 v[160:163], v181 offset:20480
    s_add_u32 m0, s36, 1024
    s_nop 0
    buffer_load_dwordx4 v203, s[12:15], s32 offen lds
    v_mfma_f32_32x32x16_bf16 v[112:127], v[132:135], v[140:143], v[112:127]
    s_waitcnt lgkmcnt(3)
    v_mfma_f32_32x32x16_bf16 v[64:79], v[148:151], v[156:159], v[64:79]
    ds_read_b128 v[136:139], v182 offset:16384
    ds_read_b64_tr_b16 v[128:129], v184 offset:49152
    ds_read_b64_tr_b16 v[130:131], v184 offset:51200
    s_add_u32 m0, s36, 2048
    s_nop 0
    buffer_load_dwordx4 v202, s[12:15], s33 offen lds
    s_waitcnt lgkmcnt(4)
    v_mfma_f32_32x32x16_bf16 v[80:95], v[152:155], v[156:159], v[80:95]
    ds_read_b64_tr_b16 v[132:133], v185 offset:49152
    ds_read_b64_tr_b16 v[134:135], v185 offset:51200
    s_waitcnt lgkmcnt(5)
    v_mfma_f32_32x32x16_bf16 v[96:111], v[148:151], v[160:163], v[96:111]
    ds_read_b128 v[140:143], v182 offset:20480
    v_mfma_f32_32x32x16_bf16 v[112:127], v[152:155], v[160:163], v[112:127]
    s_waitcnt lgkmcnt(3)
    v_mfma_f32_32x32x16_bf16 v[64:79], v[128:131], v[136:139], v[64:79]
    ds_read_b128 v[156:159], v183 offset:16384
    ds_read_b64_tr_b16 v[148:149], v184 offset:57344
    ds_read_b64_tr_b16 v[150:151], v184 offset:59392
    ds_read_b64_tr_b16 v[152:153], v185 offset:57344
    ds_read_b64_tr_b16 v[154:155], v185 offset:59392
    ds_read_b128 v[160:163], v183 offset:20480
    s_add_u32 m0, s36, 3072
    s_nop 0
    buffer_load_dwordx4 v203, s[12:15], s34 offen lds
    s_mul_i32 s31, s5, 221184
    s_add_u32 s32, s31, 6912
    s_add_u32 s33, s31, 13824
    s_add_u32 s34, s31, 20736
    s_waitcnt lgkmcnt(7)
    v_mfma_f32_32x32x16_bf16 v[80:95], v[132:135], v[136:139], v[80:95]
    s_waitcnt lgkmcnt(6)
    v_mfma_f32_32x32x16_bf16 v[96:111], v[128:131], v[140:143], v[96:111]
    v_mfma_f32_32x32x16_bf16 v[112:127], v[132:135], v[140:143], v[112:127]
    s_waitcnt lgkmcnt(0)
    s_waitcnt vmcnt(6)
    s_barrier
    v_mfma_f32_32x32x16_bf16 v[64:79], v[148:151], v[156:159], v[64:79]
    ds_read_b128 v[136:139], v180 offset:32768
    ds_read_b64_tr_b16 v[128:129], v188 offset:0
    ds_read_b64_tr_b16 v[130:131], v188 offset:2048
    s_add_u32 m0, s35, 16384
    s_nop 0
    buffer_load_dwordx4 v200, s[8:11], s30 offen lds
    v_mfma_f32_32x32x16_bf16 v[80:95], v[152:155], v[156:159], v[80:95]
    ds_read_b64_tr_b16 v[132:133], v189 offset:0
    ds_read_b64_tr_b16 v[134:135], v189 offset:2048
    v_mfma_f32_32x32x16_bf16 v[96:111], v[148:151], v[160:163], v[96:111]
    ds_read_b128 v[140:143], v180 offset:36864
    s_add_u32 m0, s35, 17408
    s_nop 0
    buffer_load_dwordx4 v201, s[8:11], s30 offen lds
    s_add_u32 s5, s5, 1
    s_cmp_eq_u32 s5, 10
    s_cselect_b32 s5, 0, s5
    s_lshl_b32 s30, s5, 7
    v_mfma_f32_32x32x16_bf16 v[112:127], v[152:155], v[160:163], v[112:127]
    s_waitcnt lgkmcnt(3)
    v_mfma_f32_32x32x16_bf16 v[64:79], v[128:131], v[136:139], v[64:79]
    ds_read_b128 v[156:159], v181 offset:32768
    ds_read_b64_tr_b16 v[148:149], v188 offset:8192
    ds_read_b64_tr_b16 v[150:151], v188 offset:10240
    s_add_u32 m0, s36, 32768
    s_nop 0
    buffer_load_dwordx4 v202, s[12:15], s31 offen lds
    s_waitcnt lgkmcnt(4)
    v_mfma_f32_32x32x16_bf16 v[80:95], v[132:135], v[136:139], v[80:95]
    ds_read_b64_tr_b16 v[152:153], v189 offset:8192
    ds_read_b64_tr_b16 v[154:155], v189 offset:10240
    s_waitcnt lgkmcnt(5)
    v_mfma_f32_32x32x16_bf16 v[96:111], v[128:131], v[140:143], v[96:111]
    ds_read_b128 v[160:163], v181 offset:36864
    s_add_u32 m0, s36, 33792
    s_nop 0
    buffer_load_dwordx4 v203, s[12:15], s32 offen lds
    v_mfma_f32_32x32x16_bf16 v[112:127], v[132:135], v[140:143], v[112:127]
    s_waitcnt lgkmcnt(3)
    v_mfma_f32_32x32x16_bf16 v[64:79], v[148:151], v[156:159], v[64:79]
    ds_read_b128 v[136:139], v182 offset:32768
    ds_read_b64_tr_b16 v[128:129], v188 offset:16384
    ds_read_b64_tr_b16 v[130:131], v188 offset:18432
    s_add_u32 m0, s36, 34816
    s_nop 0
    buffer_load_dwordx4 v202, s[12:15], s33 offen lds
    s_waitcnt lgkmcnt(4)
    v_mfma_f32_32x32x16_bf16 v[80:95], v[152:155], v[156:159], v[80:95]
    ds_read_b64_tr_b16 v[132:133], v189 offset:16384
    ds_read_b64_tr_b16 v[134:135], v189 offset:18432
    s_waitcnt lgkmcnt(5)
    v_mfma_f32_32x32x16_bf16 v[96:111], v[148:151], v[160:163], v[96:111]
    ds_read_b128 v[140:143], v182 offset:36864
    v_mfma_f32_32x32x16_bf16 v[112:127], v[152:155], v[160:163], v[112:127]
    s_waitcnt lgkmcnt(3)
    v_mfma_f32_32x32x16_bf16 v[64:79], v[128:131], v[136:139], v[64:79]
    ds_read_b128 v[156:159], v183 offset:32768
    ds_read_b64_tr_b16 v[148:149], v188 offset:24576
    ds_read_b64_tr_b16 v[150:151], v188 offset:26624
    ds_read_b64_tr_b16 v[152:153], v189 offset:24576
    ds_read_b64_tr_b16 v[154:155], v189 offset:26624
    ds_read_b128 v[160:163], v183 offset:36864
    s_add_u32 m0, s36, 35840
    s_nop 0
    buffer_load_dwordx4 v203, s[12:15], s34 offen lds
    s_mul_i32 s31, s5, 221184
    s_add_u32 s32, s31, 6912
    s_add_u32 s33, s31, 13824
    s_add_u32 s34, s31, 20736
    s_waitcnt lgkmcnt(7)
    v_mfma_f32_32x32x16_bf16 v[80:95], v[132:135], v[136:139], v[80:95]
    s_waitcnt lgkmcnt(6)
    v_mfma_f32_32x32x16_bf16 v[96:111], v[128:131], v[140:143], v[96:111]
    v_mfma_f32_32x32x16_bf16 v[112:127], v[132:135], v[140:143], v[112:127]
    s_waitcnt lgkmcnt(0)
    s_waitcnt vmcnt(6)
    s_barrier
    v_mfma_f32_32x32x16_bf16 v[64:79], v[148:151], v[156:159], v[64:79]
    ds_read_b128 v[136:139], v180 offset:0
    ds_read_b64_tr_b16 v[128:129], v184 offset:0
    ds_read_b64_tr_b16 v[130:131], v184 offset:2048
    s_add_u32 m0, s35, 32768
    s_nop 0
    buffer_load_dwordx4 v200, s[8:11], s30 offen lds
    v_mfma_f32_32x32x16_bf16 v[80:95], v[152:155], v[156:159], v[80:95]
    ds_read_b64_tr_b16 v[132:133], v185 offset:0
    ds_read_b64_tr_b16 v[134:135], v185 offset:2048
    v_mfma_f32_32x32x16_bf16 v[96:111], v[148:151], v[160:163], v[96:111]
    ds_read_b128 v[140:143], v180 offset:4096
    s_add_u32 m0, s35, 33792
    s_nop 0
    buffer_load_dwordx4 v201, s[8:11], s30 offen lds
    s_add_u32 s5, s5, 1
    s_cmp_eq_u32 s5, 10
    s_cselect_b32 s5, 0, s5
    s_lshl_b32 s30, s5, 7
    v_mfma_f32_32x32x16_bf16 v[112:127], v[152:155], v[160:163], v[112:127]
    s_waitcnt lgkmcnt(3)
    v_mfma_f32_32x32x16_bf16 v[64:79], v[128:131], v[136:139], v[64:79]
    ds_read_b128 v[156:159], v181 offset:0
    ds_read_b64_tr_b16 v[148:149], v184 offset:8192
    ds_read_b64_tr_b16 v[150:151], v184 offset:10240
    s_add_u32 m0, s36, 65536
    s_nop 0
    buffer_load_dwordx4 v202, s[12:15], s31 offen lds
    s_waitcnt lgkmcnt(4)
    v_mfma_f32_32x32x16_bf16 v[80:95], v[132:135], v[136:139], v[80:95]
    ds_read_b64_tr_b16 v[152:153], v185 offset:8192
    ds_read_b64_tr_b16 v[154:155], v185 offset:10240
    s_waitcnt lgkmcnt(5)
    v_mfma_f32_32x32x16_bf16 v[96:111], v[128:131], v[140:143], v[96:111]
    ds_read_b128 v[160:163], v181 offset:4096
    s_add_u32 m0, s36, 66560
    s_nop 0
    buffer_load_dwordx4 v203, s[12:15], s32 offen lds
    v_mfma_f32_32x32x16_bf16 v[112:127], v[132:135], v[140:143], v[112:127]
    s_waitcnt lgkmcnt(3)
    v_mfma_f32_32x32x16_bf16 v[64:79], v[148:151], v[156:159], v[64:79]
    ds_read_b128 v[136:139], v182 offset:0
    ds_read_b64_tr_b16 v[128:129], v184 offset:16384
    ds_read_b64_tr_b16 v[130:131], v184 offset:18432
    s_add_u32 m0, s36, 67584
    s_nop 0
    buffer_load_dwordx4 v202, s[12:15], s33 offen lds
    s_waitcnt lgkmcnt(4)
    v_mfma_f32_32x32x16_bf16 v[80:95], v[152:155], v[156:159], v[80:95]
    ds_read_b64_tr_b16 v[132:133], v185 offset:16384
    ds_read_b64_tr_b16 v[134:135], v185 offset:18432
    s_waitcnt lgkmcnt(5)
    v_mfma_f32_32x32x16_bf16 v[96:111], v[148:151], v[160:163], v[96:111]
    ds_read_b128 v[140:143], v182 offset:4096
    v_mfma_f32_32x32x16_bf16 v[112:127], v[152:155], v[160:163], v[112:127]
    s_waitcnt lgkmcnt(3)
    v_mfma_f32_32x32x16_bf16 v[64:79], v[128:131], v[136:139], v[64:79]
    ds_read_b128 v[156:159], v183 offset:0
    ds_read_b64_tr_b16 v[148:149], v184 offset:24576
    ds_read_b64_tr_b16 v[150:151], v184 offset:26624
    ds_read_b64_tr_b16 v[152:153], v185 offset:24576
    ds_read_b64_tr_b16 v[154:155], v185 offset:26624
    ds_read_b128 v[160:163], v183 offset:4096
    s_add_u32 m0, s36, 68608
    s_nop 0
    buffer_load_dwordx4 v203, s[12:15], s34 offen lds
    s_mul_i32 s31, s5, 221184
    s_add_u32 s32, s31, 6912
    s_add_u32 s33, s31, 13824
    s_add_u32 s34, s31, 20736
    s_waitcnt lgkmcnt(7)
    v_mfma_f32_32x32x16_bf16 v[80:95], v[132:135], v[136:139], v[80:95]
    s_waitcnt lgkmcnt(6)
    v_mfma_f32_32x32x16_bf16 v[96:111], v[128:131], v[140:143], v[96:111]
    v_mfma_f32_32x32x16_bf16 v[112:127], v[132:135], v[140:143], v[112:127]
    s_waitcnt lgkmcnt(0)
    s_waitcnt vmcnt(6)
    s_barrier
    v_mfma_f32_32x32x16_bf16 v[64:79], v[148:151], v[156:159], v[64:79]
    ds_read_b128 v[136:139], v180 offset:16384
    ds_read_b64_tr_b16 v[128:129], v184 offset:32768
    ds_read_b64_tr_b16 v[130:131], v184 offset:34816
    s_add_u32 m0, s35, 0
    s_nop 0
    buffer_load_dwordx4 v200, s[8:11], s30 offen lds
    v_mfma_f32_32x32x16_bf16 v[80:95], v[152:155], v[156:159], v[80:95]
    ds_read_b64_tr_b16 v[132:133], v185 offset:32768
    ds_read_b64_tr_b16 v[134:135], v185 offset:34816
    v_mfma_f32_32x32x16_bf16 v[96:111], v[148:151], v[160:163], v[96:111]
    ds_read_b128 v[140:143], v180 offset:20480
    s_add_u32 m0, s35, 1024
    s_nop 0
    buffer_load_dwordx4 v201, s[8:11], s30 offen lds
    s_add_u32 s5, s5, 1
    s_cmp_eq_u32 s5, 10
    s_cselect_b32 s5, 0, s5
    s_lshl_b32 s30, s5, 7
    v_mfma_f32_32x32x16_bf16 v[112:127], v[152:155], v[160:163], v[112:127]
    s_waitcnt lgkmcnt(3)
    v_mfma_f32_32x32x16_bf16 v[64:79], v[128:131], v[136:139], v[64:79]
    ds_read_b128 v[156:159], v181 offset:16384
    ds_read_b64_tr_b16 v[148:149], v184 offset:40960
    ds_read_b64_tr_b16 v[150:151], v184 offset:43008
    s_add_u32 m0, s36, 0
    s_nop 0
    buffer_load_dwordx4 v202, s[12:15], s31 offen lds
    s_waitcnt lgkmcnt(4)
    v_mfma_f32_32x32x16_bf16 v[80:95], v[132:135], v[136:139], v[80:95]
    ds_read_b64_tr_b16 v[152:153], v185 offset:40960
    ds_read_b64_tr_b16 v[154:155], v185 offset:43008
    s_waitcnt lgkmcnt(5)
    v_mfma_f32_32x32x16_bf16 v[96:111], v[128:131], v[140:143], v[96:111]
    ds_read_b128 v[160:163], v181 offset:20480
    s_add_u32 m0, s36, 1024
    s_nop 0
    buffer_load_dwordx4 v203, s[12:15], s32 offen lds
    v_mfma_f32_32x32x16_bf16 v[112:127], v[132:135], v[140:143], v[112:127]
    s_waitcnt lgkmcnt(3)
    v_mfma_f32_32x32x16_bf16 v[64:79], v[148:151], v[156:159], v[64:79]
    ds_read_b128 v[136:139], v182 offset:16384
    ds_read_b64_tr_b16 v[128:129], v184 offset:49152
    ds_read_b64_tr_b16 v[130:131], v184 offset:51200
    s_add_u32 m0, s36, 2048
    s_nop 0
    buffer_load_dwordx4 v202, s[12:15], s33 offen lds
    s_waitcnt lgkmcnt(4)
    v_mfma_f32_32x32x16_bf16 v[80:95], v[152:155], v[156:159], v[80:95]
    ds_read_b64_tr_b16 v[132:133], v185 offset:49152
    ds_read_b64_tr_b16 v[134:135], v185 offset:51200
    s_waitcnt lgkmcnt(5)
    v_mfma_f32_32x32x16_bf16 v[96:111], v[148:151], v[160:163], v[96:111]
    ds_read_b128 v[140:143], v182 offset:20480
    v_mfma_f32_32x32x16_bf16 v[112:127], v[152:155], v[160:163], v[112:127]
    s_waitcnt lgkmcnt(3)
    v_mfma_f32_32x32x16_bf16 v[64:79], v[128:131], v[136:139], v[64:79]
    ds_read_b128 v[156:159], v183 offset:16384
    ds_read_b64_tr_b16 v[148:149], v184 offset:57344
    ds_read_b64_tr_b16 v[150:151], v184 offset:59392
    ds_read_b64_tr_b16 v[152:153], v185 offset:57344
    ds_read_b64_tr_b16 v[154:155], v185 offset:59392
    ds_read_b128 v[160:163], v183 offset:20480
    s_add_u32 m0, s36, 3072
    s_nop 0
    buffer_load_dwordx4 v203, s[12:15], s34 offen lds
    s_mul_i32 s31, s5, 221184
    s_add_u32 s32, s31, 6912
    s_add_u32 s33, s31, 13824
    s_add_u32 s34, s31, 20736
    s_waitcnt lgkmcnt(7)
    v_mfma_f32_32x32x16_bf16 v[80:95], v[132:135], v[136:139], v[80:95]
    s_waitcnt lgkmcnt(6)
    v_mfma_f32_32x32x16_bf16 v[96:111], v[128:131], v[140:143], v[96:111]
    v_mfma_f32_32x32x16_bf16 v[112:127], v[132:135], v[140:143], v[112:127]
    s_waitcnt lgkmcnt(0)
    s_waitcnt vmcnt(6)
    s_barrier
    global_load_dword v213, v212, s[62:63] sc1
    v_mfma_f32_32x32x16_bf16 v[64:79], v[148:151], v[156:159], v[64:79]
    ds_read_b128 v[136:139], v180 offset:32768
    ds_read_b64_tr_b16 v[128:129], v188 offset:0
    ds_read_b64_tr_b16 v[130:131], v188 offset:2048
    v_mfma_f32_32x32x16_bf16 v[80:95], v[152:155], v[156:159], v[80:95]
    ds_read_b64_tr_b16 v[132:133], v189 offset:0
    ds_read_b64_tr_b16 v[134:135], v189 offset:2048
    v_mfma_f32_32x32x16_bf16 v[96:111], v[148:151], v[160:163], v[96:111]
    ds_read_b128 v[140:143], v180 offset:36864
    v_mfma_f32_32x32x16_bf16 v[112:127], v[152:155], v[160:163], v[112:127]
    s_waitcnt lgkmcnt(3)
    v_mfma_f32_32x32x16_bf16 v[64:79], v[128:131], v[136:139], v[64:79]
    ds_read_b128 v[156:159], v181 offset:32768
    ds_read_b64_tr_b16 v[148:149], v188 offset:8192
    ds_read_b64_tr_b16 v[150:151], v188 offset:10240
    s_waitcnt lgkmcnt(4)
    v_mfma_f32_32x32x16_bf16 v[80:95], v[132:135], v[136:139], v[80:95]
    ds_read_b64_tr_b16 v[152:153], v189 offset:8192
    ds_read_b64_tr_b16 v[154:155], v189 offset:10240
    s_waitcnt lgkmcnt(5)
    v_mfma_f32_32x32x16_bf16 v[96:111], v[128:131], v[140:143], v[96:111]
    ds_read_b128 v[160:163], v181 offset:36864
    v_mfma_f32_32x32x16_bf16 v[112:127], v[132:135], v[140:143], v[112:127]
    s_waitcnt lgkmcnt(3)
    v_mfma_f32_32x32x16_bf16 v[64:79], v[148:151], v[156:159], v[64:79]
    ds_read_b128 v[136:139], v182 offset:32768
    ds_read_b64_tr_b16 v[128:129], v188 offset:16384
    ds_read_b64_tr_b16 v[130:131], v188 offset:18432
    s_waitcnt lgkmcnt(4)
    v_mfma_f32_32x32x16_bf16 v[80:95], v[152:155], v[156:159], v[80:95]
    ds_read_b64_tr_b16 v[132:133], v189 offset:16384
    ds_read_b64_tr_b16 v[134:135], v189 offset:18432
    s_waitcnt lgkmcnt(5)
    v_mfma_f32_32x32x16_bf16 v[96:111], v[148:151], v[160:163], v[96:111]
    ds_read_b128 v[140:143], v182 offset:36864
    v_mfma_f32_32x32x16_bf16 v[112:127], v[152:155], v[160:163], v[112:127]
    s_waitcnt lgkmcnt(3)
    v_mfma_f32_32x32x16_bf16 v[64:79], v[128:131], v[136:139], v[64:79]
    ds_read_b128 v[156:159], v183 offset:32768
    ds_read_b64_tr_b16 v[148:149], v188 offset:24576
    ds_read_b64_tr_b16 v[150:151], v188 offset:26624
    ds_read_b64_tr_b16 v[152:153], v189 offset:24576
    ds_read_b64_tr_b16 v[154:155], v189 offset:26624
    ds_read_b128 v[160:163], v183 offset:36864
    s_waitcnt lgkmcnt(7)
    v_mfma_f32_32x32x16_bf16 v[80:95], v[132:135], v[136:139], v[80:95]
    s_waitcnt lgkmcnt(6)
    v_mfma_f32_32x32x16_bf16 v[96:111], v[128:131], v[140:143], v[96:111]
    v_mfma_f32_32x32x16_bf16 v[112:127], v[132:135], v[140:143], v[112:127]
    s_waitcnt lgkmcnt(0)
    s_waitcnt vmcnt(0)
    s_cmp_lg_u32 s24, 0
    s_cbranch_scc1 KF_FSKIP_F
KF_P_FF:
    v_cmp_eq_u32 vcc, s4, v213
    s_nop 0
    s_and_b32 s37, vcc_lo, 0xffffff
    s_cmp_eq_u32 s37, 0xffffff
    s_cbranch_scc1 KF_POK_FF
    s_sleep 16
    global_load_dword v213, v212, s[62:63] sc1
    s_waitcnt vmcnt(0)
    s_branch KF_P_FF
KF_POK_FF:
KF_FSKIP_F:
    s_barrier
    s_lshl_b32 s37, s27, 7
    s_lshl_b32 s38, s25, 6
    s_add_u32 s37, s37, s38
    v_add_u32 v7, s37, v6
    v_lshlrev_b32_e64 v7, 3, v7
    global_load_dwordx2 v[14:15], v7, s[62:63] sc1
    global_load_dwordx2 v[12:13], v7, s[62:63] offset:256 sc1
    s_cmp_lg_u32 s24, 7
    s_cbranch_scc1 KF_NOCSL_F
    v_lshlrev_b32 v7, 4, v1
    s_lshl_b32 s37, s29, 14
    s_add_u32 s37, s37, 23068672
    buffer_load_dwordx4 v[216:219], v7, s[20:23], s37 offen sc1
    s_add_u32 s37, s37, 1024
    buffer_load_dwordx4 v[220:223], v7, s[20:23], s37 offen sc1
    s_add_u32 s37, s37, 1024
    buffer_load_dwordx4 v[224:227], v7, s[20:23], s37 offen sc1
    s_add_u32 s37, s37, 1024
    buffer_load_dwordx4 v[228:231], v7, s[20:23], s37 offen sc1
    s_add_u32 s37, s37, 1024
    buffer_load_dwordx4 v[232:235], v7, s[20:23], s37 offen sc1
    s_add_u32 s37, s37, 1024
    buffer_load_dwordx4 v[236:239], v7, s[20:23], s37 offen sc1
    s_add_u32 s37, s37, 1024
    buffer_load_dwordx4 v[240:243], v7, s[20:23], s37 offen sc1
    s_add_u32 s37, s37, 1024
    buffer_load_dwordx4 v[244:247], v7, s[20:23], s37 offen sc1
    s_add_u32 s37, s37, 1024
    buffer_load_dwordx4 v[248:251], v7, s[20:23], s37 offen sc1
    s_add_u32 s37, s37, 1024
    buffer_load_dwordx4 v[252:255], v7, s[20:23], s37 offen sc1
    s_add_u32 s37, s37, 1024
    buffer_load_dwordx4 v[40:43], v7, s[20:23], s37 offen sc1
    s_add_u32 s37, s37, 1024
    buffer_load_dwordx4 v[44:47], v7, s[20:23], s37 offen sc1
    s_add_u32 s37, s37, 1024
    buffer_load_dwordx4 v[48:51], v7, s[20:23], s37 offen sc1
    s_add_u32 s37, s37, 1024
    buffer_load_dwordx4 v[52:55], v7, s[20:23], s37 offen sc1
    s_add_u32 s37, s37, 1024
    buffer_load_dwordx4 v[56:59], v7, s[20:23], s37 offen sc1
    s_add_u32 s37, s37, 1024
    buffer_load_dwordx4 v[60:63], v7, s[20:23], s37 offen sc1
KF_NOCSL_F:
    v_mfma_f32_32x32x16_bf16 v[64:79], v[148:151], v[156:159], v[64:79]
    ds_read_b128 v[136:139], v180 offset:0
    ds_read_b64_tr_b16 v[128:129], v184 offset:0
    ds_read_b64_tr_b16 v[130:131], v184 offset:2048
    v_lshrrev_b32 v7, 2, v6
    v_and_b32 v8, 3, v6
    v_lshrrev_b32_e64 v9, 2, v7
    v_mfma_f32_32x32x16_bf16 v[80:95], v[152:155], v[156:159], v[80:95]
    ds_read_b64_tr_b16 v[132:133], v185 offset:0
    ds_read_b64_tr_b16 v[134:135], v185 offset:2048
    v_and_b32_e64 v10, 1, v7
    v_lshl_add_u32 v9, v9, 1, v10
    v_bfe_u32 v10, v7, 1, 1
    v_mfma_f32_32x32x16_bf16 v[96:111], v[148:151], v[160:163], v[96:111]
    ds_read_b128 v[140:143], v180 offset:4096
    v_lshl_add_u32 v9, v9, 1, v10
    s_lshl_b32 s37, s26, 4
    v_add_u32 v9, s37, v9
    v_mfma_f32_32x32x16_bf16 v[112:127], v[152:155], v[160:163], v[112:127]
    v_lshl_add_u32 v9, v9, 2, v8
    v_lshlrev_b32_e64 v9, 2, v9
    v_add_u32 v208, 151552, v9
    s_waitcnt lgkmcnt(3)
    v_mfma_f32_32x32x16_bf16 v[64:79], v[128:131], v[136:139], v[64:79]
    ds_read_b128 v[156:159], v181 offset:0
    ds_read_b64_tr_b16 v[148:149], v184 offset:8192
    ds_read_b64_tr_b16 v[150:151], v184 offset:10240
    s_waitcnt lgkmcnt(4)
    v_mfma_f32_32x32x16_bf16 v[80:95], v[132:135], v[136:139], v[80:95]
    ds_read_b64_tr_b16 v[152:153], v185 offset:8192
    ds_read_b64_tr_b16 v[154:155], v185 offset:10240
    s_waitcnt lgkmcnt(5)
    v_mfma_f32_32x32x16_bf16 v[96:111], v[128:131], v[140:143], v[96:111]
    ds_read_b128 v[160:163], v181 offset:4096
    v_mfma_f32_32x32x16_bf16 v[112:127], v[132:135], v[140:143], v[112:127]
    s_waitcnt lgkmcnt(3)
    v_mfma_f32_32x32x16_bf16 v[64:79], v[148:151], v[156:159], v[64:79]
    ds_read_b128 v[136:139], v182 offset:0
    ds_read_b64_tr_b16 v[128:129], v184 offset:16384
    ds_read_b64_tr_b16 v[130:131], v184 offset:18432
    s_waitcnt lgkmcnt(4)
    v_mfma_f32_32x32x16_bf16 v[80:95], v[152:155], v[156:159], v[80:95]
    ds_read_b64_tr_b16 v[132:133], v185 offset:16384
    ds_read_b64_tr_b16 v[134:135], v185 offset:18432
    s_waitcnt lgkmcnt(5)
    v_mfma_f32_32x32x16_bf16 v[96:111], v[148:151], v[160:163], v[96:111]
    ds_read_b128 v[140:143], v182 offset:4096
    v_mfma_f32_32x32x16_bf16 v[112:127], v[152:155], v[160:163], v[112:127]
    s_waitcnt lgkmcnt(3)
    v_mfma_f32_32x32x16_bf16 v[64:79], v[128:131], v[136:139], v[64:79]
    ds_read_b128 v[156:159], v183 offset:0
    ds_read_b64_tr_b16 v[148:149], v184 offset:24576
    ds_read_b64_tr_b16 v[150:151], v184 offset:26624
    s_waitcnt lgkmcnt(4)
    v_mfma_f32_32x32x16_bf16 v[80:95], v[132:135], v[136:139], v[80:95]
    ds_read_b64_tr_b16 v[152:153], v185 offset:24576
    ds_read_b64_tr_b16 v[154:155], v185 offset:26624
    s_waitcnt lgkmcnt(5)
    v_mfma_f32_32x32x16_bf16 v[96:111], v[128:131], v[140:143], v[96:111]
    ds_read_b128 v[160:163], v183 offset:4096
    v_mfma_f32_32x32x16_bf16 v[112:127], v[132:135], v[140:143], v[112:127]
    s_waitcnt lgkmcnt(3)
    v_mfma_f32_32x32x16_bf16 v[64:79], v[148:151], v[156:159], v[64:79]
    s_waitcnt lgkmcnt(1)
    v_mfma_f32_32x32x16_bf16 v[80:95], v[152:155], v[156:159], v[80:95]
    s_cmp_lg_u32 s24, 7
    s_cbranch_scc1 KF_NOCSA_F
    s_waitcnt vmcnt(0)
    v_add_f32 v216, v216, v220
    v_add_f32 v217, v217, v221
    v_add_f32 v218, v218, v222
    v_add_f32 v219, v219, v223
    v_add_f32 v216, v216, v224
    v_add_f32 v217, v217, v225
    v_add_f32 v218, v218, v226
    v_add_f32 v219, v219, v227
    v_add_f32 v216, v216, v228
    v_add_f32 v217, v217, v229
    v_add_f32 v218, v218, v230
    v_add_f32 v219, v219, v231
    v_add_f32 v216, v216, v232
    v_add_f32 v217, v217, v233
    v_add_f32 v218, v218, v234
    v_add_f32 v219, v219, v235
    v_add_f32 v216, v216, v236
    v_add_f32 v217, v217, v237
    v_add_f32 v218, v218, v238
    v_add_f32 v219, v219, v239
    v_add_f32 v216, v216, v240
    v_add_f32 v217, v217, v241
    v_add_f32 v218, v218, v242
    v_add_f32 v219, v219, v243
    v_add_f32 v216, v216, v244
    v_add_f32 v217, v217, v245
    v_add_f32 v218, v218, v246
    v_add_f32 v219, v219, v247
    v_add_f32 v216, v216, v248
    v_add_f32 v217, v217, v249
    v_add_f32 v218, v218, v250
    v_add_f32 v219, v219, v251
    v_add_f32 v216, v216, v252
    v_add_f32 v217, v217, v253
    v_add_f32 v218, v218, v254
    v_add_f32 v219, v219, v255
    v_add_f32 v216, v216, v40
    v_add_f32 v217, v217, v41
    v_add_f32 v218, v218, v42
    v_add_f32 v219, v219, v43
    v_add_f32 v216, v216, v44
    v_add_f32 v217, v217, v45
    v_add_f32 v218, v218, v46
    v_add_f32 v219, v219, v47
    v_add_f32 v216, v216, v48
    v_add_f32 v217, v217, v49
    v_add_f32 v218, v218, v50
    v_add_f32 v219, v219, v51
    v_add_f32 v216, v216, v52
    v_add_f32 v217, v217, v53
    v_add_f32 v218, v218, v54
    v_add_f32 v219, v219, v55
    v_add_f32 v216, v216, v56
    v_add_f32 v217, v217, v57
    v_add_f32 v218, v218, v58
    v_add_f32 v219, v219, v59
    v_add_f32 v216, v216, v60
    v_add_f32 v217, v217, v61
    v_add_f32 v218, v218, v62
    v_add_f32 v219, v219, v63
KF_NOCSA_F:
    s_waitcnt lgkmcnt(0)
    v_mfma_f32_32x32x16_bf16 v[96:111], v[148:151], v[160:163], v[96:111]
    v_mfma_f32_32x32x16_bf16 v[112:127], v[152:155], v[160:163], v[112:127]
    s_waitcnt vmcnt(0)
    s_cmp_lg_u32 s24, 7
    s_cbranch_scc1 KF_NOCSS_F
    v_lshlrev_b32_e64 v7, 4, v1
    v_add_u32 v7, 151552, v7
    ds_write_b128 v7, v[216:219]
    s_waitcnt lgkmcnt(0)
KF_NOCSS_F:
    s_barrier
    ds_read_b32 v204, v208 offset:0
    ds_read_b32 v205, v208 offset:128
    s_waitcnt lgkmcnt(0)
    v_cmp_gt_u32 vcc, 32, v1
    v_mov_b32 v210, 0
    v_sub_f32 v7, 0, v14
    v_cvt_pk_bf16_f32 v8, v7, v7
    v_lshlrev_b32 v9, 16, v8
    v_sub_f32 v9, v7, v9
    v_cvt_pk_bf16_f32 v232, v7, v9
    v_and_b32 v233, 0xffff, v8
    v_mov_b32 v234, 0
    v_mov_b32 v235, 0
    v_sub_f32_e64 v7, 0, v12
    v_cvt_pk_bf16_f32 v8, v7, v7
    v_lshlrev_b32 v9, 16, v8
    v_sub_f32 v9, v7, v9
    v_cvt_pk_bf16_f32 v236, v7, v9
    v_and_b32 v237, 0xffff, v8
    v_mov_b32 v238, 0
    v_mov_b32 v239, 0
    v_cndmask_b32 v204, 0, v204, vcc
    s_nop 0
    v_cvt_pk_bf16_f32 v216, v204, v204
    v_lshlrev_b32 v211, 16, v216
    v_sub_f32 v211, v204, v211
    v_cvt_pk_bf16_f32 v217, v211, v210
    v_mov_b32 v218, 0
    v_mov_b32 v219, 0
    v_cndmask_b32 v205, 0, v205, vcc
    s_nop 0
    v_cvt_pk_bf16_f32 v220, v205, v205
    v_lshlrev_b32 v211, 16, v220
    v_sub_f32 v211, v205, v211
    v_cvt_pk_bf16_f32 v221, v211, v210
    v_mov_b32 v222, 0
    v_mov_b32 v223, 0
    v_mfma_f32_32x32x16_bf16 v[64:79], v[216:219], v[232:235], v[64:79]
    s_nop 0
    s_nop 0
    v_mfma_f32_32x32x16_bf16 v[80:95], v[220:223], v[232:235], v[80:95]
    v_mfma_f32_32x32x16_bf16 v[96:111], v[216:219], v[236:239], v[96:111]
    v_mfma_f32_32x32x16_bf16 v[112:127], v[220:223], v[236:239], v[112:127]
    v_and_b32 v9, 15, v6
    v_lshlrev_b32 v9, 4, v9
    v_lshl_add_u32 v9, v2, 8, v9
    v_lshrrev_b32_e64 v10, 4, v6
    v_lshl_add_u32 v9, v10, 10, v9
    s_lshl_b32 s37, s27, 1
    s_add_u32 s37, s37, s25
    s_mul_i32 s37, s37, 303104
    s_add_u32 s37, s37, 1048576
    s_lshl_b32 s38, s28, 3
    s_lshl_b32 s39, s26, 1
    s_add_u32 s75, s38, s39
    s_lshl_b32 s39, s75, 12
    s_add_u32 s74, s37, s39
    v_mul_f32 v64, v64, v15
    v_mul_f32 v65, v65, v15
    v_mul_f32 v66, v66, v15
    v_mul_f32_e64 v67, v67, v15
    v_cvt_pk_bf16_f32 v128, v64, v65
    v_mul_f32 v68, v68, v15
    v_mul_f32 v69, v69, v15
    v_cvt_pk_bf16_f32 v129, v66, v67
    v_mul_f32 v70, v70, v15
    v_mul_f32 v71, v71, v15
    v_cvt_pk_bf16_f32 v130, v68, v69
    v_mul_f32 v72, v72, v15
    v_mul_f32 v73, v73, v15
    v_cvt_pk_bf16_f32 v131, v70, v71
    v_mul_f32 v74, v74, v15
    v_mul_f32 v75, v75, v15
    v_cvt_pk_bf16_f32 v132, v72, v73
    v_mul_f32 v76, v76, v15
    v_mul_f32 v77, v77, v15
    v_cvt_pk_bf16_f32 v133, v74, v75
    v_mul_f32 v78, v78, v15
    v_mul_f32 v79, v79, v15
    v_cvt_pk_bf16_f32 v134, v76, v77
    v_cvt_pk_bf16_f32 v135, v78, v79
    v_pk_max_i16 v128, v128, 0
    v_pk_max_i16 v129, v129, 0
    v_pk_max_i16 v130, v130, 0
    v_pk_max_i16 v131, v131, 0
    v_pk_max_i16 v132, v132, 0
    v_pk_max_i16 v133, v133, 0
    v_pk_max_i16 v134, v134, 0
    v_pk_max_i16 v135, v135, 0
    s_add_u32 s39, s75, 0
    s_cmp_ge_u32 s39, 54
    s_cbranch_scc1 KF_FSK0
    s_add_u32 s39, s74, 0
    buffer_store_dwordx4 v[128:131], v9, s[20:23], s39 offen sc1
    buffer_store_dwordx4 v[132:135], v9, s[20:23], s39 offen offset:512 sc1
KF_FSK0:
    v_mul_f32 v96, v96, v13
    v_mul_f32 v97, v97, v13
    v_mul_f32 v98, v98, v13
    v_mul_f32 v99, v99, v13
    v_cvt_pk_bf16_f32 v144, v96, v97
    v_mul_f32 v100, v100, v13
    v_mul_f32 v101, v101, v13
    v_cvt_pk_bf16_f32 v145, v98, v99
    v_mul_f32 v102, v102, v13
    v_mul_f32 v103, v103, v13
    v_cvt_pk_bf16_f32 v146, v100, v101
    v_mul_f32 v104, v104, v13
    v_mul_f32 v105, v105, v13
    v_cvt_pk_bf16_f32 v147, v102, v103
    v_mul_f32 v106, v106, v13
    v_mul_f32 v107, v107, v13
    v_cvt_pk_bf16_f32 v148, v104, v105
    v_mul_f32 v108, v108, v13
    v_mul_f32 v109, v109, v13
    v_cvt_pk_bf16_f32 v149, v106, v107
    v_mul_f32 v110, v110, v13
    v_mul_f32 v111, v111, v13
    v_cvt_pk_bf16_f32 v150, v108, v109
    v_cvt_pk_bf16_f32 v151, v110, v111
    v_pk_max_i16 v144, v144, 0
    v_pk_max_i16 v145, v145, 0
    v_pk_max_i16 v146, v146, 0
    v_pk_max_i16 v147, v147, 0
    v_pk_max_i16 v148, v148, 0
    v_pk_max_i16 v149, v149, 0
    v_pk_max_i16 v150, v150, 0
    v_pk_max_i16 v151, v151, 0
    s_add_u32 s39, s75, 0
    s_cmp_ge_u32 s39, 54
    s_cbranch_scc1 KF_FSK2
    s_nop 0
    s_add_u32 s39, s74, 2048
    buffer_store_dwordx4 v[144:147], v9, s[20:23], s39 offen sc1
    buffer_store_dwordx4 v[148:151], v9, s[20:23], s39 offen offset:512 sc1
KF_FSK2:
    v_mul_f32 v80, v80, v15
    v_mul_f32 v81, v81, v15
    v_mul_f32 v82, v82, v15
    v_mul_f32 v83, v83, v15
    v_cvt_pk_bf16_f32 v136, v80, v81
    v_mul_f32 v84, v84, v15
    v_mul_f32 v85, v85, v15
    v_cvt_pk_bf16_f32 v137, v82, v83
    v_mul_f32 v86, v86, v15
    v_mul_f32 v87, v87, v15
    v_cvt_pk_bf16_f32 v138, v84, v85
    v_mul_f32 v88, v88, v15
    v_mul_f32 v89, v89, v15
    v_cvt_pk_bf16_f32 v139, v86, v87
    v_mul_f32 v90, v90, v15
    v_mul_f32 v91, v91, v15
    v_cvt_pk_bf16_f32 v140, v88, v89
    v_mul_f32 v92, v92, v15
    v_mul_f32 v93, v93, v15
    v_cvt_pk_bf16_f32 v141, v90, v91
    v_mul_f32 v94, v94, v15
    v_mul_f32 v95, v95, v15
    v_cvt_pk_bf16_f32 v142, v92, v93
    v_cvt_pk_bf16_f32 v143, v94, v95
    v_pk_max_i16 v136, v136, 0
    v_pk_max_i16 v137, v137, 0
    v_pk_max_i16 v138, v138, 0
    v_pk_max_i16 v139, v139, 0
    v_pk_max_i16 v140, v140, 0
    v_pk_max_i16 v141, v141, 0
    v_pk_max_i16 v142, v142, 0
    v_pk_max_i16 v143, v143, 0
    s_add_u32 s39, s75, 1
    s_cmp_ge_u32 s39, 54
    s_cbranch_scc1 KF_FSK1
    s_nop 0
    s_add_u32 s39, s74, 4096
    buffer_store_dwordx4 v[136:139], v9, s[20:23], s39 offen sc1
    buffer_store_dwordx4 v[140:143], v9, s[20:23], s39 offen offset:512 sc1
KF_FSK1:
    v_mul_f32 v112, v112, v13
    v_mul_f32 v113, v113, v13
    v_mul_f32 v114, v114, v13
    v_mul_f32 v115, v115, v13
    v_cvt_pk_bf16_f32 v152, v112, v113
    v_mul_f32 v116, v116, v13
    v_mul_f32 v117, v117, v13
    v_cvt_pk_bf16_f32 v153, v114, v115
    v_mul_f32 v118, v118, v13
    v_mul_f32 v119, v119, v13
    v_cvt_pk_bf16_f32 v154, v116, v117
    v_mul_f32 v120, v120, v13
    v_mul_f32 v121, v121, v13
    v_cvt_pk_bf16_f32 v155, v118, v119
    v_mul_f32 v122, v122, v13
    v_mul_f32 v123, v123, v13
    v_cvt_pk_bf16_f32 v156, v120, v121
    v_mul_f32 v124, v124, v13
    v_mul_f32 v125, v125, v13
    v_cvt_pk_bf16_f32 v157, v122, v123
    v_mul_f32 v126, v126, v13
    v_mul_f32 v127, v127, v13
    v_cvt_pk_bf16_f32 v158, v124, v125
    v_cvt_pk_bf16_f32 v159, v126, v127
    v_pk_max_i16 v152, v152, 0
    v_pk_max_i16 v153, v153, 0
    v_pk_max_i16 v154, v154, 0
    v_pk_max_i16 v155, v155, 0
    v_pk_max_i16 v156, v156, 0
    v_pk_max_i16 v157, v157, 0
    v_pk_max_i16 v158, v158, 0
    v_pk_max_i16 v159, v159, 0
    s_add_u32 s39, s75, 1
    s_cmp_ge_u32 s39, 54
    s_cbranch_scc1 KF_FSK3
    s_nop 0
    s_add_u32 s39, s74, 6144
    buffer_store_dwordx4 v[152:155], v9, s[20:23], s39 offen sc1
    buffer_store_dwordx4 v[156:159], v9, s[20:23], s39 offen offset:512 sc1
KF_FSK3:
    s_and_b32 s25, s24, 3
    s_lshr_b32 s26, s24, 2
    s_waitcnt vmcnt(0)
    s_nop 0
    v_mov_b32 v8, 159744
    v_mov_b32 v9, 1
    s_mov_b64 exec, 1
    ds_add_rtn_u32 v9, v8, v9 offset:16
    s_waitcnt lgkmcnt(0)
    s_mov_b64 exec, -1
    v_readfirstlane_b32 s37, v9
    s_nop 0
    s_cmp_eq_u32 s37, 7
    s_cbranch_scc0 KF_ARR_F
    s_lshl_b32 s37, s27, 7
    s_lshl_b32 s38, s28, 2
    s_add_u32 s37, s37, s38
    s_nop 0
    s_add_u32 s37, s37, 23333888
    v_mov_b32 v8, s37
    v_mov_b32 v9, s4
    s_mov_b64 exec, 1
    s_nop 0
    global_store_dword v8, v9, s[62:63] sc1
    s_mov_b64 exec, -1
KF_ARR_F:
    s_cmp_lt_u32 s24, 4
    s_cbranch_scc1 KF_FFN_Y
    s_branch KF_X
KF_FFN_Y:
    s_lshr_b32 s37, s42, 1
    s_lshl_b32 s37, s37, 7
    s_add_u32 s37, s37, 23333888
    s_mov_b32 s38, 23337984
    v_mov_b32 v16, s37
    v_subrev_u32 v7, 0, v1
    v_cmp_gt_u32 vcc, 7, v7
    v_lshlrev_b32 v7, 2, v7
    v_add_u32 v7, s37, v7
    v_cndmask_b32 v16, v16, v7, vcc
    v_subrev_u32 v7, 8, v1
    v_cmp_gt_u32 vcc, 16, v7
    v_lshlrev_b32 v7, 2, v7
    v_add_u32 v7, s38, v7
    v_cndmask_b32 v16, v16, v7, vcc
    s_nop 0
    global_load_dword v17, v16, s[62:63] sc1
    s_waitcnt vmcnt(0)
    s_cmp_lg_u32 s25, 0
    s_cbranch_scc1 KF_GN_GF
KF_P_GF:
    v_cmp_eq_u32 vcc, s4, v17
    s_nop 0
    s_nop 0
    s_and_b32 s37, vcc_lo, 0xffff03
    s_cmp_eq_u32 s37, 0xffff03
    s_cbranch_scc1 KF_POK_GF
    s_sleep 1
    global_load_dword v17, v16, s[62:63] sc1
    s_waitcnt vmcnt(0)
    s_branch KF_P_GF
KF_POK_GF:
    v_mov_b32 v10, 159744
    v_mov_b32_e64 v11, 1
    ds_write_b32 v10, v11 offset:20
    s_branch KF_GD_GF
KF_GN_GF:
    v_cmp_eq_u32 vcc, s4, v17
    s_nop 0
    s_nop 0
    s_and_b32 s37, vcc_lo, 0xffff03
    s_cmp_eq_u32 s37, 0xffff03
    s_cbranch_scc1 KF_GD_GF
    s_nop 0
    v_mov_b32 v10, 159744
KF_GL_GF_W:
    ds_read_b32 v11, v10 offset:20
    s_waitcnt lgkmcnt(0)
    v_readfirstlane_b32 s37, v11
    s_nop 0
    s_cmp_eq_u32 s37, 1
    s_cbranch_scc1 KF_GL_GF_D
    s_sleep 3
    s_branch KF_GL_GF_W
KF_GL_GF_D:
KF_GD_GF:
    s_branch KF_Y
KF_SPARE:
    s_sub_u32 s41, s29, 8
    v_and_b32 v7, 7, v1
    s_lshl_b32 s37, s24, 3
    v_add_u32 v7, s37, v7
    v_lshrrev_b32_e64 v8, 3, v1
    v_mul_u32_u24 v53, 3456, v8
    v_lshl_add_u32 v53, v7, 3, v53
    s_lshl_b32 s37, s41, 9
    v_add_u32 v53, s37, v53
    v_cmp_le_u32 vcc, 30, v7
    s_nop 1
    v_cndmask_b32 v9, 0, 1, vcc
    v_mul_u32_u24 v10, 30, v9
    v_sub_u32 v10, v7, v10
    v_mul_u32_u24 v11, 26, v10
    v_lshrrev_b32 v11, 8, v11
    v_mul_u32_u24 v52, 10, v11
    v_sub_u32 v10, v10, v52
    v_mul_u32_u24 v52, 1280, v11
    v_lshl_add_u32 v52, v10, 3, v52
    v_mul_u32_u24 v9, 80, v9
    v_add_u32_e64 v52, v52, v9
    v_mul_u32_u24 v9, 3840, v8
    v_add_u32_e64 v52, v52, v9
    s_mul_i32 s37, s41, 160
    v_add_u32 v52, s37, v52
    v_mov_b32 v9, 0x40000000
    v_cmp_gt_u32 vcc, 60, v7
    s_nop 1
    v_cndmask_b32 v52, v9, v52, vcc
    v_lshrrev_b32 v10, 5, v1
    v_mul_u32_u24 v10, 1280, v10
    v_and_b32_e64 v11, 31, v1
    v_lshl_add_u32 v50, v11, 4, v10
    v_cmp_gt_u32 vcc, 16, v11
    s_nop 1
    v_cndmask_b32 v51, v9, v50, vcc
    s_waitcnt lgkmcnt(0)
    s_mul_i32 s37, s27, 163840
    s_add_u32 s8, s44, s37
    s_addc_u32 s9, s45, 0
    s_and_b32 s9, s9, 0xffff
    s_mov_b32 s10, 163840
    s_mov_b32 s11, 0x20000
    s_mov_b32 s20, s62
    s_nop 0
    s_and_b32 s21, s63, 0xffff
    s_mov_b32 s22, 23396352
    s_mov_b32 s23, 0x20000
    s_mov_b32 s64, s46
    s_nop 0
    s_and_b32 s65, s47, 0xffff
    s_mov_b32 s66, 2457600
    s_mov_b32 s67, 0x20000
    s_lshl_b32 s37, s41, 4
    s_lshl_b32 s38, s24, 1
    s_add_u32 s37, s37, s38
    s_nop 0
    s_mul_i32 s37, s37, 1280
    buffer_load_dwordx4 v[16:19], v50, s[8:11], s37 offen
    buffer_load_dwordx4 v[20:23], v50, s[8:11], s37 offen offset:512
    buffer_load_dwordx4 v[24:27], v51, s[8:11], s37 offen offset:1024
    s_mul_i32 s37, s27, 153600
    buffer_load_dwordx2 v[28:29], v52, s[64:67], s37 offen
    s_add_u32 s37, s37, 30720
    buffer_load_dwordx2 v[30:31], v52, s[64:67], s37 offen
    s_add_u32 s37, s37, 30720
    buffer_load_dwordx2 v[32:33], v52, s[64:67], s37 offen
    s_add_u32 s37, s37, 30720
    buffer_load_dwordx2 v[34:35], v52, s[64:67], s37 offen
    s_add_u32 s37, s37, 30720
    buffer_load_dwordx2 v[36:37], v52, s[64:67], s37 offen
    v_mov_b32_e64 v213, 0
    global_load_dword v213, v213, s[60:61] sc1
    s_lshl_b32 s76, s27, 3
    s_add_u32 s76, s76, s24
    v_and_b32 v9, 7, v1
    v_lshrrev_b32 v10, 3, v1
    v_mul_u32_u24 v11, 1280, v10
    v_lshl_add_u32 v60, v9, 4, v11
    v_cmp_le_u32 vcc, 4, v10
    s_nop 0
    v_mov_b32 v12, 20480
    s_nop 0
    v_cndmask_b32 v12, 0, v12, vcc
    v_add_u32 v61, v60, v12
    s_mov_b32 s68, s56
    s_and_b32 s69, s57, 0xffff
    s_mov_b32 s70, 2211840
    s_mov_b32 s71, 0x20000
    s_mov_b32 s72, s50
    s_nop 0
    s_and_b32 s73, s51, 0xffff
    s_mov_b32 s74, 819200
    s_mov_b32 s75, 0x20000
    s_lshl_b32 s77, s24, 14
    s_add_u32 s78, s76, 0
    s_mul_i32 s79, s78, 6554
    s_lshr_b32 s79, s79, 16
    s_mul_i32 s36, s79, 10
    s_sub_u32 s36, s78, s36
    s_lshl_b32 s30, s36, 7
    s_cmp_ge_u32 s79, 54
    s_cbranch_scc1 KF_SP_WO0
    s_mul_i32 s31, s79, 40960
    s_add_u32 s31, s31, s30
    s_add_u32 m0, s77, 0
    s_nop 0
    s_nop 0
    buffer_load_dwordx4 v60, s[68:71], s31 offen lds
    s_add_u32 s31, s31, 10240
    s_add_u32 m0, s77, 1024
    s_nop 0
    s_nop 0
    buffer_load_dwordx4 v60, s[68:71], s31 offen lds
    s_add_u32 s31, s31, 10240
    s_add_u32 m0, s77, 2048
    s_nop 0
    s_nop 0
    buffer_load_dwordx4 v60, s[68:71], s31 offen lds
    s_add_u32 s31, s31, 10240
    s_add_u32 m0, s77, 3072
    s_nop 0
    s_nop 0
    buffer_load_dwordx4 v60, s[68:71], s31 offen lds
    s_add_u32 s31, s31, 10240
    s_branch KF_SP_DMAD0
KF_SP_WO0:
    s_sub_u32 s32, s79, 54
    s_lshl_b32 s32, s32, 2
    s_add_u32 s32, s32, 0
    s_mul_i32 s33, s32, 205
    s_lshr_b32 s33, s33, 10
    s_mul_i32 s34, s33, 5
    s_sub_u32 s34, s32, s34
    s_lshl_b32 s35, s34, 3
    s_cmp_ge_u32 s34, 2
    s_cselect_b32 s32, 4, 0
    s_add_u32 s35, s35, s32
    s_cmp_eq_u32 s34, 4
    s_cselect_b32 s35, 16, s35
    s_mul_i32 s33, s33, 40
    s_add_u32 s35, s35, s33
    s_nop 0
    s_mul_i32 s35, s35, 1280
    s_add_u32 s35, s35, s30
    s_add_u32 m0, s77, 0
    s_cmp_eq_u32 s34, 4
    s_cbranch_scc1 KF_SP_SPL0_0
    buffer_load_dwordx4 v60, s[72:75], s35 offen lds
    s_branch KF_SP_SPLD0_0
KF_SP_SPL0_0:
    s_nop 0
    buffer_load_dwordx4 v61, s[72:75], s35 offen lds
KF_SP_SPLD0_0:
    s_sub_u32 s32, s79, 54
    s_lshl_b32 s32, s32, 2
    s_add_u32 s32, s32, 1
    s_nop 0
    s_mul_i32 s33, s32, 205
    s_lshr_b32 s33, s33, 10
    s_mul_i32 s34, s33, 5
    s_sub_u32 s34, s32, s34
    s_lshl_b32 s35, s34, 3
    s_cmp_ge_u32 s34, 2
    s_cselect_b32 s32, 4, 0
    s_add_u32 s35, s35, s32
    s_cmp_eq_u32 s34, 4
    s_cselect_b32 s35, 16, s35
    s_mul_i32 s33, s33, 40
    s_add_u32 s35, s35, s33
    s_nop 0
    s_mul_i32 s35, s35, 1280
    s_add_u32 s35, s35, s30
    s_nop 0
    s_add_u32 m0, s77, 1024
    s_cmp_eq_u32 s34, 4
    s_cbranch_scc1 KF_SP_SPL0_1
    buffer_load_dwordx4 v60, s[72:75], s35 offen lds
    s_branch KF_SP_SPLD0_1
KF_SP_SPL0_1:
    s_nop 0
    buffer_load_dwordx4 v61, s[72:75], s35 offen lds
KF_SP_SPLD0_1:
    s_sub_u32 s32, s79, 54
    s_lshl_b32 s32, s32, 2
    s_add_u32 s32, s32, 2
    s_nop 0
    s_mul_i32 s33, s32, 205
    s_lshr_b32 s33, s33, 10
    s_mul_i32 s34, s33, 5
    s_sub_u32 s34, s32, s34
    s_lshl_b32 s35, s34, 3
    s_cmp_ge_u32 s34, 2
    s_cselect_b32 s32, 4, 0
    s_add_u32 s35, s35, s32
    s_cmp_eq_u32 s34, 4
    s_cselect_b32 s35, 16, s35
    s_mul_i32 s33, s33, 40
    s_add_u32 s35, s35, s33
    s_nop 0
    s_mul_i32 s35, s35, 1280
    s_add_u32 s35, s35, s30
    s_nop 0
    s_add_u32 m0, s77, 2048
    s_cmp_eq_u32 s34, 4
    s_cbranch_scc1 KF_SP_SPL0_2
    buffer_load_dwordx4 v60, s[72:75], s35 offen lds
    s_branch KF_SP_SPLD0_2
KF_SP_SPL0_2:
    s_nop 0
    buffer_load_dwordx4 v61, s[72:75], s35 offen lds
KF_SP_SPLD0_2:
    s_sub_u32 s32, s79, 54
    s_lshl_b32 s32, s32, 2
    s_add_u32 s32, s32, 3
    s_nop 0
    s_mul_i32 s33, s32, 205
    s_lshr_b32 s33, s33, 10
    s_mul_i32 s34, s33, 5
    s_sub_u32 s34, s32, s34
    s_lshl_b32 s35, s34, 3
    s_cmp_ge_u32 s34, 2
    s_cselect_b32 s32, 4, 0
    s_add_u32 s35, s35, s32
    s_cmp_eq_u32 s34, 4
    s_cselect_b32 s35, 16, s35
    s_mul_i32 s33, s33, 40
    s_add_u32 s35, s35, s33
    s_nop 0
    s_mul_i32 s35, s35, 1280
    s_add_u32 s35, s35, s30
    s_nop 0
    s_add_u32 m0, s77, 3072
    s_cmp_eq_u32 s34, 4
    s_cbranch_scc1 KF_SP_SPL0_3
    buffer_load_dwordx4 v60, s[72:75], s35 offen lds
    s_branch KF_SP_SPLD0_3
KF_SP_SPL0_3:
    s_nop 0
    buffer_load_dwordx4 v61, s[72:75], s35 offen lds
KF_SP_SPLD0_3:
KF_SP_DMAD0:
    s_add_u32 s78, s76, 128
    s_mul_i32 s79, s78, 6554
    s_lshr_b32 s79, s79, 16
    s_mul_i32 s36, s79, 10
    s_sub_u32 s36, s78, s36
    s_lshl_b32 s30, s36, 7
    s_cmp_ge_u32 s79, 54
    s_cbranch_scc1 KF_SP_WO1
    s_mul_i32 s31, s79, 40960
    s_add_u32 s31, s31, s30
    s_nop 0
    s_add_u32 m0, s77, 4096
    s_nop 0
    s_nop 0
    buffer_load_dwordx4 v60, s[68:71], s31 offen lds
    s_add_u32 s31, s31, 10240
    s_add_u32 m0, s77, 5120
    s_nop 0
    s_nop 0
    buffer_load_dwordx4 v60, s[68:71], s31 offen lds
    s_add_u32 s31, s31, 10240
    s_add_u32 m0, s77, 6144
    s_nop 0
    s_nop 0
    buffer_load_dwordx4 v60, s[68:71], s31 offen lds
    s_add_u32 s31, s31, 10240
    s_add_u32 m0, s77, 7168
    s_nop 0
    s_nop 0
    buffer_load_dwordx4 v60, s[68:71], s31 offen lds
    s_add_u32 s31, s31, 10240
    s_branch KF_SP_DMAD1
KF_SP_WO1:
    s_sub_u32 s32, s79, 54
    s_lshl_b32 s32, s32, 2
    s_add_u32 s32, s32, 0
    s_mul_i32 s33, s32, 205
    s_lshr_b32 s33, s33, 10
    s_mul_i32 s34, s33, 5
    s_sub_u32 s34, s32, s34
    s_lshl_b32 s35, s34, 3
    s_cmp_ge_u32 s34, 2
    s_cselect_b32 s32, 4, 0
    s_add_u32 s35, s35, s32
    s_cmp_eq_u32 s34, 4
    s_cselect_b32 s35, 16, s35
    s_mul_i32 s33, s33, 40
    s_add_u32 s35, s35, s33
    s_nop 0
    s_mul_i32 s35, s35, 1280
    s_add_u32 s35, s35, s30
    s_nop 0
    s_add_u32 m0, s77, 4096
    s_cmp_eq_u32 s34, 4
    s_cbranch_scc1 KF_SP_SPL1_0
    buffer_load_dwordx4 v60, s[72:75], s35 offen lds
    s_branch KF_SP_SPLD1_0
KF_SP_SPL1_0:
    s_nop 0
    buffer_load_dwordx4 v61, s[72:75], s35 offen lds
KF_SP_SPLD1_0:
    s_sub_u32 s32, s79, 54
    s_lshl_b32 s32, s32, 2
    s_add_u32 s32, s32, 1
    s_nop 0
    s_mul_i32 s33, s32, 205
    s_lshr_b32 s33, s33, 10
    s_mul_i32 s34, s33, 5
    s_sub_u32 s34, s32, s34
    s_lshl_b32 s35, s34, 3
    s_cmp_ge_u32 s34, 2
    s_cselect_b32 s32, 4, 0
    s_add_u32 s35, s35, s32
    s_cmp_eq_u32 s34, 4
    s_cselect_b32 s35, 16, s35
    s_mul_i32 s33, s33, 40
    s_add_u32 s35, s35, s33
    s_nop 0
    s_mul_i32 s35, s35, 1280
    s_add_u32 s35, s35, s30
    s_nop 0
    s_add_u32 m0, s77, 5120
    s_cmp_eq_u32 s34, 4
    s_cbranch_scc1 KF_SP_SPL1_1
    buffer_load_dwordx4 v60, s[72:75], s35 offen lds
    s_branch KF_SP_SPLD1_1
KF_SP_SPL1_1:
    s_nop 0
    buffer_load_dwordx4 v61, s[72:75], s35 offen lds
KF_SP_SPLD1_1:
    s_sub_u32 s32, s79, 54
    s_lshl_b32 s32, s32, 2
    s_add_u32 s32, s32, 2
    s_nop 0
    s_mul_i32 s33, s32, 205
    s_lshr_b32 s33, s33, 10
    s_mul_i32 s34, s33, 5
    s_sub_u32 s34, s32, s34
    s_lshl_b32 s35, s34, 3
    s_cmp_ge_u32 s34, 2
    s_cselect_b32 s32, 4, 0
    s_add_u32 s35, s35, s32
    s_cmp_eq_u32 s34, 4
    s_cselect_b32 s35, 16, s35
    s_mul_i32 s33, s33, 40
    s_add_u32 s35, s35, s33
    s_nop 0
    s_mul_i32 s35, s35, 1280
    s_add_u32 s35, s35, s30
    s_nop 0
    s_add_u32 m0, s77, 6144
    s_cmp_eq_u32 s34, 4
    s_cbranch_scc1 KF_SP_SPL1_2
    buffer_load_dwordx4 v60, s[72:75], s35 offen lds
    s_branch KF_SP_SPLD1_2
KF_SP_SPL1_2:
    s_nop 0
    buffer_load_dwordx4 v61, s[72:75], s35 offen lds
KF_SP_SPLD1_2:
    s_sub_u32 s32, s79, 54
    s_lshl_b32 s32, s32, 2
    s_add_u32 s32, s32, 3
    s_nop 0
    s_mul_i32 s33, s32, 205
    s_lshr_b32 s33, s33, 10
    s_mul_i32 s34, s33, 5
    s_sub_u32 s34, s32, s34
    s_lshl_b32 s35, s34, 3
    s_cmp_ge_u32 s34, 2
    s_cselect_b32 s32, 4, 0
    s_add_u32 s35, s35, s32
    s_cmp_eq_u32 s34, 4
    s_cselect_b32 s35, 16, s35
    s_mul_i32 s33, s33, 40
    s_add_u32 s35, s35, s33
    s_nop 0
    s_mul_i32 s35, s35, 1280
    s_add_u32 s35, s35, s30
    s_nop 0
    s_add_u32 m0, s77, 7168
    s_cmp_eq_u32 s34, 4
    s_cbranch_scc1 KF_SP_SPL1_3
    buffer_load_dwordx4 v60, s[72:75], s35 offen lds
    s_branch KF_SP_SPLD1_3
KF_SP_SPL1_3:
    s_nop 0
    buffer_load_dwordx4 v61, s[72:75], s35 offen lds
KF_SP_SPLD1_3:
KF_SP_DMAD1:
    s_add_u32 s78, s76, 256
    s_mul_i32 s79, s78, 6554
    s_lshr_b32 s79, s79, 16
    s_mul_i32 s36, s79, 10
    s_sub_u32 s36, s78, s36
    s_lshl_b32 s30, s36, 7
    s_cmp_ge_u32 s79, 54
    s_cbranch_scc1 KF_SP_WO2
    s_mul_i32 s31, s79, 40960
    s_add_u32 s31, s31, s30
    s_nop 0
    s_add_u32 m0, s77, 8192
    s_nop 0
    s_nop 0
    buffer_load_dwordx4 v60, s[68:71], s31 offen lds
    s_add_u32 s31, s31, 10240
    s_add_u32 m0, s77, 9216
    s_nop 0
    s_nop 0
    buffer_load_dwordx4 v60, s[68:71], s31 offen lds
    s_add_u32 s31, s31, 10240
    s_add_u32 m0, s77, 10240
    s_nop 0
    s_nop 0
    buffer_load_dwordx4 v60, s[68:71], s31 offen lds
    s_add_u32 s31, s31, 10240
    s_add_u32 m0, s77, 11264
    s_nop 0
    s_nop 0
    buffer_load_dwordx4 v60, s[68:71], s31 offen lds
    s_add_u32 s31, s31, 10240
    s_branch KF_SP_DMAD2
KF_SP_WO2:
    s_sub_u32 s32, s79, 54
    s_lshl_b32 s32, s32, 2
    s_add_u32 s32, s32, 0
    s_mul_i32 s33, s32, 205
    s_lshr_b32 s33, s33, 10
    s_mul_i32 s34, s33, 5
    s_sub_u32 s34, s32, s34
    s_lshl_b32 s35, s34, 3
    s_cmp_ge_u32 s34, 2
    s_cselect_b32 s32, 4, 0
    s_add_u32 s35, s35, s32
    s_cmp_eq_u32 s34, 4
    s_cselect_b32 s35, 16, s35
    s_mul_i32 s33, s33, 40
    s_add_u32 s35, s35, s33
    s_nop 0
    s_mul_i32 s35, s35, 1280
    s_add_u32 s35, s35, s30
    s_nop 0
    s_add_u32 m0, s77, 8192
    s_cmp_eq_u32 s34, 4
    s_cbranch_scc1 KF_SP_SPL2_0
    buffer_load_dwordx4 v60, s[72:75], s35 offen lds
    s_branch KF_SP_SPLD2_0
KF_SP_SPL2_0:
    s_nop 0
    buffer_load_dwordx4 v61, s[72:75], s35 offen lds
KF_SP_SPLD2_0:
    s_sub_u32 s32, s79, 54
    s_lshl_b32 s32, s32, 2
    s_add_u32 s32, s32, 1
    s_nop 0
    s_mul_i32 s33, s32, 205
    s_lshr_b32 s33, s33, 10
    s_mul_i32 s34, s33, 5
    s_sub_u32 s34, s32, s34
    s_lshl_b32 s35, s34, 3
    s_cmp_ge_u32 s34, 2
    s_cselect_b32 s32, 4, 0
    s_add_u32 s35, s35, s32
    s_cmp_eq_u32 s34, 4
    s_cselect_b32 s35, 16, s35
    s_mul_i32 s33, s33, 40
    s_add_u32 s35, s35, s33
    s_nop 0
    s_mul_i32 s35, s35, 1280
    s_add_u32 s35, s35, s30
    s_nop 0
    s_add_u32 m0, s77, 9216
    s_cmp_eq_u32 s34, 4
    s_cbranch_scc1 KF_SP_SPL2_1
    buffer_load_dwordx4 v60, s[72:75], s35 offen lds
    s_branch KF_SP_SPLD2_1
KF_SP_SPL2_1:
    s_nop 0
    buffer_load_dwordx4 v61, s[72:75], s35 offen lds
KF_SP_SPLD2_1:
    s_sub_u32 s32, s79, 54
    s_lshl_b32 s32, s32, 2
    s_add_u32 s32, s32, 2
    s_nop 0
    s_mul_i32 s33, s32, 205
    s_lshr_b32 s33, s33, 10
    s_mul_i32 s34, s33, 5
    s_sub_u32 s34, s32, s34
    s_lshl_b32 s35, s34, 3
    s_cmp_ge_u32 s34, 2
    s_cselect_b32 s32, 4, 0
    s_add_u32 s35, s35, s32
    s_cmp_eq_u32 s34, 4
    s_cselect_b32 s35, 16, s35
    s_mul_i32 s33, s33, 40
    s_add_u32 s35, s35, s33
    s_nop 0
    s_mul_i32 s35, s35, 1280
    s_add_u32 s35, s35, s30
    s_nop 0
    s_add_u32 m0, s77, 10240
    s_cmp_eq_u32 s34, 4
    s_cbranch_scc1 KF_SP_SPL2_2
    buffer_load_dwordx4 v60, s[72:75], s35 offen lds
    s_branch KF_SP_SPLD2_2
KF_SP_SPL2_2:
    s_nop 0
    buffer_load_dwordx4 v61, s[72:75], s35 offen lds
KF_SP_SPLD2_2:
    s_sub_u32 s32, s79, 54
    s_lshl_b32 s32, s32, 2
    s_add_u32 s32, s32, 3
    s_nop 0
    s_mul_i32 s33, s32, 205
    s_lshr_b32 s33, s33, 10
    s_mul_i32 s34, s33, 5
    s_sub_u32 s34, s32, s34
    s_lshl_b32 s35, s34, 3
    s_cmp_ge_u32 s34, 2
    s_cselect_b32 s32, 4, 0
    s_add_u32 s35, s35, s32
    s_cmp_eq_u32 s34, 4
    s_cselect_b32 s35, 16, s35
    s_mul_i32 s33, s33, 40
    s_add_u32 s35, s35, s33
    s_nop 0
    s_mul_i32 s35, s35, 1280
    s_add_u32 s35, s35, s30
    s_nop 0
    s_add_u32 m0, s77, 11264
    s_cmp_eq_u32 s34, 4
    s_cbranch_scc1 KF_SP_SPL2_3
    buffer_load_dwordx4 v60, s[72:75], s35 offen lds
    s_branch KF_SP_SPLD2_3
KF_SP_SPL2_3:
    s_nop 0
    buffer_load_dwordx4 v61, s[72:75], s35 offen lds
KF_SP_SPLD2_3:
KF_SP_DMAD2:
    s_add_u32 s78, s76, 384
    s_mul_i32 s79, s78, 6554
    s_lshr_b32 s79, s79, 16
    s_mul_i32 s36, s79, 10
    s_sub_u32 s36, s78, s36
    s_lshl_b32 s30, s36, 7
    s_cmp_ge_u32 s79, 54
    s_cbranch_scc1 KF_SP_WO3
    s_mul_i32 s31, s79, 40960
    s_add_u32 s31, s31, s30
    s_nop 0
    s_add_u32 m0, s77, 12288
    s_nop 0
    s_nop 0
    buffer_load_dwordx4 v60, s[68:71], s31 offen lds
    s_add_u32 s31, s31, 10240
    s_add_u32 m0, s77, 13312
    s_nop 0
    s_nop 0
    buffer_load_dwordx4 v60, s[68:71], s31 offen lds
    s_add_u32 s31, s31, 10240
    s_add_u32 m0, s77, 14336
    s_nop 0
    s_nop 0
    buffer_load_dwordx4 v60, s[68:71], s31 offen lds
    s_add_u32 s31, s31, 10240
    s_add_u32 m0, s77, 15360
    s_nop 0
    s_nop 0
    buffer_load_dwordx4 v60, s[68:71], s31 offen lds
    s_add_u32 s31, s31, 10240
    s_branch KF_SP_DMAD3
KF_SP_WO3:
    s_sub_u32 s32, s79, 54
    s_lshl_b32 s32, s32, 2
    s_add_u32 s32, s32, 0
    s_mul_i32 s33, s32, 205
    s_lshr_b32 s33, s33, 10
    s_mul_i32 s34, s33, 5
    s_sub_u32 s34, s32, s34
    s_lshl_b32 s35, s34, 3
    s_cmp_ge_u32 s34, 2
    s_cselect_b32 s32, 4, 0
    s_add_u32 s35, s35, s32
    s_cmp_eq_u32 s34, 4
    s_cselect_b32 s35, 16, s35
    s_mul_i32 s33, s33, 40
    s_add_u32 s35, s35, s33
    s_nop 0
    s_mul_i32 s35, s35, 1280
    s_add_u32 s35, s35, s30
    s_nop 0
    s_add_u32 m0, s77, 12288
    s_cmp_eq_u32 s34, 4
    s_cbranch_scc1 KF_SP_SPL3_0
    buffer_load_dwordx4 v60, s[72:75], s35 offen lds
    s_branch KF_SP_SPLD3_0
KF_SP_SPL3_0:
    s_nop 0
    buffer_load_dwordx4 v61, s[72:75], s35 offen lds
KF_SP_SPLD3_0:
    s_sub_u32 s32, s79, 54
    s_lshl_b32 s32, s32, 2
    s_add_u32 s32, s32, 1
    s_nop 0
    s_mul_i32 s33, s32, 205
    s_lshr_b32 s33, s33, 10
    s_mul_i32 s34, s33, 5
    s_sub_u32 s34, s32, s34
    s_lshl_b32 s35, s34, 3
    s_cmp_ge_u32 s34, 2
    s_cselect_b32 s32, 4, 0
    s_add_u32 s35, s35, s32
    s_cmp_eq_u32 s34, 4
    s_cselect_b32 s35, 16, s35
    s_mul_i32 s33, s33, 40
    s_add_u32 s35, s35, s33
    s_nop 0
    s_mul_i32 s35, s35, 1280
    s_add_u32 s35, s35, s30
    s_nop 0
    s_add_u32 m0, s77, 13312
    s_cmp_eq_u32 s34, 4
    s_cbranch_scc1 KF_SP_SPL3_1
    buffer_load_dwordx4 v60, s[72:75], s35 offen lds
    s_branch KF_SP_SPLD3_1
KF_SP_SPL3_1:
    s_nop 0
    buffer_load_dwordx4 v61, s[72:75], s35 offen lds
KF_SP_SPLD3_1:
    s_sub_u32 s32, s79, 54
    s_lshl_b32 s32, s32, 2
    s_add_u32 s32, s32, 2
    s_nop 0
    s_mul_i32 s33, s32, 205
    s_lshr_b32 s33, s33, 10
    s_mul_i32 s34, s33, 5
    s_sub_u32 s34, s32, s34
    s_lshl_b32 s35, s34, 3
    s_cmp_ge_u32 s34, 2
    s_cselect_b32 s32, 4, 0
    s_add_u32 s35, s35, s32
    s_cmp_eq_u32 s34, 4
    s_cselect_b32 s35, 16, s35
    s_mul_i32 s33, s33, 40
    s_add_u32 s35, s35, s33
    s_nop 0
    s_mul_i32 s35, s35, 1280
    s_add_u32 s35, s35, s30
    s_nop 0
    s_add_u32 m0, s77, 14336
    s_cmp_eq_u32 s34, 4
    s_cbranch_scc1 KF_SP_SPL3_2
    buffer_load_dwordx4 v60, s[72:75], s35 offen lds
    s_branch KF_SP_SPLD3_2
KF_SP_SPL3_2:
    s_nop 0
    buffer_load_dwordx4 v61, s[72:75], s35 offen lds
KF_SP_SPLD3_2:
    s_sub_u32 s32, s79, 54
    s_lshl_b32 s32, s32, 2
    s_add_u32 s32, s32, 3
    s_nop 0
    s_mul_i32 s33, s32, 205
    s_lshr_b32 s33, s33, 10
    s_mul_i32 s34, s33, 5
    s_sub_u32 s34, s32, s34
    s_lshl_b32 s35, s34, 3
    s_cmp_ge_u32 s34, 2
    s_cselect_b32 s32, 4, 0
    s_add_u32 s35, s35, s32
    s_cmp_eq_u32 s34, 4
    s_cselect_b32 s35, 16, s35
    s_mul_i32 s33, s33, 40
    s_add_u32 s35, s35, s33
    s_nop 0
    s_mul_i32 s35, s35, 1280
    s_add_u32 s35, s35, s30
    s_nop 0
    s_add_u32 m0, s77, 15360
    s_cmp_eq_u32 s34, 4
    s_cbranch_scc1 KF_SP_SPL3_3
    buffer_load_dwordx4 v60, s[72:75], s35 offen lds
    s_branch KF_SP_SPLD3_3
KF_SP_SPL3_3:
    s_nop 0
    buffer_load_dwordx4 v61, s[72:75], s35 offen lds
KF_SP_SPLD3_3:
KF_SP_DMAD3:
    s_waitcnt vmcnt(16)
KF_NON_SN:
    v_readfirstlane_b32 s4, v213
    s_nop 0
    s_cmp_lg_u32 s4, 0
    s_cbranch_scc1 KF_NOK_SN
    s_sleep 8
    v_mov_b32_e64 v213, 0
    global_load_dword v213, v213, s[60:61] sc1
    s_waitcnt vmcnt(0)
    s_branch KF_NON_SN
KF_NOK_SN:
    v_lshlrev_b32 v216, 16, v16
    v_lshlrev_b32 v246, 16, v28
    v_and_b32 v217, 0xffff0000, v16
    v_and_b32 v247, 0xffff0000, v28
    v_lshlrev_b32 v218, 16, v17
    v_lshlrev_b32 v248, 16, v29
    v_and_b32 v219, 0xffff0000, v17
    v_and_b32 v249, 0xffff0000, v29
    v_lshlrev_b32 v220, 16, v18
    v_lshlrev_b32 v250, 16, v30
    v_and_b32 v221, 0xffff0000, v18
    v_and_b32 v251, 0xffff0000, v30
    v_lshlrev_b32 v222, 16, v19
    v_lshlrev_b32 v252, 16, v31
    v_and_b32 v223, 0xffff0000, v19
    v_and_b32 v253, 0xffff0000, v31
    v_lshlrev_b32 v224, 16, v20
    v_add_f32 v246, v246, v250
    v_and_b32 v225, 0xffff0000, v20
    v_add_f32 v247, v247, v251
    v_lshlrev_b32 v226, 16, v21
    v_add_f32_e64 v248, v248, v252
    v_and_b32 v227, 0xffff0000, v21
    v_add_f32 v249, v249, v253
    v_lshlrev_b32 v228, 16, v22
    v_lshlrev_b32_e64 v250, 16, v32
    v_and_b32 v229, 0xffff0000, v22
    v_and_b32 v251, 0xffff0000, v32
    v_lshlrev_b32 v230, 16, v23
    v_lshlrev_b32 v252, 16, v33
    v_and_b32 v231, 0xffff0000, v23
    v_and_b32 v253, 0xffff0000, v33
    v_lshlrev_b32 v232, 16, v24
    v_add_f32 v246, v246, v250
    v_and_b32 v233, 0xffff0000, v24
    v_add_f32 v247, v247, v251
    v_lshlrev_b32 v234, 16, v25
    v_add_f32_e64 v248, v248, v252
    v_and_b32 v235, 0xffff0000, v25
    v_add_f32 v249, v249, v253
    v_lshlrev_b32 v236, 16, v26
    v_lshlrev_b32_e64 v250, 16, v34
    v_and_b32 v237, 0xffff0000, v26
    v_and_b32 v251, 0xffff0000, v34
    v_lshlrev_b32 v238, 16, v27
    v_lshlrev_b32 v252, 16, v35
    v_and_b32 v239, 0xffff0000, v27
    v_and_b32 v253, 0xffff0000, v35
    v_add_f32 v240, v216, v217
    v_add_f32 v246, v246, v250
    v_add_f32 v241, v218, v219
    v_add_f32 v247, v247, v251
    v_add_f32 v240, v240, v220
    v_add_f32 v248, v248, v252
    v_add_f32 v241, v241, v221
    v_add_f32 v249, v249, v253
    v_add_f32 v240, v240, v222
    v_lshlrev_b32 v250, 16, v36
    v_add_f32_e64 v241, v241, v223
    v_and_b32 v251, 0xffff0000, v36
    v_add_f32 v240, v240, v224
    v_lshlrev_b32 v252, 16, v37
    v_add_f32_e64 v241, v241, v225
    v_and_b32 v253, 0xffff0000, v37
    v_add_f32 v240, v240, v226
    v_add_f32 v246, v246, v250
    v_add_f32 v241, v241, v227
    v_add_f32 v247, v247, v251
    v_add_f32 v240, v240, v228
    v_add_f32 v248, v248, v252
    v_add_f32 v241, v241, v229
    v_add_f32 v249, v249, v253
    v_add_f32_e64 v240, v240, v230
    v_add_f32_dpp v246, v246, v246 row_ror:8 row_mask:0xf bank_mask:0xf
    v_add_f32_e64 v241, v241, v231
    v_add_f32_dpp v247, v247, v247 row_ror:8 row_mask:0xf bank_mask:0xf
    v_add_f32_e64 v240, v240, v232
    v_add_f32_dpp v248, v248, v248 row_ror:8 row_mask:0xf bank_mask:0xf
    v_add_f32_e64 v241, v241, v233
    v_add_f32_dpp v249, v249, v249 row_ror:8 row_mask:0xf bank_mask:0xf
    v_add_f32 v240, v240, v234
    v_mov_b32 v250, v246
    v_add_f32 v241, v241, v235
    v_mov_b32 v251, v247
    v_add_f32 v240, v240, v236
    v_mov_b32 v252, v248
    v_add_f32 v241, v241, v237
    v_mov_b32 v253, v249
    v_add_f32 v240, v240, v238
    v_permlane16_swap_b32 v246, v250
    v_add_f32 v241, v241, v239
    v_permlane16_swap_b32 v247, v251
    v_add_f32 v240, v240, v241
    v_permlane16_swap_b32 v248, v252
    s_nop 0
    s_nop 0
    v_add_f32_dpp v240, v240, v240 quad_perm:[1,0,3,2] row_mask:0xf bank_mask:0xf
    v_permlane16_swap_b32 v249, v253
    s_nop 0
    v_add_f32_dpp v240, v240, v240 quad_perm:[2,3,0,1] row_mask:0xf bank_mask:0xf
    v_add_f32 v246, v246, v250
    s_nop 0
    v_add_f32_dpp v240, v240, v240 row_half_mirror row_mask:0xf bank_mask:0xf
    v_add_f32 v247, v247, v251
    s_nop 0
    v_add_f32_dpp v240, v240, v240 row_mirror row_mask:0xf bank_mask:0xf
    v_add_f32 v248, v248, v252
    v_mov_b32 v241, v240
    v_add_f32 v249, v249, v253
    s_nop 0
    v_permlane16_swap_b32 v240, v241
    v_mov_b32 v250, v246
    v_add_f32 v240, v240, v241
    v_mov_b32 v251, v247
    v_mul_f32 v242, 0x3acccccd, v240
    v_mov_b32 v252, v248
    v_sub_f32 v216, v216, v242
    v_mov_b32 v253, v249
    v_sub_f32 v217, v217, v242
    v_permlane32_swap_b32 v246, v250
    v_sub_f32 v218, v218, v242
    v_permlane32_swap_b32 v247, v251
    v_sub_f32 v219, v219, v242
    v_permlane32_swap_b32 v248, v252
    v_sub_f32 v220, v220, v242
    v_permlane32_swap_b32 v249, v253
    v_sub_f32 v221, v221, v242
    v_add_f32 v246, v246, v250
    v_sub_f32 v222, v222, v242
    v_add_f32 v247, v247, v251
    v_sub_f32 v223, v223, v242
    v_add_f32 v248, v248, v252
    v_sub_f32 v224, v224, v242
    v_add_f32 v249, v249, v253
    v_sub_f32 v225, v225, v242
    v_sub_f32 v226, v226, v242
    v_sub_f32 v227, v227, v242
    v_sub_f32 v228, v228, v242
    v_sub_f32 v229, v229, v242
    v_sub_f32 v230, v230, v242
    v_sub_f32 v231, v231, v242
    v_sub_f32 v232, v232, v242
    v_sub_f32 v233, v233, v242
    v_sub_f32 v234, v234, v242
    v_sub_f32 v235, v235, v242
    v_sub_f32 v236, v236, v242
    v_sub_f32 v237, v237, v242
    v_sub_f32 v238, v238, v242
    v_sub_f32 v239, v239, v242
    v_mul_f32 v240, v216, v216
    v_mul_f32 v241, v217, v217
    v_fma_f32 v240, v218, v218, v240
    v_fma_f32 v241, v219, v219, v241
    v_fma_f32 v240, v220, v220, v240
    v_fma_f32 v241, v221, v221, v241
    v_fma_f32 v240, v222, v222, v240
    v_fma_f32 v241, v223, v223, v241
    v_fma_f32 v240, v224, v224, v240
    v_fma_f32 v241, v225, v225, v241
    v_fma_f32 v240, v226, v226, v240
    v_fma_f32 v241, v227, v227, v241
    v_fma_f32 v240, v228, v228, v240
    v_fma_f32 v241, v229, v229, v241
    v_fma_f32 v240, v230, v230, v240
    v_fma_f32 v241, v231, v231, v241
    v_mul_f32 v244, v232, v232
    v_mul_f32 v245, v233, v233
    v_fma_f32 v244, v234, v234, v244
    v_fma_f32 v245, v235, v235, v245
    v_fma_f32 v244, v236, v236, v244
    v_fma_f32 v245, v237, v237, v245
    v_fma_f32 v244, v238, v238, v244
    v_fma_f32 v245, v239, v239, v245
    v_add_f32_e64 v244, v244, v245
    v_bfe_u32 v245, v1, 4, 1
    v_xor_b32 v245, 1, v245
    v_cvt_f32_u32 v245, v245
    v_add_f32_e64 v240, v240, v241
    v_fma_f32 v240, v244, v245, v240
    s_nop 1
    s_nop 0
    v_add_f32_dpp v240, v240, v240 quad_perm:[1,0,3,2] row_mask:0xf bank_mask:0xf
    s_nop 1
    s_nop 0
    v_add_f32_dpp v240, v240, v240 quad_perm:[2,3,0,1] row_mask:0xf bank_mask:0xf
    s_nop 1
    s_nop 0
    v_add_f32_dpp v240, v240, v240 row_half_mirror row_mask:0xf bank_mask:0xf
    s_nop 1
    s_nop 0
    v_add_f32_dpp v240, v240, v240 row_mirror row_mask:0xf bank_mask:0xf
    v_mov_b32 v241, v240
    s_nop 1
    v_permlane16_swap_b32 v240, v241
    v_add_f32 v240, v240, v241
    v_mov_b32 v243, 0x3727c5ac
    v_fmac_f32 v243, 0x3acccccd, v240
    v_rsq_f32 v243, v243
    v_lshlrev_b32 v7, 4, v1
    v_mov_b32 v8, 0x40000000
    v_cmp_gt_u32 vcc, 8, v1
    s_nop 1
    v_cndmask_b32 v7, v8, v7, vcc
    s_sub_u32 s41, s29, 8
    s_add_u32 s37, s41, 0
    s_lshl_b32 s37, s37, 4
    s_add_u32 s37, s37, s27
    s_lshl_b32 s37, s37, 10
    s_lshl_b32 s38, s24, 7
    s_add_u32 s37, s37, s38
    s_nop 0
    s_add_u32 s37, s37, 23068672
    buffer_store_dwordx4 v[246:249], v7, s[20:23], s37 offen sc1
    s_lshl_b32 s37, s27, 7
    s_lshl_b32 s38, s41, 4
    s_add_u32 s37, s37, s38
    s_lshl_b32 s38, s24, 1
    s_add_u32 s37, s37, s38
    s_lshl_b32 s37, s37, 3
    v_lshrrev_b32 v7, 5, v1
    v_lshlrev_b32 v7, 3, v7
    v_and_b32 v9, 31, v1
    v_cmp_eq_u32 vcc, 0, v9
    s_nop 1
    v_cndmask_b32 v7, v8, v7, vcc
    buffer_store_dwordx2 v[242:243], v7, s[20:23], s37 offen sc1
    s_waitcnt vmcnt(0) lgkmcnt(0)
    s_barrier
    s_cmp_lg_u32 s24, 0
    s_cbranch_scc1 KF_NOPUB_S
    s_sub_u32 s38, s29, 8
    s_lshl_b32 s37, s27, 7
    s_lshl_b32 s39, s38, 2
    s_add_u32 s37, s37, s39
    s_add_u32 s37, s37, 23330816
    v_mov_b32 v8, s37
    v_mov_b32 v9, s4
    s_mov_b64 exec, 1
    s_nop 0
    global_store_dword v8, v9, s[62:63] sc1
    s_mov_b64 exec, -1
    s_lshl_b32 s37, s38, 7
    s_lshl_b32 s39, s27, 2
    s_add_u32 s37, s37, s39
    s_add_u32 s37, s37, 23332864
    v_mov_b32 v8, s37
    v_mov_b32 v9, s4
    s_mov_b64 exec, 1
    s_nop 0
    global_store_dword v8, v9, s[62:63] sc1
    s_mov_b64 exec, -1
KF_NOPUB_S:
    v_lshrrev_b32 v10, 4, v1
    v_bfe_u32 v11, v1, 2, 2
    v_lshl_add_u32 v10, v10, 3, v11
    v_lshlrev_b32 v10, 7, v10
    v_and_b32 v11, 3, v1
    v_lshl_add_u32 v10, v11, 3, v10
    v_add_u32 v62, s77, v10
    v_lshlrev_b32 v63, 4, v1
    s_add_u32 s78, s76, 0
    s_nop 0
    s_mul_i32 s79, s78, 6554
    s_lshr_b32 s79, s79, 16
    s_mul_i32 s36, s79, 10
    s_sub_u32 s36, s78, s36
    s_nop 0
    ds_read_b64_tr_b16 v[64:65], v62 offset:0
    ds_read_b64_tr_b16 v[66:67], v62 offset:512
    ds_read_b64_tr_b16 v[68:69], v62 offset:32
    ds_read_b64_tr_b16 v[70:71], v62 offset:544
    ds_read_b64_tr_b16 v[72:73], v62 offset:64
    ds_read_b64_tr_b16 v[74:75], v62 offset:576
    ds_read_b64_tr_b16 v[76:77], v62 offset:96
    ds_read_b64_tr_b16 v[78:79], v62 offset:608
    s_waitcnt lgkmcnt(0)
    s_lshl_b32 s30, s36, 2
    s_add_u32 s30, s30, 0
    s_nop 0
    s_mul_i32 s31, s30, 205
    s_lshr_b32 s31, s31, 10
    s_mul_i32 s32, s31, 5
    s_sub_u32 s32, s30, s32
    s_nop 0
    s_mul_i32 s31, s31, 378880
    s_mul_i32 s33, s79, 5120
    s_add_u32 s31, s31, s33
    s_lshl_b32 s32, s32, 10
    s_add_u32 s31, s31, s32
    s_nop 0
    s_add_u32 s31, s31, 11534336
    buffer_store_dwordx4 v[64:67], v63, s[20:23], s31 offen sc1
    s_lshl_b32 s30, s36, 2
    s_add_u32 s30, s30, 1
    s_mul_i32 s31, s30, 205
    s_lshr_b32 s31, s31, 10
    s_mul_i32 s32, s31, 5
    s_sub_u32 s32, s30, s32
    s_nop 0
    s_mul_i32 s31, s31, 378880
    s_mul_i32 s33, s79, 5120
    s_add_u32 s31, s31, s33
    s_lshl_b32 s32, s32, 10
    s_add_u32 s31, s31, s32
    s_nop 0
    s_add_u32 s31, s31, 11534336
    buffer_store_dwordx4 v[68:71], v63, s[20:23], s31 offen sc1
    s_lshl_b32 s30, s36, 2
    s_add_u32 s30, s30, 2
    s_mul_i32 s31, s30, 205
    s_lshr_b32 s31, s31, 10
    s_mul_i32 s32, s31, 5
    s_sub_u32 s32, s30, s32
    s_nop 0
    s_mul_i32 s31, s31, 378880
    s_mul_i32 s33, s79, 5120
    s_add_u32 s31, s31, s33
    s_lshl_b32 s32, s32, 10
    s_add_u32 s31, s31, s32
    s_nop 0
    s_add_u32 s31, s31, 11534336
    buffer_store_dwordx4 v[72:75], v63, s[20:23], s31 offen sc1
    s_lshl_b32 s30, s36, 2
    s_add_u32 s30, s30, 3
    s_mul_i32 s31, s30, 205
    s_lshr_b32 s31, s31, 10
    s_mul_i32 s32, s31, 5
    s_sub_u32 s32, s30, s32
    s_nop 0
    s_mul_i32 s31, s31, 378880
    s_mul_i32 s33, s79, 5120
    s_add_u32 s31, s31, s33
    s_lshl_b32 s32, s32, 10
    s_add_u32 s31, s31, s32
    s_nop 0
    s_add_u32 s31, s31, 11534336
    buffer_store_dwordx4 v[76:79], v63, s[20:23], s31 offen sc1
    s_add_u32 s78, s76, 512
    s_mul_i32 s79, s78, 6554
    s_lshr_b32 s79, s79, 16
    s_mul_i32 s36, s79, 10
    s_sub_u32 s36, s78, s36
    s_lshl_b32 s30, s36, 7
    s_cmp_ge_u32 s79, 54
    s_cbranch_scc1 KF_SP_WO4
    s_mul_i32 s31, s79, 40960
    s_add_u32 s31, s31, s30
    s_add_u32 m0, s77, 0
    s_nop 0
    s_nop 0
    buffer_load_dwordx4 v60, s[68:71], s31 offen lds
    s_add_u32 s31, s31, 10240
    s_add_u32 m0, s77, 1024
    s_nop 0
    s_nop 0
    buffer_load_dwordx4 v60, s[68:71], s31 offen lds
    s_add_u32 s31, s31, 10240
    s_add_u32 m0, s77, 2048
    s_nop 0
    s_nop 0
    buffer_load_dwordx4 v60, s[68:71], s31 offen lds
    s_add_u32 s31, s31, 10240
    s_add_u32 m0, s77, 3072
    s_nop 0
    s_nop 0
    buffer_load_dwordx4 v60, s[68:71], s31 offen lds
    s_add_u32 s31, s31, 10240
    s_branch KF_SP_DMAD4
KF_SP_WO4:
    s_sub_u32 s32, s79, 54
    s_lshl_b32 s32, s32, 2
    s_add_u32 s32, s32, 0
    s_mul_i32 s33, s32, 205
    s_lshr_b32 s33, s33, 10
    s_mul_i32 s34, s33, 5
    s_sub_u32 s34, s32, s34
    s_lshl_b32 s35, s34, 3
    s_cmp_ge_u32 s34, 2
    s_cselect_b32 s32, 4, 0
    s_add_u32 s35, s35, s32
    s_cmp_eq_u32 s34, 4
    s_cselect_b32 s35, 16, s35
    s_mul_i32 s33, s33, 40
    s_add_u32 s35, s35, s33
    s_nop 0
    s_mul_i32 s35, s35, 1280
    s_add_u32 s35, s35, s30
    s_add_u32 m0, s77, 0
    s_cmp_eq_u32 s34, 4
    s_cbranch_scc1 KF_SP_SPL4_0
    buffer_load_dwordx4 v60, s[72:75], s35 offen lds
    s_branch KF_SP_SPLD4_0
KF_SP_SPL4_0:
    s_nop 0
    buffer_load_dwordx4 v61, s[72:75], s35 offen lds
KF_SP_SPLD4_0:
    s_sub_u32 s32, s79, 54
    s_lshl_b32 s32, s32, 2
    s_add_u32 s32, s32, 1
    s_nop 0
    s_mul_i32 s33, s32, 205
    s_lshr_b32 s33, s33, 10
    s_mul_i32 s34, s33, 5
    s_sub_u32 s34, s32, s34
    s_lshl_b32 s35, s34, 3
    s_cmp_ge_u32 s34, 2
    s_cselect_b32 s32, 4, 0
    s_add_u32 s35, s35, s32
    s_cmp_eq_u32 s34, 4
    s_cselect_b32 s35, 16, s35
    s_mul_i32 s33, s33, 40
    s_add_u32 s35, s35, s33
    s_nop 0
    s_mul_i32 s35, s35, 1280
    s_add_u32 s35, s35, s30
    s_nop 0
    s_add_u32 m0, s77, 1024
    s_cmp_eq_u32 s34, 4
    s_cbranch_scc1 KF_SP_SPL4_1
    buffer_load_dwordx4 v60, s[72:75], s35 offen lds
    s_branch KF_SP_SPLD4_1
KF_SP_SPL4_1:
    s_nop 0
    buffer_load_dwordx4 v61, s[72:75], s35 offen lds
KF_SP_SPLD4_1:
    s_sub_u32 s32, s79, 54
    s_lshl_b32 s32, s32, 2
    s_add_u32 s32, s32, 2
    s_nop 0
    s_mul_i32 s33, s32, 205
    s_lshr_b32 s33, s33, 10
    s_mul_i32 s34, s33, 5
    s_sub_u32 s34, s32, s34
    s_lshl_b32 s35, s34, 3
    s_cmp_ge_u32 s34, 2
    s_cselect_b32 s32, 4, 0
    s_add_u32 s35, s35, s32
    s_cmp_eq_u32 s34, 4
    s_cselect_b32 s35, 16, s35
    s_mul_i32 s33, s33, 40
    s_add_u32 s35, s35, s33
    s_nop 0
    s_mul_i32 s35, s35, 1280
    s_add_u32 s35, s35, s30
    s_nop 0
    s_add_u32 m0, s77, 2048
    s_cmp_eq_u32 s34, 4
    s_cbranch_scc1 KF_SP_SPL4_2
    buffer_load_dwordx4 v60, s[72:75], s35 offen lds
    s_branch KF_SP_SPLD4_2
KF_SP_SPL4_2:
    s_nop 0
    buffer_load_dwordx4 v61, s[72:75], s35 offen lds
KF_SP_SPLD4_2:
    s_sub_u32 s32, s79, 54
    s_lshl_b32 s32, s32, 2
    s_add_u32 s32, s32, 3
    s_nop 0
    s_mul_i32 s33, s32, 205
    s_lshr_b32 s33, s33, 10
    s_mul_i32 s34, s33, 5
    s_sub_u32 s34, s32, s34
    s_lshl_b32 s35, s34, 3
    s_cmp_ge_u32 s34, 2
    s_cselect_b32 s32, 4, 0
    s_add_u32 s35, s35, s32
    s_cmp_eq_u32 s34, 4
    s_cselect_b32 s35, 16, s35
    s_mul_i32 s33, s33, 40
    s_add_u32 s35, s35, s33
    s_nop 0
    s_mul_i32 s35, s35, 1280
    s_add_u32 s35, s35, s30
    s_nop 0
    s_add_u32 m0, s77, 3072
    s_cmp_eq_u32 s34, 4
    s_cbranch_scc1 KF_SP_SPL4_3
    buffer_load_dwordx4 v60, s[72:75], s35 offen lds
    s_branch KF_SP_SPLD4_3
KF_SP_SPL4_3:
    s_nop 0
    buffer_load_dwordx4 v61, s[72:75], s35 offen lds
KF_SP_SPLD4_3:
KF_SP_DMAD4:
    s_add_u32 s78, s76, 128
    s_mul_i32 s79, s78, 6554
    s_lshr_b32 s79, s79, 16
    s_mul_i32 s36, s79, 10
    s_sub_u32 s36, s78, s36
    s_nop 0
    ds_read_b64_tr_b16 v[64:65], v62 offset:4096
    ds_read_b64_tr_b16 v[66:67], v62 offset:4608
    ds_read_b64_tr_b16 v[68:69], v62 offset:4128
    ds_read_b64_tr_b16 v[70:71], v62 offset:4640
    ds_read_b64_tr_b16 v[72:73], v62 offset:4160
    ds_read_b64_tr_b16 v[74:75], v62 offset:4672
    ds_read_b64_tr_b16 v[76:77], v62 offset:4192
    ds_read_b64_tr_b16 v[78:79], v62 offset:4704
    s_waitcnt lgkmcnt(0)
    s_lshl_b32 s30, s36, 2
    s_add_u32 s30, s30, 0
    s_nop 0
    s_mul_i32 s31, s30, 205
    s_lshr_b32 s31, s31, 10
    s_mul_i32 s32, s31, 5
    s_sub_u32 s32, s30, s32
    s_nop 0
    s_mul_i32 s31, s31, 378880
    s_mul_i32 s33, s79, 5120
    s_add_u32 s31, s31, s33
    s_lshl_b32 s32, s32, 10
    s_add_u32 s31, s31, s32
    s_nop 0
    s_add_u32 s31, s31, 11534336
    buffer_store_dwordx4 v[64:67], v63, s[20:23], s31 offen sc1
    s_lshl_b32 s30, s36, 2
    s_add_u32 s30, s30, 1
    s_mul_i32 s31, s30, 205
    s_lshr_b32 s31, s31, 10
    s_mul_i32 s32, s31, 5
    s_sub_u32 s32, s30, s32
    s_nop 0
    s_mul_i32 s31, s31, 378880
    s_mul_i32 s33, s79, 5120
    s_add_u32 s31, s31, s33
    s_lshl_b32 s32, s32, 10
    s_add_u32 s31, s31, s32
    s_nop 0
    s_add_u32 s31, s31, 11534336
    buffer_store_dwordx4 v[68:71], v63, s[20:23], s31 offen sc1
    s_lshl_b32 s30, s36, 2
    s_add_u32 s30, s30, 2
    s_mul_i32 s31, s30, 205
    s_lshr_b32 s31, s31, 10
    s_mul_i32 s32, s31, 5
    s_sub_u32 s32, s30, s32
    s_nop 0
    s_mul_i32 s31, s31, 378880
    s_mul_i32 s33, s79, 5120
    s_add_u32 s31, s31, s33
    s_lshl_b32 s32, s32, 10
    s_add_u32 s31, s31, s32
    s_nop 0
    s_add_u32 s31, s31, 11534336
    buffer_store_dwordx4 v[72:75], v63, s[20:23], s31 offen sc1
    s_lshl_b32 s30, s36, 2
    s_add_u32 s30, s30, 3
    s_mul_i32 s31, s30, 205
    s_lshr_b32 s31, s31, 10
    s_mul_i32 s32, s31, 5
    s_sub_u32 s32, s30, s32
    s_nop 0
    s_mul_i32 s31, s31, 378880
    s_mul_i32 s33, s79, 5120
    s_add_u32 s31, s31, s33
    s_lshl_b32 s32, s32, 10
    s_add_u32 s31, s31, s32
    s_nop 0
    s_add_u32 s31, s31, 11534336
    buffer_store_dwordx4 v[76:79], v63, s[20:23], s31 offen sc1
    s_cmp_ge_u32 s76, 100
    s_cbranch_scc1 KF_SP_NO6A
    s_nop 0
    s_add_u32 s78, s76, 640
    s_mul_i32 s79, s78, 6554
    s_lshr_b32 s79, s79, 16
    s_mul_i32 s36, s79, 10
    s_sub_u32 s36, s78, s36
    s_lshl_b32 s30, s36, 7
    s_cmp_ge_u32 s79, 54
    s_cbranch_scc1 KF_SP_WO5
    s_mul_i32 s31, s79, 40960
    s_add_u32 s31, s31, s30
    s_nop 0
    s_add_u32 m0, s77, 4096
    s_nop 0
    s_nop 0
    buffer_load_dwordx4 v60, s[68:71], s31 offen lds
    s_add_u32 s31, s31, 10240
    s_add_u32 m0, s77, 5120
    s_nop 0
    s_nop 0
    buffer_load_dwordx4 v60, s[68:71], s31 offen lds
    s_add_u32 s31, s31, 10240
    s_add_u32 m0, s77, 6144
    s_nop 0
    s_nop 0
    buffer_load_dwordx4 v60, s[68:71], s31 offen lds
    s_add_u32 s31, s31, 10240
    s_add_u32 m0, s77, 7168
    s_nop 0
    s_nop 0
    buffer_load_dwordx4 v60, s[68:71], s31 offen lds
    s_add_u32 s31, s31, 10240
    s_branch KF_SP_DMAD5
KF_SP_WO5:
    s_sub_u32 s32, s79, 54
    s_lshl_b32 s32, s32, 2
    s_add_u32 s32, s32, 0
    s_mul_i32 s33, s32, 205
    s_lshr_b32 s33, s33, 10
    s_mul_i32 s34, s33, 5
    s_sub_u32 s34, s32, s34
    s_lshl_b32 s35, s34, 3
    s_cmp_ge_u32 s34, 2
    s_cselect_b32 s32, 4, 0
    s_add_u32 s35, s35, s32
    s_cmp_eq_u32 s34, 4
    s_cselect_b32 s35, 16, s35
    s_mul_i32 s33, s33, 40
    s_add_u32 s35, s35, s33
    s_nop 0
    s_mul_i32 s35, s35, 1280
    s_add_u32 s35, s35, s30
    s_nop 0
    s_add_u32 m0, s77, 4096
    s_cmp_eq_u32 s34, 4
    s_cbranch_scc1 KF_SP_SPL5_0
    buffer_load_dwordx4 v60, s[72:75], s35 offen lds
    s_branch KF_SP_SPLD5_0
KF_SP_SPL5_0:
    s_nop 0
    buffer_load_dwordx4 v61, s[72:75], s35 offen lds
KF_SP_SPLD5_0:
    s_sub_u32 s32, s79, 54
    s_lshl_b32 s32, s32, 2
    s_add_u32 s32, s32, 1
    s_nop 0
    s_mul_i32 s33, s32, 205
    s_lshr_b32 s33, s33, 10
    s_mul_i32 s34, s33, 5
    s_sub_u32 s34, s32, s34
    s_lshl_b32 s35, s34, 3
    s_cmp_ge_u32 s34, 2
    s_cselect_b32 s32, 4, 0
    s_add_u32 s35, s35, s32
    s_cmp_eq_u32 s34, 4
    s_cselect_b32 s35, 16, s35
    s_mul_i32 s33, s33, 40
    s_add_u32 s35, s35, s33
    s_nop 0
    s_mul_i32 s35, s35, 1280
    s_add_u32 s35, s35, s30
    s_nop 0
    s_add_u32 m0, s77, 5120
    s_cmp_eq_u32 s34, 4
    s_cbranch_scc1 KF_SP_SPL5_1
    buffer_load_dwordx4 v60, s[72:75], s35 offen lds
    s_branch KF_SP_SPLD5_1
KF_SP_SPL5_1:
    s_nop 0
    buffer_load_dwordx4 v61, s[72:75], s35 offen lds
KF_SP_SPLD5_1:
    s_sub_u32 s32, s79, 54
    s_lshl_b32 s32, s32, 2
    s_add_u32 s32, s32, 2
    s_nop 0
    s_mul_i32 s33, s32, 205
    s_lshr_b32 s33, s33, 10
    s_mul_i32 s34, s33, 5
    s_sub_u32 s34, s32, s34
    s_lshl_b32 s35, s34, 3
    s_cmp_ge_u32 s34, 2
    s_cselect_b32 s32, 4, 0
    s_add_u32 s35, s35, s32
    s_cmp_eq_u32 s34, 4
    s_cselect_b32 s35, 16, s35
    s_mul_i32 s33, s33, 40
    s_add_u32 s35, s35, s33
    s_nop 0
    s_mul_i32 s35, s35, 1280
    s_add_u32 s35, s35, s30
    s_nop 0
    s_add_u32 m0, s77, 6144
    s_cmp_eq_u32 s34, 4
    s_cbranch_scc1 KF_SP_SPL5_2
    buffer_load_dwordx4 v60, s[72:75], s35 offen lds
    s_branch KF_SP_SPLD5_2
KF_SP_SPL5_2:
    s_nop 0
    buffer_load_dwordx4 v61, s[72:75], s35 offen lds
KF_SP_SPLD5_2:
    s_sub_u32 s32, s79, 54
    s_lshl_b32 s32, s32, 2
    s_add_u32 s32, s32, 3
    s_nop 0
    s_mul_i32 s33, s32, 205
    s_lshr_b32 s33, s33, 10
    s_mul_i32 s34, s33, 5
    s_sub_u32 s34, s32, s34
    s_lshl_b32 s35, s34, 3
    s_cmp_ge_u32 s34, 2
    s_cselect_b32 s32, 4, 0
    s_add_u32 s35, s35, s32
    s_cmp_eq_u32 s34, 4
    s_cselect_b32 s35, 16, s35
    s_mul_i32 s33, s33, 40
    s_add_u32 s35, s35, s33
    s_nop 0
    s_mul_i32 s35, s35, 1280
    s_add_u32 s35, s35, s30
    s_nop 0
    s_add_u32 m0, s77, 7168
    s_cmp_eq_u32 s34, 4
    s_cbranch_scc1 KF_SP_SPL5_3
    buffer_load_dwordx4 v60, s[72:75], s35 offen lds
    s_branch KF_SP_SPLD5_3
KF_SP_SPL5_3:
    s_nop 0
    buffer_load_dwordx4 v61, s[72:75], s35 offen lds
KF_SP_SPLD5_3:
KF_SP_DMAD5:
KF_SP_NO6A:
    s_add_u32 s78, s76, 256
    s_mul_i32 s79, s78, 6554
    s_lshr_b32 s79, s79, 16
    s_mul_i32 s36, s79, 10
    s_sub_u32 s36, s78, s36
    s_nop 0
    ds_read_b64_tr_b16 v[64:65], v62 offset:8192
    ds_read_b64_tr_b16 v[66:67], v62 offset:8704
    ds_read_b64_tr_b16 v[68:69], v62 offset:8224
    ds_read_b64_tr_b16 v[70:71], v62 offset:8736
    ds_read_b64_tr_b16 v[72:73], v62 offset:8256
    ds_read_b64_tr_b16 v[74:75], v62 offset:8768
    ds_read_b64_tr_b16 v[76:77], v62 offset:8288
    ds_read_b64_tr_b16 v[78:79], v62 offset:8800
    s_waitcnt lgkmcnt(0)
    s_lshl_b32 s30, s36, 2
    s_add_u32 s30, s30, 0
    s_nop 0
    s_mul_i32 s31, s30, 205
    s_lshr_b32 s31, s31, 10
    s_mul_i32 s32, s31, 5
    s_sub_u32 s32, s30, s32
    s_nop 0
    s_mul_i32 s31, s31, 378880
    s_mul_i32 s33, s79, 5120
    s_add_u32 s31, s31, s33
    s_lshl_b32 s32, s32, 10
    s_add_u32 s31, s31, s32
    s_nop 0
    s_add_u32 s31, s31, 11534336
    buffer_store_dwordx4 v[64:67], v63, s[20:23], s31 offen sc1
    s_lshl_b32 s30, s36, 2
    s_add_u32 s30, s30, 1
    s_mul_i32 s31, s30, 205
    s_lshr_b32 s31, s31, 10
    s_mul_i32 s32, s31, 5
    s_sub_u32 s32, s30, s32
    s_nop 0
    s_mul_i32 s31, s31, 378880
    s_mul_i32 s33, s79, 5120
    s_add_u32 s31, s31, s33
    s_lshl_b32 s32, s32, 10
    s_add_u32 s31, s31, s32
    s_nop 0
    s_add_u32 s31, s31, 11534336
    buffer_store_dwordx4 v[68:71], v63, s[20:23], s31 offen sc1
    s_lshl_b32 s30, s36, 2
    s_add_u32 s30, s30, 2
    s_mul_i32 s31, s30, 205
    s_lshr_b32 s31, s31, 10
    s_mul_i32 s32, s31, 5
    s_sub_u32 s32, s30, s32
    s_nop 0
    s_mul_i32 s31, s31, 378880
    s_mul_i32 s33, s79, 5120
    s_add_u32 s31, s31, s33
    s_lshl_b32 s32, s32, 10
    s_add_u32 s31, s31, s32
    s_nop 0
    s_add_u32 s31, s31, 11534336
    buffer_store_dwordx4 v[72:75], v63, s[20:23], s31 offen sc1
    s_lshl_b32 s30, s36, 2
    s_add_u32 s30, s30, 3
    s_mul_i32 s31, s30, 205
    s_lshr_b32 s31, s31, 10
    s_mul_i32 s32, s31, 5
    s_sub_u32 s32, s30, s32
    s_nop 0
    s_mul_i32 s31, s31, 378880
    s_mul_i32 s33, s79, 5120
    s_add_u32 s31, s31, s33
    s_lshl_b32 s32, s32, 10
    s_add_u32 s31, s31, s32
    s_nop 0
    s_add_u32 s31, s31, 11534336
    buffer_store_dwordx4 v[76:79], v63, s[20:23], s31 offen sc1
    s_add_u32 s78, s76, 384
    s_mul_i32 s79, s78, 6554
    s_lshr_b32 s79, s79, 16
    s_mul_i32 s36, s79, 10
    s_sub_u32 s36, s78, s36
    s_nop 0
    ds_read_b64_tr_b16 v[64:65], v62 offset:12288
    ds_read_b64_tr_b16 v[66:67], v62 offset:12800
    ds_read_b64_tr_b16 v[68:69], v62 offset:12320
    ds_read_b64_tr_b16 v[70:71], v62 offset:12832
    ds_read_b64_tr_b16 v[72:73], v62 offset:12352
    ds_read_b64_tr_b16 v[74:75], v62 offset:12864
    ds_read_b64_tr_b16 v[76:77], v62 offset:12384
    ds_read_b64_tr_b16 v[78:79], v62 offset:12896
    s_waitcnt lgkmcnt(0)
    s_lshl_b32 s30, s36, 2
    s_add_u32 s30, s30, 0
    s_nop 0
    s_mul_i32 s31, s30, 205
    s_lshr_b32 s31, s31, 10
    s_mul_i32 s32, s31, 5
    s_sub_u32 s32, s30, s32
    s_nop 0
    s_mul_i32 s31, s31, 378880
    s_mul_i32 s33, s79, 5120
    s_add_u32 s31, s31, s33
    s_lshl_b32 s32, s32, 10
    s_add_u32 s31, s31, s32
    s_nop 0
    s_add_u32 s31, s31, 11534336
    buffer_store_dwordx4 v[64:67], v63, s[20:23], s31 offen sc1
    s_lshl_b32 s30, s36, 2
    s_add_u32 s30, s30, 1
    s_mul_i32 s31, s30, 205
    s_lshr_b32 s31, s31, 10
    s_mul_i32 s32, s31, 5
    s_sub_u32 s32, s30, s32
    s_nop 0
    s_mul_i32 s31, s31, 378880
    s_mul_i32 s33, s79, 5120
    s_add_u32 s31, s31, s33
    s_lshl_b32 s32, s32, 10
    s_add_u32 s31, s31, s32
    s_nop 0
    s_add_u32 s31, s31, 11534336
    buffer_store_dwordx4 v[68:71], v63, s[20:23], s31 offen sc1
    s_lshl_b32 s30, s36, 2
    s_add_u32 s30, s30, 2
    s_mul_i32 s31, s30, 205
    s_lshr_b32 s31, s31, 10
    s_mul_i32 s32, s31, 5
    s_sub_u32 s32, s30, s32
    s_nop 0
    s_mul_i32 s31, s31, 378880
    s_mul_i32 s33, s79, 5120
    s_add_u32 s31, s31, s33
    s_lshl_b32 s32, s32, 10
    s_add_u32 s31, s31, s32
    s_nop 0
    s_add_u32 s31, s31, 11534336
    buffer_store_dwordx4 v[72:75], v63, s[20:23], s31 offen sc1
    s_lshl_b32 s30, s36, 2
    s_add_u32 s30, s30, 3
    s_mul_i32 s31, s30, 205
    s_lshr_b32 s31, s31, 10
    s_mul_i32 s32, s31, 5
    s_sub_u32 s32, s30, s32
    s_nop 0
    s_mul_i32 s31, s31, 378880
    s_mul_i32 s33, s79, 5120
    s_add_u32 s31, s31, s33
    s_lshl_b32 s32, s32, 10
    s_add_u32 s31, s31, s32
    s_nop 0
    s_add_u32 s31, s31, 11534336
    buffer_store_dwordx4 v[76:79], v63, s[20:23], s31 offen sc1
    s_waitcnt vmcnt(0)
    s_nop 0
    s_add_u32 s78, s76, 512
    s_mul_i32 s79, s78, 6554
    s_lshr_b32 s79, s79, 16
    s_mul_i32 s36, s79, 10
    s_sub_u32 s36, s78, s36
    s_nop 0
    ds_read_b64_tr_b16 v[64:65], v62 offset:0
    ds_read_b64_tr_b16 v[66:67], v62 offset:512
    ds_read_b64_tr_b16 v[68:69], v62 offset:32
    ds_read_b64_tr_b16 v[70:71], v62 offset:544
    ds_read_b64_tr_b16 v[72:73], v62 offset:64
    ds_read_b64_tr_b16 v[74:75], v62 offset:576
    ds_read_b64_tr_b16 v[76:77], v62 offset:96
    ds_read_b64_tr_b16 v[78:79], v62 offset:608
    s_waitcnt lgkmcnt(0)
    s_lshl_b32 s30, s36, 2
    s_add_u32 s30, s30, 0
    s_nop 0
    s_mul_i32 s31, s30, 205
    s_lshr_b32 s31, s31, 10
    s_mul_i32 s32, s31, 5
    s_sub_u32 s32, s30, s32
    s_nop 0
    s_mul_i32 s31, s31, 378880
    s_mul_i32 s33, s79, 5120
    s_add_u32 s31, s31, s33
    s_lshl_b32 s32, s32, 10
    s_add_u32 s31, s31, s32
    s_nop 0
    s_add_u32 s31, s31, 11534336
    buffer_store_dwordx4 v[64:67], v63, s[20:23], s31 offen sc1
    s_lshl_b32 s30, s36, 2
    s_add_u32 s30, s30, 1
    s_mul_i32 s31, s30, 205
    s_lshr_b32 s31, s31, 10
    s_mul_i32 s32, s31, 5
    s_sub_u32 s32, s30, s32
    s_nop 0
    s_mul_i32 s31, s31, 378880
    s_mul_i32 s33, s79, 5120
    s_add_u32 s31, s31, s33
    s_lshl_b32 s32, s32, 10
    s_add_u32 s31, s31, s32
    s_nop 0
    s_add_u32 s31, s31, 11534336
    buffer_store_dwordx4 v[68:71], v63, s[20:23], s31 offen sc1
    s_lshl_b32 s30, s36, 2
    s_add_u32 s30, s30, 2
    s_mul_i32 s31, s30, 205
    s_lshr_b32 s31, s31, 10
    s_mul_i32 s32, s31, 5
    s_sub_u32 s32, s30, s32
    s_nop 0
    s_mul_i32 s31, s31, 378880
    s_mul_i32 s33, s79, 5120
    s_add_u32 s31, s31, s33
    s_lshl_b32 s32, s32, 10
    s_add_u32 s31, s31, s32
    s_nop 0
    s_add_u32 s31, s31, 11534336
    buffer_store_dwordx4 v[72:75], v63, s[20:23], s31 offen sc1
    s_lshl_b32 s30, s36, 2
    s_add_u32 s30, s30, 3
    s_mul_i32 s31, s30, 205
    s_lshr_b32 s31, s31, 10
    s_mul_i32 s32, s31, 5
    s_sub_u32 s32, s30, s32
    s_nop 0
    s_mul_i32 s31, s31, 378880
    s_mul_i32 s33, s79, 5120
    s_add_u32 s31, s31, s33
    s_lshl_b32 s32, s32, 10
    s_add_u32 s31, s31, s32
    s_nop 0
    s_add_u32 s31, s31, 11534336
    buffer_store_dwordx4 v[76:79], v63, s[20:23], s31 offen sc1
    s_cmp_ge_u32 s76, 100
    s_cbranch_scc1 KF_SP_NO6B
    s_nop 0
    s_add_u32 s78, s76, 640
    s_mul_i32 s79, s78, 6554
    s_lshr_b32 s79, s79, 16
    s_mul_i32 s36, s79, 10
    s_sub_u32 s36, s78, s36
    s_nop 0
    ds_read_b64_tr_b16 v[64:65], v62 offset:4096
    ds_read_b64_tr_b16 v[66:67], v62 offset:4608
    ds_read_b64_tr_b16 v[68:69], v62 offset:4128
    ds_read_b64_tr_b16 v[70:71], v62 offset:4640
    ds_read_b64_tr_b16 v[72:73], v62 offset:4160
    ds_read_b64_tr_b16 v[74:75], v62 offset:4672
    ds_read_b64_tr_b16 v[76:77], v62 offset:4192
    ds_read_b64_tr_b16 v[78:79], v62 offset:4704
    s_waitcnt lgkmcnt(0)
    s_lshl_b32 s30, s36, 2
    s_add_u32 s30, s30, 0
    s_nop 0
    s_mul_i32 s31, s30, 205
    s_lshr_b32 s31, s31, 10
    s_mul_i32 s32, s31, 5
    s_sub_u32 s32, s30, s32
    s_nop 0
    s_mul_i32 s31, s31, 378880
    s_mul_i32 s33, s79, 5120
    s_add_u32 s31, s31, s33
    s_lshl_b32 s32, s32, 10
    s_add_u32 s31, s31, s32
    s_nop 0
    s_add_u32 s31, s31, 11534336
    buffer_store_dwordx4 v[64:67], v63, s[20:23], s31 offen sc1
    s_lshl_b32 s30, s36, 2
    s_add_u32 s30, s30, 1
    s_mul_i32 s31, s30, 205
    s_lshr_b32 s31, s31, 10
    s_mul_i32 s32, s31, 5
    s_sub_u32 s32, s30, s32
    s_nop 0
    s_mul_i32 s31, s31, 378880
    s_mul_i32 s33, s79, 5120
    s_add_u32 s31, s31, s33
    s_lshl_b32 s32, s32, 10
    s_add_u32 s31, s31, s32
    s_nop 0
    s_add_u32 s31, s31, 11534336
    buffer_store_dwordx4 v[68:71], v63, s[20:23], s31 offen sc1
    s_lshl_b32 s30, s36, 2
    s_add_u32 s30, s30, 2
    s_mul_i32 s31, s30, 205
    s_lshr_b32 s31, s31, 10
    s_mul_i32 s32, s31, 5
    s_sub_u32 s32, s30, s32
    s_nop 0
    s_mul_i32 s31, s31, 378880
    s_mul_i32 s33, s79, 5120
    s_add_u32 s31, s31, s33
    s_lshl_b32 s32, s32, 10
    s_add_u32 s31, s31, s32
    s_nop 0
    s_add_u32 s31, s31, 11534336
    buffer_store_dwordx4 v[72:75], v63, s[20:23], s31 offen sc1
    s_lshl_b32 s30, s36, 2
    s_add_u32 s30, s30, 3
    s_mul_i32 s31, s30, 205
    s_lshr_b32 s31, s31, 10
    s_mul_i32 s32, s31, 5
    s_sub_u32 s32, s30, s32
    s_nop 0
    s_mul_i32 s31, s31, 378880
    s_mul_i32 s33, s79, 5120
    s_add_u32 s31, s31, s33
    s_lshl_b32 s32, s32, 10
    s_add_u32 s31, s31, s32
    s_nop 0
    s_add_u32 s31, s31, 11534336
    buffer_store_dwordx4 v[76:79], v63, s[20:23], s31 offen sc1
KF_SP_NO6B:
    s_waitcnt vmcnt(0)
    s_nop 0
    v_mov_b32 v8, 159744
    v_mov_b32 v9, 1
    s_mov_b64 exec, 1
    ds_add_rtn_u32 v9, v8, v9 offset:16
    s_waitcnt lgkmcnt(0)
    s_mov_b64 exec, -1
    v_readfirstlane_b32 s37, v9
    s_nop 0
    s_cmp_eq_u32 s37, 7
    s_cbranch_scc0 KF_ARR_S
    s_lshl_b32 s37, s27, 2
    s_nop 0
    s_add_u32 s37, s37, 23337984
    v_mov_b32 v8, s37
    v_mov_b32 v9, s4
    s_mov_b64 exec, 1
    s_nop 0
    global_store_dword v8, v9, s[62:63] sc1
    s_mov_b64 exec, -1
KF_ARR_S:
    s_cmp_lt_u32 s24, 4
    s_cbranch_scc1 KF_SP_Y
    s_branch KF_X
KF_SP_Y:
    s_lshr_b32 s37, s42, 1
    s_lshl_b32 s37, s37, 7
    s_add_u32 s37, s37, 23333888
    s_mov_b32 s38, 23337984
    v_mov_b32 v16, s37
    v_subrev_u32 v7, 0, v1
    v_cmp_gt_u32 vcc, 7, v7
    v_lshlrev_b32 v7, 2, v7
    v_add_u32 v7, s37, v7
    v_cndmask_b32 v16, v16, v7, vcc
    v_subrev_u32 v7, 8, v1
    v_cmp_gt_u32 vcc, 16, v7
    v_lshlrev_b32 v7, 2, v7
    v_add_u32 v7, s38, v7
    v_cndmask_b32 v16, v16, v7, vcc
    s_nop 0
    global_load_dword v17, v16, s[62:63] sc1
    s_waitcnt vmcnt(0)
    s_cmp_lg_u32 s25, 0
    s_cbranch_scc1 KF_GN_GS
KF_P_GS:
    v_cmp_eq_u32 vcc, s4, v17
    s_nop 0
    s_nop 0
    s_and_b32 s37, vcc_lo, 0xffff03
    s_cmp_eq_u32 s37, 0xffff03
    s_cbranch_scc1 KF_POK_GS
    s_sleep 1
    global_load_dword v17, v16, s[62:63] sc1
    s_waitcnt vmcnt(0)
    s_branch KF_P_GS
KF_POK_GS:
    v_mov_b32 v10, 159744
    v_mov_b32_e64 v11, 1
    ds_write_b32 v10, v11 offset:20
    s_branch KF_GD_GS
KF_GN_GS:
    v_cmp_eq_u32 vcc, s4, v17
    s_nop 0
    s_nop 0
    s_and_b32 s37, vcc_lo, 0xffff03
    s_cmp_eq_u32 s37, 0xffff03
    s_cbranch_scc1 KF_GD_GS
    s_nop 0
    v_mov_b32 v10, 159744
KF_GL_GS_W:
    ds_read_b32 v11, v10 offset:20
    s_waitcnt lgkmcnt(0)
    v_readfirstlane_b32 s37, v11
    s_nop 0
    s_cmp_eq_u32 s37, 1
    s_cbranch_scc1 KF_GL_GS_D
    s_sleep 3
    s_branch KF_GL_GS_W
KF_GL_GS_D:
KF_GD_GS:
    s_branch KF_Y
KF_X:
    s_setprio 3
    s_and_b32 s36, s2, 31
    s_lshr_b32 s35, s2, 5
    v_and_b32 v6, 31, v1
    v_lshrrev_b32 v5, 5, v1
    s_lshl_b32 s30, s25, 6
    v_add_u32 v0, s30, v1
    v_lshlrev_b32 v12, 4, v0
    v_mov_b32 v13, 0x40000000
    s_nop 0
    v_cmp_gt_u32 vcc, 3840, v12
    s_nop 1
    v_cndmask_b32 v13, v13, v12, vcc
    v_mul_u32_u24 v15, 2560, v5
    v_lshl_add_u32 v15, v6, 4, v15
    s_mul_i32 s34, s36, 3840
    s_add_u32 s34, s34, 20971520
    s_lshl_b32 s33, s35, 3
    s_lshl_b32 s30, s25, 1
    s_add_u32 s33, s33, s30
    s_nop 0
    s_mul_i32 s32, s36, 163840
    s_mul_i32 s30, s33, 2560
    s_add_u32 s32, s32, s30
    s_nop 0
    s_add_u32 s32, s32, 14680064
    s_lshr_b32 s30, s36, 2
    s_lshl_b32 s30, s30, 7
    s_add_u32 s30, s30, 23335936
    v_mov_b32 v8, s30
    v_subrev_u32 v7, 0, v1
    v_cmp_gt_u32 vcc, 16, v7
    v_lshlrev_b32 v7, 2, v7
    v_add_u32 v7, s30, v7
    v_cndmask_b32 v8, v8, v7, vcc
    s_lshl_b32 s31, s35, 1
    s_lshl_b32 s41, 3, s31
    s_cmp_lg_u32 s25, 0
    s_cbranch_scc1 KF_XWAIT1
    global_load_dword v9, v8, s[62:63] sc1
    s_waitcnt vmcnt(0)
KF_XP1:
    v_cmp_eq_u32 vcc, s4, v9
    s_nop 0
    s_and_b32 s37, vcc_lo, s41
    s_cmp_eq_u32 s37, s41
    s_cbranch_scc1 KF_XP1OK
    s_sleep 2
    s_nop 0
    global_load_dword v9, v8, s[62:63] sc1
    s_waitcnt vmcnt(0)
    s_branch KF_XP1
KF_XP1OK:
    s_and_b32 s37, vcc_lo, 0xffff
    s_cmp_eq_u32 s37, 0xffff
    s_cselect_b32 s31, 1, 0
    s_cbranch_scc0 KF_XSET1
    v_mov_b32 v10, 159744
    v_mov_b32_e64 v11, 1
    ds_write_b32 v10, v11 offset:8
KF_XSET1:
    v_mov_b32 v10, 159744
    v_mov_b32_e64 v11, 1
    ds_write_b32 v10, v11 offset:24
    s_branch KF_XGO1
KF_XWAIT1:
    s_nop 0
    v_mov_b32 v10, 159744
KF_XL1_W:
    ds_read_b32 v11, v10 offset:24
    s_waitcnt lgkmcnt(0)
    v_readfirstlane_b32 s37, v11
    s_nop 0
    s_cmp_eq_u32 s37, 1
    s_cbranch_scc1 KF_XL1_D
    s_sleep 3
    s_branch KF_XL1_W
KF_XL1_D:
    s_nop 0
    ds_read_b32 v11, v10 offset:8
    s_waitcnt lgkmcnt(0)
    v_readfirstlane_b32 s31, v11
KF_XGO1:
    buffer_load_dwordx4 v[96:99], v15, s[20:23], s32 offen offset:0 sc1
    buffer_load_dwordx4 v[100:103], v15, s[20:23], s32 offen offset:512 sc1
    buffer_load_dwordx4 v[104:107], v15, s[20:23], s32 offen offset:1024 sc1
    buffer_load_dwordx4 v[108:111], v15, s[20:23], s32 offen offset:1536 sc1
    buffer_load_dwordx4 v[112:115], v15, s[20:23], s32 offen offset:2048 sc1
    s_cmp_eq_u32 s31, 1
    s_cbranch_scc0 KF_XNOP
    buffer_load_dwordx4 v[16:19], v13, s[20:23], s34 offen sc1
    s_add_u32 s34, s34, 122880
    buffer_load_dwordx4 v[20:23], v13, s[20:23], s34 offen sc1
    s_add_u32 s34, s34, 122880
    buffer_load_dwordx4 v[24:27], v13, s[20:23], s34 offen sc1
    s_add_u32 s34, s34, 122880
    buffer_load_dwordx4 v[28:31], v13, s[20:23], s34 offen sc1
    s_add_u32 s34, s34, 122880
    buffer_load_dwordx4 v[32:35], v13, s[20:23], s34 offen sc1
    s_add_u32 s34, s34, 122880
    buffer_load_dwordx4 v[36:39], v13, s[20:23], s34 offen sc1
    s_add_u32 s34, s34, 122880
    buffer_load_dwordx4 v[40:43], v13, s[20:23], s34 offen sc1
    s_add_u32 s34, s34, 122880
    buffer_load_dwordx4 v[44:47], v13, s[20:23], s34 offen sc1
    s_add_u32 s34, s34, 122880
    buffer_load_dwordx4 v[48:51], v13, s[20:23], s34 offen sc1
    s_add_u32 s34, s34, 122880
    buffer_load_dwordx4 v[52:55], v13, s[20:23], s34 offen sc1
    s_add_u32 s34, s34, 122880
    buffer_load_dwordx4 v[56:59], v13, s[20:23], s34 offen sc1
    s_add_u32 s34, s34, 122880
    buffer_load_dwordx4 v[60:63], v13, s[20:23], s34 offen sc1
    s_add_u32 s34, s34, 122880
    buffer_load_dwordx4 v[64:67], v13, s[20:23], s34 offen sc1
    s_add_u32 s34, s34, 122880
    buffer_load_dwordx4 v[68:71], v13, s[20:23], s34 offen sc1
    s_add_u32 s34, s34, 122880
    buffer_load_dwordx4 v[72:75], v13, s[20:23], s34 offen sc1
    s_add_u32 s34, s34, 122880
    buffer_load_dwordx4 v[76:79], v13, s[20:23], s34 offen sc1
    s_waitcnt vmcnt(16)
    s_branch KF_XSM
KF_XNOP:
    s_waitcnt vmcnt(0)
KF_XSM:
    s_nop 0
    v_max3_f32 v160, v96, v97, v98
    v_min3_f32 v161, v96, v97, v98
    v_max3_f32 v162, v106, v107, v108
    v_min3_f32 v163, v106, v107, v108
    v_max3_f32 v160, v160, v99, v100
    v_min3_f32 v161, v161, v99, v100
    v_max3_f32 v162, v162, v109, v110
    v_min3_f32 v163, v163, v109, v110
    v_max3_f32 v160, v160, v101, v102
    v_min3_f32 v161, v161, v101, v102
    v_max3_f32 v162, v162, v111, v112
    v_min3_f32 v163, v163, v111, v112
    v_max3_f32 v160, v160, v103, v104
    v_min3_f32 v161, v161, v103, v104
    v_max3_f32 v162, v162, v113, v114
    v_min3_f32 v163, v163, v113, v114
    v_max3_f32 v160, v160, v105, v115
    v_min3_f32 v161, v161, v105, v115
    v_max_f32 v160, v160, v162
    v_min_f32 v161, v161, v163
    v_sub_f32 v116, v161, v96
    v_sub_f32 v96, v96, v160
    v_sub_f32 v117, v161, v97
    v_sub_f32 v97, v97, v160
    v_sub_f32 v118, v161, v98
    v_sub_f32 v98, v98, v160
    v_sub_f32 v119, v161, v99
    v_sub_f32 v99, v99, v160
    v_sub_f32 v120, v161, v100
    v_sub_f32 v100, v100, v160
    v_sub_f32 v121, v161, v101
    v_sub_f32 v101, v101, v160
    v_sub_f32 v122, v161, v102
    v_sub_f32 v102, v102, v160
    v_sub_f32 v123, v161, v103
    v_sub_f32 v103, v103, v160
    v_sub_f32 v124, v161, v104
    v_sub_f32 v104, v104, v160
    v_sub_f32 v125, v161, v105
    v_sub_f32 v105, v105, v160
    v_sub_f32 v126, v161, v106
    v_sub_f32 v106, v106, v160
    v_sub_f32 v127, v161, v107
    v_sub_f32 v107, v107, v160
    v_sub_f32 v128, v161, v108
    v_sub_f32 v108, v108, v160
    v_sub_f32 v129, v161, v109
    v_sub_f32 v109, v109, v160
    v_sub_f32 v130, v161, v110
    v_sub_f32 v110, v110, v160
    v_sub_f32 v131, v161, v111
    v_sub_f32 v111, v111, v160
    v_sub_f32 v132, v161, v112
    v_sub_f32 v112, v112, v160
    v_sub_f32 v133, v161, v113
    v_sub_f32 v113, v113, v160
    v_sub_f32 v134, v161, v114
    v_sub_f32 v114, v114, v160
    v_sub_f32 v135, v161, v115
    v_sub_f32 v115, v115, v160
    v_exp_f32 v116, v116
    v_exp_f32 v96, v96
    v_exp_f32 v117, v117
    v_exp_f32 v97, v97
    v_exp_f32 v118, v118
    v_exp_f32 v98, v98
    v_mov_b32 v167, v116
    v_mov_b32 v166, v96
    v_exp_f32 v119, v119
    v_exp_f32 v99, v99
    v_mov_b32 v169, v117
    v_mov_b32 v168, v97
    v_exp_f32 v120, v120
    v_exp_f32 v100, v100
    v_add_f32 v167, v167, v118
    v_add_f32 v166, v166, v98
    v_exp_f32 v121, v121
    v_exp_f32 v101, v101
    v_add_f32 v169, v169, v119
    v_add_f32 v168, v168, v99
    v_exp_f32 v122, v122
    v_exp_f32 v102, v102
    v_add_f32 v167, v167, v120
    v_add_f32 v166, v166, v100
    v_exp_f32 v123, v123
    v_exp_f32 v103, v103
    v_add_f32 v169, v169, v121
    v_add_f32 v168, v168, v101
    v_exp_f32 v124, v124
    v_exp_f32 v104, v104
    v_add_f32 v167, v167, v122
    v_add_f32 v166, v166, v102
    v_exp_f32 v125, v125
    v_exp_f32 v105, v105
    v_add_f32 v169, v169, v123
    v_add_f32 v168, v168, v103
    v_exp_f32 v126, v126
    v_exp_f32 v106, v106
    v_add_f32 v167, v167, v124
    v_add_f32 v166, v166, v104
    v_exp_f32 v127, v127
    v_exp_f32 v107, v107
    v_add_f32 v169, v169, v125
    v_add_f32 v168, v168, v105
    v_exp_f32 v128, v128
    v_exp_f32 v108, v108
    v_add_f32 v167, v167, v126
    v_add_f32 v166, v166, v106
    v_exp_f32 v129, v129
    v_exp_f32 v109, v109
    v_add_f32 v169, v169, v127
    v_add_f32 v168, v168, v107
    v_exp_f32 v130, v130
    v_exp_f32 v110, v110
    v_add_f32 v167, v167, v128
    v_add_f32 v166, v166, v108
    v_exp_f32 v131, v131
    v_exp_f32 v111, v111
    v_add_f32 v169, v169, v129
    v_add_f32 v168, v168, v109
    v_exp_f32 v132, v132
    v_exp_f32 v112, v112
    v_add_f32 v167, v167, v130
    v_add_f32 v166, v166, v110
    v_exp_f32 v133, v133
    v_exp_f32 v113, v113
    v_add_f32 v169, v169, v131
    v_add_f32 v168, v168, v111
    v_exp_f32 v134, v134
    v_exp_f32 v114, v114
    v_add_f32 v167, v167, v132
    v_add_f32 v166, v166, v112
    v_exp_f32 v135, v135
    v_exp_f32 v115, v115
    v_add_f32 v169, v169, v133
    v_add_f32 v168, v168, v113
    v_add_f32 v167, v167, v134
    v_add_f32 v166, v166, v114
    v_add_f32 v169, v169, v135
    v_add_f32 v168, v168, v115
    v_add_f32 v166, v166, v168
    v_add_f32 v167, v167, v169
    v_rcp_f32 v166, v166
    v_rcp_f32 v167, v167
    v_mul_f32 v96, v96, v166
    v_mul_f32 v97, v97, v166
    v_mul_f32 v116, v116, v167
    v_mul_f32 v117, v117, v167
    v_mul_f32 v98, v98, v166
    v_mul_f32 v99, v99, v166
    v_mul_f32 v118, v118, v167
    v_mul_f32 v119, v119, v167
    v_cvt_pk_bf16_f32 v136, v96, v97
    v_cvt_pk_bf16_f32 v146, v116, v117
    v_mul_f32 v100, v100, v166
    v_mul_f32 v101, v101, v166
    v_mul_f32 v120, v120, v167
    v_mul_f32 v121, v121, v167
    v_cvt_pk_bf16_f32 v137, v98, v99
    v_cvt_pk_bf16_f32 v147, v118, v119
    v_mul_f32 v102, v102, v166
    v_mul_f32 v103, v103, v166
    v_mul_f32 v122, v122, v167
    v_mul_f32 v123, v123, v167
    v_cvt_pk_bf16_f32 v138, v100, v101
    v_cvt_pk_bf16_f32 v148, v120, v121
    v_mul_f32 v104, v104, v166
    v_mul_f32 v105, v105, v166
    v_mul_f32 v124, v124, v167
    v_mul_f32 v125, v125, v167
    v_cvt_pk_bf16_f32 v139, v102, v103
    v_cvt_pk_bf16_f32 v149, v122, v123
    v_mul_f32 v106, v106, v166
    v_mul_f32 v107, v107, v166
    v_mul_f32 v126, v126, v167
    v_mul_f32 v127, v127, v167
    v_cvt_pk_bf16_f32 v140, v104, v105
    v_cvt_pk_bf16_f32 v150, v124, v125
    v_mul_f32 v108, v108, v166
    v_mul_f32 v109, v109, v166
    v_mul_f32 v128, v128, v167
    v_mul_f32 v129, v129, v167
    v_cvt_pk_bf16_f32 v141, v106, v107
    v_cvt_pk_bf16_f32 v151, v126, v127
    v_mul_f32 v110, v110, v166
    v_mul_f32 v111, v111, v166
    v_mul_f32 v130, v130, v167
    v_mul_f32 v131, v131, v167
    v_cvt_pk_bf16_f32 v142, v108, v109
    v_cvt_pk_bf16_f32 v152, v128, v129
    v_mul_f32 v112, v112, v166
    v_mul_f32 v113, v113, v166
    v_mul_f32 v132, v132, v167
    v_mul_f32 v133, v133, v167
    v_cvt_pk_bf16_f32 v143, v110, v111
    v_cvt_pk_bf16_f32 v153, v130, v131
    v_mul_f32 v114, v114, v166
    v_mul_f32 v115, v115, v166
    v_mul_f32 v134, v134, v167
    v_mul_f32 v135, v135, v167
    v_cvt_pk_bf16_f32 v144, v112, v113
    v_cvt_pk_bf16_f32 v154, v132, v133
    v_cvt_pk_bf16_f32 v145, v114, v115
    v_cvt_pk_bf16_f32 v155, v134, v135
    v_mov_b32 v156, 0
    v_mov_b32 v157, 0
    v_mov_b32 v158, 0
    v_mov_b32 v159, 0
    v_permlane32_swap_b32 v136, v140
    v_permlane32_swap_b32 v137, v141
    v_permlane32_swap_b32 v138, v142
    v_permlane32_swap_b32 v139, v143
    v_permlane32_swap_b32 v144, v148
    v_permlane32_swap_b32 v145, v149
    v_permlane32_swap_b32 v146, v150
    v_permlane32_swap_b32 v147, v151
    v_permlane32_swap_b32 v152, v156
    v_permlane32_swap_b32 v153, v157
    v_permlane32_swap_b32 v154, v158
    v_permlane32_swap_b32 v155, v159
    s_cmp_eq_u32 s31, 1
    s_cbranch_scc1 KF_XGO
    s_cmp_lg_u32 s25, 0
    s_cbranch_scc1 KF_XWAIT
    global_load_dword v9, v8, s[62:63] sc1
    s_waitcnt vmcnt(0)
KF_P_XK:
    v_cmp_eq_u32 vcc, s4, v9
    s_nop 0
    s_nop 0
    s_and_b32 s37, vcc_lo, 0xffff
    s_cmp_eq_u32 s37, 0xffff
    s_cbranch_scc1 KF_POK_XK
    s_sleep 2
    global_load_dword v9, v8, s[62:63] sc1
    s_waitcnt vmcnt(0)
    s_branch KF_P_XK
KF_POK_XK:
    v_mov_b32 v10, 159744
    v_mov_b32_e64 v11, 1
    ds_write_b32 v10, v11 offset:8
    s_branch KF_XGO2
KF_XWAIT:
    s_nop 0
    v_mov_b32 v10, 159744
KF_XL_W:
    ds_read_b32 v11, v10 offset:8
    s_waitcnt lgkmcnt(0)
    v_readfirstlane_b32 s37, v11
    s_nop 0
    s_cmp_eq_u32 s37, 1
    s_cbranch_scc1 KF_XL_D
    s_sleep 3
    s_branch KF_XL_W
KF_XL_D:
KF_XGO2:
    s_nop 0
    buffer_load_dwordx4 v[16:19], v13, s[20:23], s34 offen sc1
    s_add_u32 s34, s34, 122880
    buffer_load_dwordx4 v[20:23], v13, s[20:23], s34 offen sc1
    s_add_u32 s34, s34, 122880
    buffer_load_dwordx4 v[24:27], v13, s[20:23], s34 offen sc1
    s_add_u32 s34, s34, 122880
    buffer_load_dwordx4 v[28:31], v13, s[20:23], s34 offen sc1
    s_add_u32 s34, s34, 122880
    buffer_load_dwordx4 v[32:35], v13, s[20:23], s34 offen sc1
    s_add_u32 s34, s34, 122880
    buffer_load_dwordx4 v[36:39], v13, s[20:23], s34 offen sc1
    s_add_u32 s34, s34, 122880
    buffer_load_dwordx4 v[40:43], v13, s[20:23], s34 offen sc1
    s_add_u32 s34, s34, 122880
    buffer_load_dwordx4 v[44:47], v13, s[20:23], s34 offen sc1
    s_add_u32 s34, s34, 122880
    buffer_load_dwordx4 v[48:51], v13, s[20:23], s34 offen sc1
    s_add_u32 s34, s34, 122880
    buffer_load_dwordx4 v[52:55], v13, s[20:23], s34 offen sc1
    s_add_u32 s34, s34, 122880
    buffer_load_dwordx4 v[56:59], v13, s[20:23], s34 offen sc1
    s_add_u32 s34, s34, 122880
    buffer_load_dwordx4 v[60:63], v13, s[20:23], s34 offen sc1
    s_add_u32 s34, s34, 122880
    buffer_load_dwordx4 v[64:67], v13, s[20:23], s34 offen sc1
    s_add_u32 s34, s34, 122880
    buffer_load_dwordx4 v[68:71], v13, s[20:23], s34 offen sc1
    s_add_u32 s34, s34, 122880
    buffer_load_dwordx4 v[72:75], v13, s[20:23], s34 offen sc1
    s_add_u32 s34, s34, 122880
    buffer_load_dwordx4 v[76:79], v13, s[20:23], s34 offen sc1
KF_XGO:
    v_lshrrev_b32 v7, 2, v6
    v_and_b32 v12, 3, v6
    v_and_b32 v13, 1, v7
    v_lshlrev_b32 v13, 1, v13
    v_bfe_u32 v14, v7, 1, 1
    v_or_b32 v13, v13, v14
    v_cmp_eq_u32 vcc, 4, v7
    s_nop 1
    s_nop 0
    v_cndmask_b32 v13, v13, 4, vcc
    v_lshl_add_u32 v13, v13, 2, v12
    v_mul_u32_u24 v13, 80, v13
    v_mov_b32 v14, 1680
    v_cmp_ge_u32 vcc, 4, v7
    s_nop 1
    v_cndmask_b32 v13, v14, v13, vcc
    v_and_b32 v15, 27, v6
    v_cmp_eq_u32 vcc, 24, v15
    s_nop 0
    v_mov_b32 v15, 1600
    s_nop 0
    v_cndmask_b32 v13, v13, v15, vcc
    v_lshl_add_u32 v12, v5, 4, v13
    v_cmp_eq_u32 vcc, 1680, v13
    s_nop 1
    v_cndmask_b32 v12, v12, v14, vcc
    v_add_u32 v13, 64, v13
    v_cndmask_b32 v13, v13, v14, vcc
    v_cmp_eq_u32 vcc, 0, v5
    s_nop 1
    v_cndmask_b32 v13, v14, v13, vcc
    s_nop 0
    v_add_u32 v12, 155648, v12
    v_add_u32 v13, 155648, v13
    s_lshr_b32 s32, s36, 1
    s_and_b32 s31, s36, 1
    s_mul_i32 s32, s32, 5
    s_lshl_b32 s34, s31, 1
    s_add_u32 s34, s34, s32
    s_lshr_b32 s38, s34, 2
    s_lshl_b32 s38, s38, 12
    s_and_b32 s30, s34, 3
    s_lshl_b32 s30, s30, 8
    s_add_u32 s38, s38, s30
    s_add_u32 s34, s34, 1
    s_lshr_b32 s39, s34, 2
    s_lshl_b32 s39, s39, 12
    s_and_b32 s30, s34, 3
    s_lshl_b32 s30, s30, 8
    s_add_u32 s39, s39, s30
    s_add_u32 s34, s32, 4
    s_lshr_b32 s40, s34, 2
    s_lshl_b32 s40, s40, 12
    s_and_b32 s30, s34, 3
    s_lshl_b32 s30, s30, 8
    s_add_u32 s40, s40, s30
    s_lshl_b32 s31, s31, 3
    s_add_u32 s40, s40, s31
    v_mov_b32 v14, s38
    v_mov_b32 v15, s39
    v_cmp_eq_u32 vcc, 0, v5
    s_nop 1
    v_cndmask_b32 v14, v15, v14, vcc
    v_and_b32 v15, 15, v6
    v_lshlrev_b32 v15, 4, v15
    v_lshrrev_b32 v7, 4, v6
    v_lshl_add_u32 v15, v7, 10, v15
    v_add_u32 v14, v14, v15
    v_add_u32 v15, s40, v15
    v_mov_b32 v7, 0x40000000
    v_cndmask_b32 v15, v7, v15, vcc
    v_lshrrev_b32_e64 v80, 6, v0
    v_bfe_u32 v81, v0, 5, 1
    v_and_b32_e64 v82, 31, v0
    v_subrev_u32 v83, 192, v0
    v_lshrrev_b32_e64 v84, 4, v83
    v_bfe_u32 v85, v83, 3, 1
    v_and_b32 v86, 7, v83
    v_add_u32 v86, 32, v86
    v_cmp_le_u32 vcc, 192, v0
    s_nop 1
    v_cndmask_b32 v80, v80, v84, vcc
    v_cndmask_b32 v81, v81, v85, vcc
    v_cndmask_b32 v82, v82, v86, vcc
    v_lshl_add_u32 v80, v80, 1, v81
    v_add_u32 v83, 1, v80
    v_cmp_eq_u32 vcc, 4, v80
    s_nop 1
    s_nop 0
    v_cndmask_b32 v83, v83, 0, vcc
    v_cmp_eq_u32 vcc, 5, v80
    s_nop 1
    v_cndmask_b32 v83, v83, 5, vcc
    s_and_b32 s38, s36, 1
    s_cmp_eq_u32 s38, 1
    s_cselect_b64 vcc, -1, 0
    v_cndmask_b32 v83, v83, v80, vcc
    v_mul_u32_u24 v84, 320, v83
    v_lshl_add_u32 v84, v82, 1, v84
    v_add_u32 v84, 155648, v84
    v_mov_b32 v86, 157696
    v_cmp_eq_u32 vcc, 5, v80
    s_nop 1
    v_cndmask_b32 v85, v84, v86, vcc
    s_nop 0
    v_cmp_le_u32 vcc, 240, v0
    s_nop 1
    v_cndmask_b32 v84, v84, v86, vcc
    v_cndmask_b32 v85, v85, v86, vcc
    v_mov_b32 v90, 0
    v_mov_b32 v91, 0
    v_lshlrev_b32 v89, 3, v1
    v_add_u32 v89, 157328, v89
    v_cmp_gt_u32 vcc, 46, v1
    s_nop 1
    v_cndmask_b32 v89, v86, v89, vcc
    s_nop 0
    ds_write_b64 v89, v[90:91]
    s_waitcnt vmcnt(0)
    v_add_f32 v16, v16, v20
    v_add_f32 v17, v17, v21
    v_add_f32 v18, v18, v22
    v_add_f32 v19, v19, v23
    v_add_f32 v16, v16, v24
    v_add_f32 v17, v17, v25
    v_add_f32 v18, v18, v26
    v_add_f32 v19, v19, v27
    v_add_f32 v16, v16, v28
    v_add_f32 v17, v17, v29
    v_add_f32 v18, v18, v30
    v_add_f32 v19, v19, v31
    v_add_f32 v16, v16, v32
    v_add_f32 v17, v17, v33
    v_add_f32 v18, v18, v34
    v_add_f32 v19, v19, v35
    v_add_f32 v16, v16, v36
    v_add_f32 v17, v17, v37
    v_add_f32 v18, v18, v38
    v_add_f32 v19, v19, v39
    v_add_f32 v16, v16, v40
    v_add_f32 v17, v17, v41
    v_add_f32 v18, v18, v42
    v_add_f32 v19, v19, v43
    v_add_f32 v16, v16, v44
    v_add_f32 v17, v17, v45
    v_add_f32 v18, v18, v46
    v_add_f32 v19, v19, v47
    v_add_f32 v16, v16, v48
    v_add_f32 v17, v17, v49
    v_add_f32 v18, v18, v50
    v_add_f32 v19, v19, v51
    v_add_f32 v16, v16, v52
    v_add_f32 v17, v17, v53
    v_add_f32 v18, v18, v54
    v_add_f32 v19, v19, v55
    v_add_f32 v16, v16, v56
    v_add_f32 v17, v17, v57
    v_add_f32 v18, v18, v58
    v_add_f32 v19, v19, v59
    v_add_f32 v16, v16, v60
    v_add_f32 v17, v17, v61
    v_add_f32 v18, v18, v62
    v_add_f32 v19, v19, v63
    v_add_f32 v16, v16, v64
    v_add_f32 v17, v17, v65
    v_add_f32 v18, v18, v66
    v_add_f32 v19, v19, v67
    v_add_f32 v16, v16, v68
    v_add_f32 v17, v17, v69
    v_add_f32 v18, v18, v70
    v_add_f32 v19, v19, v71
    v_add_f32 v16, v16, v72
    v_add_f32 v17, v17, v73
    v_add_f32 v18, v18, v74
    v_add_f32 v19, v19, v75
    v_add_f32 v16, v16, v76
    v_add_f32 v17, v17, v77
    v_add_f32 v18, v18, v78
    v_add_f32_e64 v19, v19, v79
    v_cvt_pk_bf16_f32 v16, v16, v17
    v_cvt_pk_bf16_f32 v17, v18, v19
    ds_write_b16 v84, v16
    ds_write_b16_d16_hi v85, v16 offset:80
    ds_write_b16 v85, v17 offset:160
    ds_write_b16_d16_hi v85, v17 offset:240
    s_waitcnt lgkmcnt(0)
    s_nop 0
    v_mov_b32 v10, 159744
    v_mov_b32 v8, 1
    s_mov_b64 exec, 1
    ds_add_u32 v10, v8 offset:0
    s_mov_b64 exec, -1
KF_HSPIN:
    s_nop 0
    ds_read_b32 v9, v10 offset:0
    s_waitcnt lgkmcnt(0)
    v_readfirstlane_b32 s30, v9
    s_nop 0
    s_cmp_eq_u32 s30, 4
    s_cbranch_scc1 KF_HGO
    s_sleep 1
    s_branch KF_HSPIN
KF_HGO:
    s_nop 0
    ds_read_b128 v[172:175], v12
    ds_read_b128 v[176:179], v12 offset:32
    ds_read_b128 v[180:183], v13
    s_waitcnt lgkmcnt(0)
    s_nop 0
    v_mfma_f32_32x32x16_bf16 v[16:31], v[172:175], v[136:139], 0
    v_mfma_f32_32x32x16_bf16 v[16:31], v[176:179], v[144:147], v[16:31]
    v_mfma_f32_32x32x16_bf16 v[16:31], v[180:183], v[152:155], v[16:31]
    v_mfma_f32_32x32x16_bf16 v[32:47], v[172:175], v[140:143], 0
    v_mfma_f32_32x32x16_bf16 v[32:47], v[176:179], v[148:151], v[32:47]
    v_mfma_f32_32x32x16_bf16 v[32:47], v[180:183], v[156:159], v[32:47]
    s_lshr_b32 s30, s33, 1
    s_nop 0
    s_mul_i32 s30, s30, 303104
    s_nop 6
    s_nop 0
    v_add_f32 v28, 0x358637bd, v28
    v_rcp_f32 v28, v28
    s_nop 0
    v_mul_f32 v16, v16, v28
    v_mul_f32 v17, v17, v28
    v_mul_f32 v18, v18, v28
    v_mul_f32 v19, v19, v28
    v_mul_f32 v20, v20, v28
    v_mul_f32 v21, v21, v28
    v_mul_f32 v22, v22, v28
    v_mul_f32 v23, v23, v28
    v_mul_f32 v24, v24, v28
    v_mul_f32 v25, v25, v28
    v_mul_f32 v26, v26, v28
    v_mul_f32 v27, v27, v28
    v_cvt_pk_bf16_f32 v48, v16, v17
    v_cvt_pk_bf16_f32 v49, v18, v19
    v_cvt_pk_bf16_f32 v50, v20, v21
    v_cvt_pk_bf16_f32 v51, v22, v23
    v_cvt_pk_bf16_f32 v52, v24, v25
    v_cvt_pk_bf16_f32 v53, v26, v27
    s_add_u32 s32, s30, 1269760
    buffer_store_dwordx4 v[48:51], v14, s[20:23], s32 offen sc1
    buffer_store_dwordx2 v[52:53], v15, s[20:23], s32 offen sc1
    v_add_f32 v44, 0x358637bd, v44
    v_rcp_f32 v44, v44
    s_nop 0
    v_mul_f32 v32, v32, v44
    v_mul_f32 v33, v33, v44
    v_mul_f32 v34, v34, v44
    v_mul_f32 v35, v35, v44
    v_mul_f32 v36, v36, v44
    v_mul_f32 v37, v37, v44
    v_mul_f32 v38, v38, v44
    v_mul_f32 v39, v39, v44
    v_mul_f32 v40, v40, v44
    v_mul_f32 v41, v41, v44
    v_mul_f32 v42, v42, v44
    v_mul_f32 v43, v43, v44
    v_cvt_pk_bf16_f32 v56, v32, v33
    v_cvt_pk_bf16_f32 v57, v34, v35
    v_cvt_pk_bf16_f32 v58, v36, v37
    v_cvt_pk_bf16_f32 v59, v38, v39
    v_cvt_pk_bf16_f32 v60, v40, v41
    v_cvt_pk_bf16_f32 v61, v42, v43
    s_add_u32 s32, s30, 1271808
    buffer_store_dwordx4 v[56:59], v14, s[20:23], s32 offen sc1
    buffer_store_dwordx2 v[60:61], v15, s[20:23], s32 offen sc1
    s_waitcnt vmcnt(0)
    s_mov_b64 exec, 1
    ds_add_rtn_u32 v9, v10, v8 offset:4
    s_waitcnt lgkmcnt(0)
    s_mov_b64 exec, -1
    v_readfirstlane_b32 s30, v9
    s_nop 0
    s_cmp_eq_u32 s30, 3
    s_cbranch_scc0 KF_XEND
    s_lshl_b32 s30, s35, 7
    s_lshl_b32 s31, s36, 2
    s_add_u32 s30, s30, s31
    s_nop 0
    s_add_u32 s30, s30, 23336960
    v_mov_b32 v12, s30
    v_mov_b32 v13, s4
    s_mov_b64 exec, 1
    s_nop 0
    global_store_dword v12, v13, s[62:63] sc1
    s_mov_b64 exec, -1
KF_XEND:
    s_endpgm
KF_Y:
    s_setprio 0
    v_lshlrev_b32 v2, 4, v1
    v_add_u32 v3, 4096, v2
    s_add_u32 s30, s25, 0
    s_and_b32 s30, s30, 3
    s_lshl_b32 s30, s30, 10
    v_add_u32 v250, s30, v2
    s_add_u32 s30, s25, 1
    s_and_b32 s30, s30, 3
    s_lshl_b32 s30, s30, 10
    v_add_u32 v251, s30, v2
    s_add_u32 s30, s25, 2
    s_and_b32 s30, s30, 3
    s_lshl_b32 s30, s30, 10
    v_add_u32 v252, s30, v2
    s_add_u32 s30, s25, 3
    s_and_b32 s30, s30, 3
    s_lshl_b32 s30, s30, 10
    v_add_u32 v253, s30, v2
    s_mul_i32 s30, s42, 303104
    s_add_u32 s30, s30, 1048576
    s_add_u32 s64, s62, s30
    s_addc_u32 s65, s63, 0
    s_and_b32 s65, s65, 0xffff
    s_mov_b32 s66, 303104
    s_mov_b32 s67, 0x20000
    s_mul_i32 s30, s43, 378880
    s_add_u32 s30, s30, 11534336
    s_add_u32 s68, s62, s30
    s_addc_u32 s69, s63, 0
    s_and_b32 s69, s69, 0xffff
    s_mov_b32 s70, 378880
    s_mov_b32 s71, 0x20000
    s_mov_b32 s8, s44
    s_nop 0
    s_and_b32 s9, s45, 0xffff
    s_mov_b32 s10, 2621440
    s_mov_b32 s11, 0x20000
    s_mov_b32 s12, s58
    s_nop 0
    s_and_b32 s13, s59, 0xffff
    s_mov_b32 s14, 2621440
    s_mov_b32 s15, 0x20000
    s_lshr_b32 s30, s42, 2
    s_lshl_b32 s30, s30, 7
    s_add_u32 s30, s30, 23336960
    v_mov_b32 v254, s30
    v_subrev_u32 v7, 0, v1
    v_cmp_gt_u32 vcc, 32, v7
    v_lshlrev_b32 v7, 2, v7
    v_add_u32 v7, s30, v7
    v_cndmask_b32 v254, v254, v7, vcc
    v_and_b32 v4, 15, v1
    s_lshl_b32 s30, s42, 6
    s_lshl_b32 s32, s25, 4
    s_add_u32 s30, s30, s32
    v_add_u32_e64 v4, s30, v4
    v_mul_u32_u24 v4, 1280, v4
    v_lshrrev_b32_e64 v7, 4, v1
    v_lshl_add_u32 v4, v7, 3, v4
    s_mul_i32 s30, s43, 160
    v_add_u32 v4, s30, v4
    s_lshr_b32 s37, s42, 1
    s_lshl_b32 s37, s37, 7
    s_nop 0
    s_add_u32 s38, s37, 23333888
    v_mov_b32 v12, s38
    v_subrev_u32 v7, 0, v1
    v_cmp_gt_u32 vcc, 7, v7
    v_lshlrev_b32 v7, 2, v7
    v_add_u32 v7, s38, v7
    v_cndmask_b32 v12, v12, v7, vcc
    s_add_u32 s30, s25, 0
    s_nop 0
    s_mul_i32 s31, s30, 5120
    s_lshl_b32 s30, s30, 12
    s_nop 0
    buffer_load_dwordx4 v[96:99], v2, s[68:71], s31 offen offset:0 sc1
    buffer_load_dwordx4 v[100:103], v2, s[68:71], s31 offen offset:1024 sc1
    buffer_load_dwordx4 v[104:107], v2, s[68:71], s31 offen offset:2048 sc1
    buffer_load_dwordx4 v[108:111], v2, s[68:71], s31 offen offset:3072 sc1
    buffer_load_dwordx4 v[112:115], v3, s[68:71], s31 offen sc1
    buffer_load_dwordx4 v[116:119], v250, s[64:67], s30 offen sc1
    buffer_load_dwordx4 v[120:123], v251, s[64:67], s30 offen sc1
    buffer_load_dwordx4 v[124:127], v252, s[64:67], s30 offen sc1
    buffer_load_dwordx4 v[128:131], v253, s[64:67], s30 offen sc1
    s_add_u32 s30, s25, 4
    s_nop 0
    s_mul_i32 s31, s30, 5120
    s_lshl_b32 s30, s30, 12
    s_nop 0
    buffer_load_dwordx4 v[132:135], v2, s[68:71], s31 offen offset:0 sc1
    buffer_load_dwordx4 v[136:139], v2, s[68:71], s31 offen offset:1024 sc1
    buffer_load_dwordx4 v[140:143], v2, s[68:71], s31 offen offset:2048 sc1
    buffer_load_dwordx4 v[144:147], v2, s[68:71], s31 offen offset:3072 sc1
    buffer_load_dwordx4 v[148:151], v3, s[68:71], s31 offen sc1
    buffer_load_dwordx4 v[152:155], v250, s[64:67], s30 offen sc1
    buffer_load_dwordx4 v[156:159], v251, s[64:67], s30 offen sc1
    buffer_load_dwordx4 v[160:163], v252, s[64:67], s30 offen sc1
    buffer_load_dwordx4 v[164:167], v253, s[64:67], s30 offen sc1
    s_add_u32 s30, s25, 8
    s_nop 0
    s_mul_i32 s31, s30, 5120
    s_lshl_b32 s30, s30, 12
    s_nop 0
    buffer_load_dwordx4 v[168:171], v2, s[68:71], s31 offen offset:0 sc1
    buffer_load_dwordx4 v[172:175], v2, s[68:71], s31 offen offset:1024 sc1
    buffer_load_dwordx4 v[176:179], v2, s[68:71], s31 offen offset:2048 sc1
    buffer_load_dwordx4 v[180:183], v2, s[68:71], s31 offen offset:3072 sc1
    buffer_load_dwordx4 v[184:187], v3, s[68:71], s31 offen sc1
    buffer_load_dwordx4 v[188:191], v250, s[64:67], s30 offen sc1
    buffer_load_dwordx4 v[192:195], v251, s[64:67], s30 offen sc1
    buffer_load_dwordx4 v[196:199], v252, s[64:67], s30 offen sc1
    buffer_load_dwordx4 v[200:203], v253, s[64:67], s30 offen sc1
    global_load_dword v13, v12, s[62:63] sc1
    s_add_u32 s30, s25, 12
    s_nop 0
    s_mul_i32 s31, s30, 5120
    s_lshl_b32 s30, s30, 12
    s_nop 0
    buffer_load_dwordx4 v[204:207], v2, s[68:71], s31 offen offset:0 sc1
    buffer_load_dwordx4 v[208:211], v2, s[68:71], s31 offen offset:1024 sc1
    buffer_load_dwordx4 v[212:215], v2, s[68:71], s31 offen offset:2048 sc1
    buffer_load_dwordx4 v[216:219], v2, s[68:71], s31 offen offset:3072 sc1
    buffer_load_dwordx4 v[220:223], v3, s[68:71], s31 offen sc1
    buffer_load_dwordx4 v[224:227], v250, s[64:67], s30 offen sc1
    buffer_load_dwordx4 v[228:231], v251, s[64:67], s30 offen sc1
    buffer_load_dwordx4 v[232:235], v252, s[64:67], s30 offen sc1
    buffer_load_dwordx4 v[236:239], v253, s[64:67], s30 offen sc1
    s_waitcnt vmcnt(28)
    s_waitcnt vmcnt(9)
KF_P_YH2:
    v_cmp_eq_u32 vcc, s4, v13
    s_nop 0
    s_and_b32 s37, vcc_lo, 0x7f
    s_cmp_eq_u32 s37, 0x7f
    s_cbranch_scc1 KF_POK_YH2
    s_sleep 6
    global_load_dword v13, v12, s[62:63] sc1
    s_waitcnt vmcnt(0)
    s_branch KF_P_YH2
KF_POK_YH2:
    s_add_u32 s30, s25, 16
    s_mul_i32 s31, s30, 5120
    s_lshl_b32 s30, s30, 12
    v_mfma_f32_16x16x32_bf16 v[16:19], v[96:99], v[116:119], 0
    v_mfma_f32_16x16x32_bf16 v[36:39], v[96:99], v[120:123], 0
    v_mfma_f32_16x16x32_bf16 v[56:59], v[96:99], v[124:127], 0
    v_mfma_f32_16x16x32_bf16 v[76:79], v[96:99], v[128:131], 0
    buffer_load_dwordx4 v[96:99], v2, s[68:71], s31 offen offset:0 sc1
    v_mfma_f32_16x16x32_bf16 v[20:23], v[100:103], v[116:119], 0
    v_mfma_f32_16x16x32_bf16 v[40:43], v[100:103], v[120:123], 0
    v_mfma_f32_16x16x32_bf16 v[60:63], v[100:103], v[124:127], 0
    v_mfma_f32_16x16x32_bf16 v[80:83], v[100:103], v[128:131], 0
    buffer_load_dwordx4 v[100:103], v2, s[68:71], s31 offen offset:1024 sc1
    v_mfma_f32_16x16x32_bf16 v[24:27], v[104:107], v[116:119], 0
    v_mfma_f32_16x16x32_bf16 v[44:47], v[104:107], v[120:123], 0
    v_mfma_f32_16x16x32_bf16 v[64:67], v[104:107], v[124:127], 0
    v_mfma_f32_16x16x32_bf16 v[84:87], v[104:107], v[128:131], 0
    buffer_load_dwordx4 v[104:107], v2, s[68:71], s31 offen offset:2048 sc1
    v_mfma_f32_16x16x32_bf16 v[28:31], v[108:111], v[116:119], 0
    v_mfma_f32_16x16x32_bf16 v[48:51], v[108:111], v[120:123], 0
    v_mfma_f32_16x16x32_bf16 v[68:71], v[108:111], v[124:127], 0
    v_mfma_f32_16x16x32_bf16 v[88:91], v[108:111], v[128:131], 0
    buffer_load_dwordx4 v[108:111], v2, s[68:71], s31 offen offset:3072 sc1
    v_mfma_f32_16x16x32_bf16 v[32:35], v[112:115], v[116:119], 0
    v_mfma_f32_16x16x32_bf16 v[52:55], v[112:115], v[120:123], 0
    v_mfma_f32_16x16x32_bf16 v[72:75], v[112:115], v[124:127], 0
    v_mfma_f32_16x16x32_bf16 v[92:95], v[112:115], v[128:131], 0
    buffer_load_dwordx4 v[112:115], v3, s[68:71], s31 offen sc1
    buffer_load_dwordx4 v[116:119], v250, s[64:67], s30 offen sc1
    buffer_load_dwordx4 v[120:123], v251, s[64:67], s30 offen sc1
    buffer_load_dwordx4 v[124:127], v252, s[64:67], s30 offen sc1
    buffer_load_dwordx4 v[128:131], v253, s[64:67], s30 offen sc1
    s_add_u32 s30, s25, 20
    s_mul_i32 s31, s30, 5120
    s_lshl_b32 s30, s30, 12
    v_mfma_f32_16x16x32_bf16 v[16:19], v[132:135], v[152:155], v[16:19]
    v_mfma_f32_16x16x32_bf16 v[36:39], v[132:135], v[156:159], v[36:39]
    v_mfma_f32_16x16x32_bf16 v[56:59], v[132:135], v[160:163], v[56:59]
    v_mfma_f32_16x16x32_bf16 v[76:79], v[132:135], v[164:167], v[76:79]
    buffer_load_dwordx4 v[132:135], v2, s[68:71], s31 offen offset:0 sc1
    v_mfma_f32_16x16x32_bf16 v[20:23], v[136:139], v[152:155], v[20:23]
    v_mfma_f32_16x16x32_bf16 v[40:43], v[136:139], v[156:159], v[40:43]
    v_mfma_f32_16x16x32_bf16 v[60:63], v[136:139], v[160:163], v[60:63]
    v_mfma_f32_16x16x32_bf16 v[80:83], v[136:139], v[164:167], v[80:83]
    buffer_load_dwordx4 v[136:139], v2, s[68:71], s31 offen offset:1024 sc1
    v_mfma_f32_16x16x32_bf16 v[24:27], v[140:143], v[152:155], v[24:27]
    v_mfma_f32_16x16x32_bf16 v[44:47], v[140:143], v[156:159], v[44:47]
    v_mfma_f32_16x16x32_bf16 v[64:67], v[140:143], v[160:163], v[64:67]
    v_mfma_f32_16x16x32_bf16 v[84:87], v[140:143], v[164:167], v[84:87]
    buffer_load_dwordx4 v[140:143], v2, s[68:71], s31 offen offset:2048 sc1
    v_mfma_f32_16x16x32_bf16 v[28:31], v[144:147], v[152:155], v[28:31]
    v_mfma_f32_16x16x32_bf16 v[48:51], v[144:147], v[156:159], v[48:51]
    v_mfma_f32_16x16x32_bf16 v[68:71], v[144:147], v[160:163], v[68:71]
    v_mfma_f32_16x16x32_bf16 v[88:91], v[144:147], v[164:167], v[88:91]
    buffer_load_dwordx4 v[144:147], v2, s[68:71], s31 offen offset:3072 sc1
    v_mfma_f32_16x16x32_bf16 v[32:35], v[148:151], v[152:155], v[32:35]
    v_mfma_f32_16x16x32_bf16 v[52:55], v[148:151], v[156:159], v[52:55]
    v_mfma_f32_16x16x32_bf16 v[72:75], v[148:151], v[160:163], v[72:75]
    v_mfma_f32_16x16x32_bf16 v[92:95], v[148:151], v[164:167], v[92:95]
    buffer_load_dwordx4 v[148:151], v3, s[68:71], s31 offen sc1
    buffer_load_dwordx4 v[152:155], v250, s[64:67], s30 offen sc1
    buffer_load_dwordx4 v[156:159], v251, s[64:67], s30 offen sc1
    buffer_load_dwordx4 v[160:163], v252, s[64:67], s30 offen sc1
    buffer_load_dwordx4 v[164:167], v253, s[64:67], s30 offen sc1
    s_add_u32 s30, s25, 24
    s_mul_i32 s31, s30, 5120
    s_lshl_b32 s30, s30, 12
    v_mfma_f32_16x16x32_bf16 v[16:19], v[168:171], v[188:191], v[16:19]
    v_mfma_f32_16x16x32_bf16 v[36:39], v[168:171], v[192:195], v[36:39]
    v_mfma_f32_16x16x32_bf16 v[56:59], v[168:171], v[196:199], v[56:59]
    v_mfma_f32_16x16x32_bf16 v[76:79], v[168:171], v[200:203], v[76:79]
    buffer_load_dwordx4 v[168:171], v2, s[68:71], s31 offen offset:0 sc1
    v_mfma_f32_16x16x32_bf16 v[20:23], v[172:175], v[188:191], v[20:23]
    v_mfma_f32_16x16x32_bf16 v[40:43], v[172:175], v[192:195], v[40:43]
    v_mfma_f32_16x16x32_bf16 v[60:63], v[172:175], v[196:199], v[60:63]
    v_mfma_f32_16x16x32_bf16 v[80:83], v[172:175], v[200:203], v[80:83]
    buffer_load_dwordx4 v[172:175], v2, s[68:71], s31 offen offset:1024 sc1
    v_mfma_f32_16x16x32_bf16 v[24:27], v[176:179], v[188:191], v[24:27]
    v_mfma_f32_16x16x32_bf16 v[44:47], v[176:179], v[192:195], v[44:47]
    v_mfma_f32_16x16x32_bf16 v[64:67], v[176:179], v[196:199], v[64:67]
    v_mfma_f32_16x16x32_bf16 v[84:87], v[176:179], v[200:203], v[84:87]
    buffer_load_dwordx4 v[176:179], v2, s[68:71], s31 offen offset:2048 sc1
    v_mfma_f32_16x16x32_bf16 v[28:31], v[180:183], v[188:191], v[28:31]
    v_mfma_f32_16x16x32_bf16 v[48:51], v[180:183], v[192:195], v[48:51]
    v_mfma_f32_16x16x32_bf16 v[68:71], v[180:183], v[196:199], v[68:71]
    v_mfma_f32_16x16x32_bf16 v[88:91], v[180:183], v[200:203], v[88:91]
    buffer_load_dwordx4 v[180:183], v2, s[68:71], s31 offen offset:3072 sc1
    v_mfma_f32_16x16x32_bf16 v[32:35], v[184:187], v[188:191], v[32:35]
    v_mfma_f32_16x16x32_bf16 v[52:55], v[184:187], v[192:195], v[52:55]
    v_mfma_f32_16x16x32_bf16 v[72:75], v[184:187], v[196:199], v[72:75]
    v_mfma_f32_16x16x32_bf16 v[92:95], v[184:187], v[200:203], v[92:95]
    buffer_load_dwordx4 v[184:187], v3, s[68:71], s31 offen sc1
    buffer_load_dwordx4 v[188:191], v250, s[64:67], s30 offen sc1
    buffer_load_dwordx4 v[192:195], v251, s[64:67], s30 offen sc1
    buffer_load_dwordx4 v[196:199], v252, s[64:67], s30 offen sc1
    buffer_load_dwordx4 v[200:203], v253, s[64:67], s30 offen sc1
    s_waitcnt vmcnt(27)
    s_add_u32 s30, s25, 28
    s_mul_i32 s31, s30, 5120
    s_lshl_b32 s30, s30, 12
    v_mfma_f32_16x16x32_bf16 v[16:19], v[204:207], v[224:227], v[16:19]
    v_mfma_f32_16x16x32_bf16 v[36:39], v[204:207], v[228:231], v[36:39]
    v_mfma_f32_16x16x32_bf16 v[56:59], v[204:207], v[232:235], v[56:59]
    v_mfma_f32_16x16x32_bf16 v[76:79], v[204:207], v[236:239], v[76:79]
    buffer_load_dwordx4 v[204:207], v2, s[68:71], s31 offen offset:0 sc1
    v_mfma_f32_16x16x32_bf16 v[20:23], v[208:211], v[224:227], v[20:23]
    v_mfma_f32_16x16x32_bf16 v[40:43], v[208:211], v[228:231], v[40:43]
    v_mfma_f32_16x16x32_bf16 v[60:63], v[208:211], v[232:235], v[60:63]
    v_mfma_f32_16x16x32_bf16 v[80:83], v[208:211], v[236:239], v[80:83]
    buffer_load_dwordx4 v[208:211], v2, s[68:71], s31 offen offset:1024 sc1
    v_mfma_f32_16x16x32_bf16 v[24:27], v[212:215], v[224:227], v[24:27]
    v_mfma_f32_16x16x32_bf16 v[44:47], v[212:215], v[228:231], v[44:47]
    v_mfma_f32_16x16x32_bf16 v[64:67], v[212:215], v[232:235], v[64:67]
    v_mfma_f32_16x16x32_bf16 v[84:87], v[212:215], v[236:239], v[84:87]
    buffer_load_dwordx4 v[212:215], v2, s[68:71], s31 offen offset:2048 sc1
    v_mfma_f32_16x16x32_bf16 v[28:31], v[216:219], v[224:227], v[28:31]
    v_mfma_f32_16x16x32_bf16 v[48:51], v[216:219], v[228:231], v[48:51]
    v_mfma_f32_16x16x32_bf16 v[68:71], v[216:219], v[232:235], v[68:71]
    v_mfma_f32_16x16x32_bf16 v[88:91], v[216:219], v[236:239], v[88:91]
    buffer_load_dwordx4 v[216:219], v2, s[68:71], s31 offen offset:3072 sc1
    v_mfma_f32_16x16x32_bf16 v[32:35], v[220:223], v[224:227], v[32:35]
    v_mfma_f32_16x16x32_bf16 v[52:55], v[220:223], v[228:231], v[52:55]
    v_mfma_f32_16x16x32_bf16 v[72:75], v[220:223], v[232:235], v[72:75]
    v_mfma_f32_16x16x32_bf16 v[92:95], v[220:223], v[236:239], v[92:95]
    buffer_load_dwordx4 v[220:223], v3, s[68:71], s31 offen sc1
    buffer_load_dwordx4 v[224:227], v250, s[64:67], s30 offen sc1
    buffer_load_dwordx4 v[228:231], v251, s[64:67], s30 offen sc1
    buffer_load_dwordx4 v[232:235], v252, s[64:67], s30 offen sc1
    buffer_load_dwordx4 v[236:239], v253, s[64:67], s30 offen sc1
    s_waitcnt vmcnt(27)
    s_add_u32 s30, s25, 32
    s_mul_i32 s31, s30, 5120
    s_lshl_b32 s30, s30, 12
    v_mfma_f32_16x16x32_bf16 v[16:19], v[96:99], v[116:119], v[16:19]
    v_mfma_f32_16x16x32_bf16 v[36:39], v[96:99], v[120:123], v[36:39]
    v_mfma_f32_16x16x32_bf16 v[56:59], v[96:99], v[124:127], v[56:59]
    v_mfma_f32_16x16x32_bf16 v[76:79], v[96:99], v[128:131], v[76:79]
    buffer_load_dwordx4 v[96:99], v2, s[68:71], s31 offen offset:0 sc1
    v_mfma_f32_16x16x32_bf16 v[20:23], v[100:103], v[116:119], v[20:23]
    v_mfma_f32_16x16x32_bf16 v[40:43], v[100:103], v[120:123], v[40:43]
    v_mfma_f32_16x16x32_bf16 v[60:63], v[100:103], v[124:127], v[60:63]
    v_mfma_f32_16x16x32_bf16 v[80:83], v[100:103], v[128:131], v[80:83]
    buffer_load_dwordx4 v[100:103], v2, s[68:71], s31 offen offset:1024 sc1
    v_mfma_f32_16x16x32_bf16 v[24:27], v[104:107], v[116:119], v[24:27]
    v_mfma_f32_16x16x32_bf16 v[44:47], v[104:107], v[120:123], v[44:47]
    v_mfma_f32_16x16x32_bf16 v[64:67], v[104:107], v[124:127], v[64:67]
    v_mfma_f32_16x16x32_bf16 v[84:87], v[104:107], v[128:131], v[84:87]
    buffer_load_dwordx4 v[104:107], v2, s[68:71], s31 offen offset:2048 sc1
    v_mfma_f32_16x16x32_bf16 v[28:31], v[108:111], v[116:119], v[28:31]
    v_mfma_f32_16x16x32_bf16 v[48:51], v[108:111], v[120:123], v[48:51]
    v_mfma_f32_16x16x32_bf16 v[68:71], v[108:111], v[124:127], v[68:71]
    v_mfma_f32_16x16x32_bf16 v[88:91], v[108:111], v[128:131], v[88:91]
    buffer_load_dwordx4 v[108:111], v2, s[68:71], s31 offen offset:3072 sc1
    v_mfma_f32_16x16x32_bf16 v[32:35], v[112:115], v[116:119], v[32:35]
    v_mfma_f32_16x16x32_bf16 v[52:55], v[112:115], v[120:123], v[52:55]
    v_mfma_f32_16x16x32_bf16 v[72:75], v[112:115], v[124:127], v[72:75]
    v_mfma_f32_16x16x32_bf16 v[92:95], v[112:115], v[128:131], v[92:95]
    buffer_load_dwordx4 v[112:115], v3, s[68:71], s31 offen sc1
    buffer_load_dwordx4 v[116:119], v250, s[64:67], s30 offen sc1
    buffer_load_dwordx4 v[120:123], v251, s[64:67], s30 offen sc1
    buffer_load_dwordx4 v[124:127], v252, s[64:67], s30 offen sc1
    buffer_load_dwordx4 v[128:131], v253, s[64:67], s30 offen sc1
    s_waitcnt vmcnt(27)
    s_add_u32 s30, s25, 36
    s_mul_i32 s31, s30, 5120
    s_lshl_b32 s30, s30, 12
    v_mfma_f32_16x16x32_bf16 v[16:19], v[132:135], v[152:155], v[16:19]
    v_mfma_f32_16x16x32_bf16 v[36:39], v[132:135], v[156:159], v[36:39]
    v_mfma_f32_16x16x32_bf16 v[56:59], v[132:135], v[160:163], v[56:59]
    v_mfma_f32_16x16x32_bf16 v[76:79], v[132:135], v[164:167], v[76:79]
    buffer_load_dwordx4 v[132:135], v2, s[68:71], s31 offen offset:0 sc1
    v_mfma_f32_16x16x32_bf16 v[20:23], v[136:139], v[152:155], v[20:23]
    v_mfma_f32_16x16x32_bf16 v[40:43], v[136:139], v[156:159], v[40:43]
    v_mfma_f32_16x16x32_bf16 v[60:63], v[136:139], v[160:163], v[60:63]
    v_mfma_f32_16x16x32_bf16 v[80:83], v[136:139], v[164:167], v[80:83]
    buffer_load_dwordx4 v[136:139], v2, s[68:71], s31 offen offset:1024 sc1
    v_mfma_f32_16x16x32_bf16 v[24:27], v[140:143], v[152:155], v[24:27]
    v_mfma_f32_16x16x32_bf16 v[44:47], v[140:143], v[156:159], v[44:47]
    v_mfma_f32_16x16x32_bf16 v[64:67], v[140:143], v[160:163], v[64:67]
    v_mfma_f32_16x16x32_bf16 v[84:87], v[140:143], v[164:167], v[84:87]
    buffer_load_dwordx4 v[140:143], v2, s[68:71], s31 offen offset:2048 sc1
    v_mfma_f32_16x16x32_bf16 v[28:31], v[144:147], v[152:155], v[28:31]
    v_mfma_f32_16x16x32_bf16 v[48:51], v[144:147], v[156:159], v[48:51]
    v_mfma_f32_16x16x32_bf16 v[68:71], v[144:147], v[160:163], v[68:71]
    v_mfma_f32_16x16x32_bf16 v[88:91], v[144:147], v[164:167], v[88:91]
    buffer_load_dwordx4 v[144:147], v2, s[68:71], s31 offen offset:3072 sc1
    v_mfma_f32_16x16x32_bf16 v[32:35], v[148:151], v[152:155], v[32:35]
    v_mfma_f32_16x16x32_bf16 v[52:55], v[148:151], v[156:159], v[52:55]
    v_mfma_f32_16x16x32_bf16 v[72:75], v[148:151], v[160:163], v[72:75]
    v_mfma_f32_16x16x32_bf16 v[92:95], v[148:151], v[164:167], v[92:95]
    buffer_load_dwordx4 v[148:151], v3, s[68:71], s31 offen sc1
    buffer_load_dwordx4 v[152:155], v250, s[64:67], s30 offen sc1
    buffer_load_dwordx4 v[156:159], v251, s[64:67], s30 offen sc1
    buffer_load_dwordx4 v[160:163], v252, s[64:67], s30 offen sc1
    buffer_load_dwordx4 v[164:167], v253, s[64:67], s30 offen sc1
    s_waitcnt vmcnt(27)
    s_add_u32 s30, s25, 40
    s_mul_i32 s31, s30, 5120
    s_lshl_b32 s30, s30, 12
    v_mfma_f32_16x16x32_bf16 v[16:19], v[168:171], v[188:191], v[16:19]
    v_mfma_f32_16x16x32_bf16 v[36:39], v[168:171], v[192:195], v[36:39]
    v_mfma_f32_16x16x32_bf16 v[56:59], v[168:171], v[196:199], v[56:59]
    v_mfma_f32_16x16x32_bf16 v[76:79], v[168:171], v[200:203], v[76:79]
    buffer_load_dwordx4 v[168:171], v2, s[68:71], s31 offen offset:0 sc1
    v_mfma_f32_16x16x32_bf16 v[20:23], v[172:175], v[188:191], v[20:23]
    v_mfma_f32_16x16x32_bf16 v[40:43], v[172:175], v[192:195], v[40:43]
    v_mfma_f32_16x16x32_bf16 v[60:63], v[172:175], v[196:199], v[60:63]
    v_mfma_f32_16x16x32_bf16 v[80:83], v[172:175], v[200:203], v[80:83]
    buffer_load_dwordx4 v[172:175], v2, s[68:71], s31 offen offset:1024 sc1
    v_mfma_f32_16x16x32_bf16 v[24:27], v[176:179], v[188:191], v[24:27]
    v_mfma_f32_16x16x32_bf16 v[44:47], v[176:179], v[192:195], v[44:47]
    v_mfma_f32_16x16x32_bf16 v[64:67], v[176:179], v[196:199], v[64:67]
    v_mfma_f32_16x16x32_bf16 v[84:87], v[176:179], v[200:203], v[84:87]
    buffer_load_dwordx4 v[176:179], v2, s[68:71], s31 offen offset:2048 sc1
    v_mfma_f32_16x16x32_bf16 v[28:31], v[180:183], v[188:191], v[28:31]
    v_mfma_f32_16x16x32_bf16 v[48:51], v[180:183], v[192:195], v[48:51]
    v_mfma_f32_16x16x32_bf16 v[68:71], v[180:183], v[196:199], v[68:71]
    v_mfma_f32_16x16x32_bf16 v[88:91], v[180:183], v[200:203], v[88:91]
    buffer_load_dwordx4 v[180:183], v2, s[68:71], s31 offen offset:3072 sc1
    v_mfma_f32_16x16x32_bf16 v[32:35], v[184:187], v[188:191], v[32:35]
    v_mfma_f32_16x16x32_bf16 v[52:55], v[184:187], v[192:195], v[52:55]
    v_mfma_f32_16x16x32_bf16 v[72:75], v[184:187], v[196:199], v[72:75]
    v_mfma_f32_16x16x32_bf16 v[92:95], v[184:187], v[200:203], v[92:95]
    buffer_load_dwordx4 v[184:187], v3, s[68:71], s31 offen sc1
    buffer_load_dwordx4 v[188:191], v250, s[64:67], s30 offen sc1
    buffer_load_dwordx4 v[192:195], v251, s[64:67], s30 offen sc1
    buffer_load_dwordx4 v[196:199], v252, s[64:67], s30 offen sc1
    buffer_load_dwordx4 v[200:203], v253, s[64:67], s30 offen sc1
    s_waitcnt vmcnt(27)
    s_add_u32 s30, s25, 44
    s_mul_i32 s31, s30, 5120
    s_lshl_b32 s30, s30, 12
    v_mfma_f32_16x16x32_bf16 v[16:19], v[204:207], v[224:227], v[16:19]
    v_mfma_f32_16x16x32_bf16 v[36:39], v[204:207], v[228:231], v[36:39]
    v_mfma_f32_16x16x32_bf16 v[56:59], v[204:207], v[232:235], v[56:59]
    v_mfma_f32_16x16x32_bf16 v[76:79], v[204:207], v[236:239], v[76:79]
    buffer_load_dwordx4 v[204:207], v2, s[68:71], s31 offen offset:0 sc1
    v_mfma_f32_16x16x32_bf16 v[20:23], v[208:211], v[224:227], v[20:23]
    v_mfma_f32_16x16x32_bf16 v[40:43], v[208:211], v[228:231], v[40:43]
    v_mfma_f32_16x16x32_bf16 v[60:63], v[208:211], v[232:235], v[60:63]
    v_mfma_f32_16x16x32_bf16 v[80:83], v[208:211], v[236:239], v[80:83]
    buffer_load_dwordx4 v[208:211], v2, s[68:71], s31 offen offset:1024 sc1
    v_mfma_f32_16x16x32_bf16 v[24:27], v[212:215], v[224:227], v[24:27]
    v_mfma_f32_16x16x32_bf16 v[44:47], v[212:215], v[228:231], v[44:47]
    v_mfma_f32_16x16x32_bf16 v[64:67], v[212:215], v[232:235], v[64:67]
    v_mfma_f32_16x16x32_bf16 v[84:87], v[212:215], v[236:239], v[84:87]
    buffer_load_dwordx4 v[212:215], v2, s[68:71], s31 offen offset:2048 sc1
    v_mfma_f32_16x16x32_bf16 v[28:31], v[216:219], v[224:227], v[28:31]
    v_mfma_f32_16x16x32_bf16 v[48:51], v[216:219], v[228:231], v[48:51]
    v_mfma_f32_16x16x32_bf16 v[68:71], v[216:219], v[232:235], v[68:71]
    v_mfma_f32_16x16x32_bf16 v[88:91], v[216:219], v[236:239], v[88:91]
    buffer_load_dwordx4 v[216:219], v2, s[68:71], s31 offen offset:3072 sc1
    v_mfma_f32_16x16x32_bf16 v[32:35], v[220:223], v[224:227], v[32:35]
    v_mfma_f32_16x16x32_bf16 v[52:55], v[220:223], v[228:231], v[52:55]
    v_mfma_f32_16x16x32_bf16 v[72:75], v[220:223], v[232:235], v[72:75]
    v_mfma_f32_16x16x32_bf16 v[92:95], v[220:223], v[236:239], v[92:95]
    buffer_load_dwordx4 v[220:223], v3, s[68:71], s31 offen sc1
    buffer_load_dwordx4 v[224:227], v250, s[64:67], s30 offen sc1
    buffer_load_dwordx4 v[228:231], v251, s[64:67], s30 offen sc1
    buffer_load_dwordx4 v[232:235], v252, s[64:67], s30 offen sc1
    buffer_load_dwordx4 v[236:239], v253, s[64:67], s30 offen sc1
    s_waitcnt vmcnt(27)
    s_add_u32 s30, s25, 48
    s_mul_i32 s31, s30, 5120
    s_lshl_b32 s30, s30, 12
    v_mfma_f32_16x16x32_bf16 v[16:19], v[96:99], v[116:119], v[16:19]
    v_mfma_f32_16x16x32_bf16 v[36:39], v[96:99], v[120:123], v[36:39]
    v_mfma_f32_16x16x32_bf16 v[56:59], v[96:99], v[124:127], v[56:59]
    v_mfma_f32_16x16x32_bf16 v[76:79], v[96:99], v[128:131], v[76:79]
    buffer_load_dwordx4 v[96:99], v2, s[68:71], s31 offen offset:0 sc1
    v_mfma_f32_16x16x32_bf16 v[20:23], v[100:103], v[116:119], v[20:23]
    v_mfma_f32_16x16x32_bf16 v[40:43], v[100:103], v[120:123], v[40:43]
    v_mfma_f32_16x16x32_bf16 v[60:63], v[100:103], v[124:127], v[60:63]
    v_mfma_f32_16x16x32_bf16 v[80:83], v[100:103], v[128:131], v[80:83]
    buffer_load_dwordx4 v[100:103], v2, s[68:71], s31 offen offset:1024 sc1
    v_mfma_f32_16x16x32_bf16 v[24:27], v[104:107], v[116:119], v[24:27]
    v_mfma_f32_16x16x32_bf16 v[44:47], v[104:107], v[120:123], v[44:47]
    v_mfma_f32_16x16x32_bf16 v[64:67], v[104:107], v[124:127], v[64:67]
    v_mfma_f32_16x16x32_bf16 v[84:87], v[104:107], v[128:131], v[84:87]
    buffer_load_dwordx4 v[104:107], v2, s[68:71], s31 offen offset:2048 sc1
    v_mfma_f32_16x16x32_bf16 v[28:31], v[108:111], v[116:119], v[28:31]
    v_mfma_f32_16x16x32_bf16 v[48:51], v[108:111], v[120:123], v[48:51]
    v_mfma_f32_16x16x32_bf16 v[68:71], v[108:111], v[124:127], v[68:71]
    v_mfma_f32_16x16x32_bf16 v[88:91], v[108:111], v[128:131], v[88:91]
    buffer_load_dwordx4 v[108:111], v2, s[68:71], s31 offen offset:3072 sc1
    v_mfma_f32_16x16x32_bf16 v[32:35], v[112:115], v[116:119], v[32:35]
    v_mfma_f32_16x16x32_bf16 v[52:55], v[112:115], v[120:123], v[52:55]
    v_mfma_f32_16x16x32_bf16 v[72:75], v[112:115], v[124:127], v[72:75]
    v_mfma_f32_16x16x32_bf16 v[92:95], v[112:115], v[128:131], v[92:95]
    buffer_load_dwordx4 v[112:115], v3, s[68:71], s31 offen sc1
    buffer_load_dwordx4 v[116:119], v250, s[64:67], s30 offen sc1
    buffer_load_dwordx4 v[120:123], v251, s[64:67], s30 offen sc1
    buffer_load_dwordx4 v[124:127], v252, s[64:67], s30 offen sc1
    buffer_load_dwordx4 v[128:131], v253, s[64:67], s30 offen sc1
    s_waitcnt vmcnt(27)
    global_load_dword v255, v254, s[62:63] sc1
    s_add_u32 s30, s25, 52
    s_cmp_lt_u32 s30, 54
    s_cselect_b32 s30, s30, 0x1000
    s_mul_i32 s31, s30, 5120
    s_lshl_b32 s30, s30, 12
    v_mfma_f32_16x16x32_bf16 v[16:19], v[132:135], v[152:155], v[16:19]
    v_mfma_f32_16x16x32_bf16 v[36:39], v[132:135], v[156:159], v[36:39]
    v_mfma_f32_16x16x32_bf16 v[56:59], v[132:135], v[160:163], v[56:59]
    v_mfma_f32_16x16x32_bf16 v[76:79], v[132:135], v[164:167], v[76:79]
    buffer_load_dwordx4 v[132:135], v2, s[68:71], s31 offen offset:0 sc1
    v_mfma_f32_16x16x32_bf16 v[20:23], v[136:139], v[152:155], v[20:23]
    v_mfma_f32_16x16x32_bf16 v[40:43], v[136:139], v[156:159], v[40:43]
    v_mfma_f32_16x16x32_bf16 v[60:63], v[136:139], v[160:163], v[60:63]
    v_mfma_f32_16x16x32_bf16 v[80:83], v[136:139], v[164:167], v[80:83]
    buffer_load_dwordx4 v[136:139], v2, s[68:71], s31 offen offset:1024 sc1
    v_mfma_f32_16x16x32_bf16 v[24:27], v[140:143], v[152:155], v[24:27]
    v_mfma_f32_16x16x32_bf16 v[44:47], v[140:143], v[156:159], v[44:47]
    v_mfma_f32_16x16x32_bf16 v[64:67], v[140:143], v[160:163], v[64:67]
    v_mfma_f32_16x16x32_bf16 v[84:87], v[140:143], v[164:167], v[84:87]
    buffer_load_dwordx4 v[140:143], v2, s[68:71], s31 offen offset:2048 sc1
    v_mfma_f32_16x16x32_bf16 v[28:31], v[144:147], v[152:155], v[28:31]
    v_mfma_f32_16x16x32_bf16 v[48:51], v[144:147], v[156:159], v[48:51]
    v_mfma_f32_16x16x32_bf16 v[68:71], v[144:147], v[160:163], v[68:71]
    v_mfma_f32_16x16x32_bf16 v[88:91], v[144:147], v[164:167], v[88:91]
    buffer_load_dwordx4 v[144:147], v2, s[68:71], s31 offen offset:3072 sc1
    v_mfma_f32_16x16x32_bf16 v[32:35], v[148:151], v[152:155], v[32:35]
    v_mfma_f32_16x16x32_bf16 v[52:55], v[148:151], v[156:159], v[52:55]
    v_mfma_f32_16x16x32_bf16 v[72:75], v[148:151], v[160:163], v[72:75]
    v_mfma_f32_16x16x32_bf16 v[92:95], v[148:151], v[164:167], v[92:95]
    buffer_load_dwordx4 v[148:151], v3, s[68:71], s31 offen sc1
    buffer_load_dwordx4 v[152:155], v250, s[64:67], s30 offen sc1
    buffer_load_dwordx4 v[156:159], v251, s[64:67], s30 offen sc1
    buffer_load_dwordx4 v[160:163], v252, s[64:67], s30 offen sc1
    buffer_load_dwordx4 v[164:167], v253, s[64:67], s30 offen sc1
    s_waitcnt vmcnt(28)
    s_waitcnt vmcnt(9)
    s_cmp_lg_u32 s25, 0
    s_cbranch_scc1 KF_GN_YO
KF_P_YO:
    v_cmp_eq_u32 vcc, s4, v255
    s_nop 0
    s_and_b32 s37, vcc_lo, 0xffffffff
    s_cmp_eq_u32 s37, 0xffffffff
    s_cbranch_scc1 KF_POK_YO
    s_sleep 2
    global_load_dword v255, v254, s[62:63] sc1
    s_waitcnt vmcnt(0)
    s_branch KF_P_YO
KF_POK_YO:
    v_mov_b32 v12, 159744
    v_mov_b32_e64 v13, 1
    ds_write_b32 v12, v13 offset:12
    s_branch KF_GD_YO
KF_GN_YO:
    v_cmp_eq_u32 vcc, s4, v255
    s_nop 0
    s_and_b32 s37, vcc_lo, 0xffffffff
    s_cmp_eq_u32 s37, 0xffffffff
    s_cbranch_scc1 KF_GD_YO
    v_mov_b32 v12, 159744
KF_GL_YO_W:
    ds_read_b32 v13, v12 offset:12
    s_waitcnt lgkmcnt(0)
    v_readfirstlane_b32 s37, v13
    s_nop 0
    s_cmp_eq_u32 s37, 1
    s_cbranch_scc1 KF_GL_YO_D
    s_sleep 3
    s_branch KF_GL_YO_W
KF_GL_YO_D:
KF_GD_YO:
    s_add_u32 s30, s25, 54
    s_mul_i32 s31, s30, 5120
    s_lshl_b32 s30, s30, 12
    v_mfma_f32_16x16x32_bf16 v[16:19], v[168:171], v[188:191], v[16:19]
    v_mfma_f32_16x16x32_bf16 v[36:39], v[168:171], v[192:195], v[36:39]
    v_mfma_f32_16x16x32_bf16 v[56:59], v[168:171], v[196:199], v[56:59]
    v_mfma_f32_16x16x32_bf16 v[76:79], v[168:171], v[200:203], v[76:79]
    buffer_load_dwordx4 v[168:171], v2, s[68:71], s31 offen offset:0 sc1
    v_mfma_f32_16x16x32_bf16 v[20:23], v[172:175], v[188:191], v[20:23]
    v_mfma_f32_16x16x32_bf16 v[40:43], v[172:175], v[192:195], v[40:43]
    v_mfma_f32_16x16x32_bf16 v[60:63], v[172:175], v[196:199], v[60:63]
    v_mfma_f32_16x16x32_bf16 v[80:83], v[172:175], v[200:203], v[80:83]
    buffer_load_dwordx4 v[172:175], v2, s[68:71], s31 offen offset:1024 sc1
    v_mfma_f32_16x16x32_bf16 v[24:27], v[176:179], v[188:191], v[24:27]
    v_mfma_f32_16x16x32_bf16 v[44:47], v[176:179], v[192:195], v[44:47]
    v_mfma_f32_16x16x32_bf16 v[64:67], v[176:179], v[196:199], v[64:67]
    v_mfma_f32_16x16x32_bf16 v[84:87], v[176:179], v[200:203], v[84:87]
    buffer_load_dwordx4 v[176:179], v2, s[68:71], s31 offen offset:2048 sc1
    v_mfma_f32_16x16x32_bf16 v[28:31], v[180:183], v[188:191], v[28:31]
    v_mfma_f32_16x16x32_bf16 v[48:51], v[180:183], v[192:195], v[48:51]
    v_mfma_f32_16x16x32_bf16 v[68:71], v[180:183], v[196:199], v[68:71]
    v_mfma_f32_16x16x32_bf16 v[88:91], v[180:183], v[200:203], v[88:91]
    buffer_load_dwordx4 v[180:183], v2, s[68:71], s31 offen offset:3072 sc1
    v_mfma_f32_16x16x32_bf16 v[32:35], v[184:187], v[188:191], v[32:35]
    v_mfma_f32_16x16x32_bf16 v[52:55], v[184:187], v[192:195], v[52:55]
    v_mfma_f32_16x16x32_bf16 v[72:75], v[184:187], v[196:199], v[72:75]
    v_mfma_f32_16x16x32_bf16 v[92:95], v[184:187], v[200:203], v[92:95]
    buffer_load_dwordx4 v[184:187], v3, s[68:71], s31 offen sc1
    buffer_load_dwordx4 v[188:191], v250, s[64:67], s30 offen sc1
    buffer_load_dwordx4 v[192:195], v251, s[64:67], s30 offen sc1
    buffer_load_dwordx4 v[196:199], v252, s[64:67], s30 offen sc1
    buffer_load_dwordx4 v[200:203], v253, s[64:67], s30 offen sc1
    s_add_u32 s30, s25, 58
    s_mul_i32 s31, s30, 5120
    s_lshl_b32 s30, s30, 12
    v_mfma_f32_16x16x32_bf16 v[16:19], v[204:207], v[224:227], v[16:19]
    v_mfma_f32_16x16x32_bf16 v[36:39], v[204:207], v[228:231], v[36:39]
    v_mfma_f32_16x16x32_bf16 v[56:59], v[204:207], v[232:235], v[56:59]
    v_mfma_f32_16x16x32_bf16 v[76:79], v[204:207], v[236:239], v[76:79]
    buffer_load_dwordx4 v[204:207], v2, s[68:71], s31 offen offset:0 sc1
    v_mfma_f32_16x16x32_bf16 v[20:23], v[208:211], v[224:227], v[20:23]
    v_mfma_f32_16x16x32_bf16 v[40:43], v[208:211], v[228:231], v[40:43]
    v_mfma_f32_16x16x32_bf16 v[60:63], v[208:211], v[232:235], v[60:63]
    v_mfma_f32_16x16x32_bf16 v[80:83], v[208:211], v[236:239], v[80:83]
    buffer_load_dwordx4 v[208:211], v2, s[68:71], s31 offen offset:1024 sc1
    v_mfma_f32_16x16x32_bf16 v[24:27], v[212:215], v[224:227], v[24:27]
    v_mfma_f32_16x16x32_bf16 v[44:47], v[212:215], v[228:231], v[44:47]
    v_mfma_f32_16x16x32_bf16 v[64:67], v[212:215], v[232:235], v[64:67]
    v_mfma_f32_16x16x32_bf16 v[84:87], v[212:215], v[236:239], v[84:87]
    buffer_load_dwordx4 v[212:215], v2, s[68:71], s31 offen offset:2048 sc1
    v_mfma_f32_16x16x32_bf16 v[28:31], v[216:219], v[224:227], v[28:31]
    v_mfma_f32_16x16x32_bf16 v[48:51], v[216:219], v[228:231], v[48:51]
    v_mfma_f32_16x16x32_bf16 v[68:71], v[216:219], v[232:235], v[68:71]
    v_mfma_f32_16x16x32_bf16 v[88:91], v[216:219], v[236:239], v[88:91]
    buffer_load_dwordx4 v[216:219], v2, s[68:71], s31 offen offset:3072 sc1
    v_mfma_f32_16x16x32_bf16 v[32:35], v[220:223], v[224:227], v[32:35]
    v_mfma_f32_16x16x32_bf16 v[52:55], v[220:223], v[228:231], v[52:55]
    v_mfma_f32_16x16x32_bf16 v[72:75], v[220:223], v[232:235], v[72:75]
    v_mfma_f32_16x16x32_bf16 v[92:95], v[220:223], v[236:239], v[92:95]
    buffer_load_dwordx4 v[220:223], v3, s[68:71], s31 offen sc1
    buffer_load_dwordx4 v[224:227], v250, s[64:67], s30 offen sc1
    buffer_load_dwordx4 v[228:231], v251, s[64:67], s30 offen sc1
    buffer_load_dwordx4 v[232:235], v252, s[64:67], s30 offen sc1
    buffer_load_dwordx4 v[236:239], v253, s[64:67], s30 offen sc1
    s_add_u32 s30, s25, 62
    s_mul_i32 s31, s30, 5120
    s_lshl_b32 s30, s30, 12
    v_mfma_f32_16x16x32_bf16 v[16:19], v[96:99], v[116:119], v[16:19]
    v_mfma_f32_16x16x32_bf16 v[36:39], v[96:99], v[120:123], v[36:39]
    v_mfma_f32_16x16x32_bf16 v[56:59], v[96:99], v[124:127], v[56:59]
    v_mfma_f32_16x16x32_bf16 v[76:79], v[96:99], v[128:131], v[76:79]
    buffer_load_dwordx4 v[96:99], v2, s[68:71], s31 offen offset:0 sc1
    v_mfma_f32_16x16x32_bf16 v[20:23], v[100:103], v[116:119], v[20:23]
    v_mfma_f32_16x16x32_bf16 v[40:43], v[100:103], v[120:123], v[40:43]
    v_mfma_f32_16x16x32_bf16 v[60:63], v[100:103], v[124:127], v[60:63]
    v_mfma_f32_16x16x32_bf16 v[80:83], v[100:103], v[128:131], v[80:83]
    buffer_load_dwordx4 v[100:103], v2, s[68:71], s31 offen offset:1024 sc1
    v_mfma_f32_16x16x32_bf16 v[24:27], v[104:107], v[116:119], v[24:27]
    v_mfma_f32_16x16x32_bf16 v[44:47], v[104:107], v[120:123], v[44:47]
    v_mfma_f32_16x16x32_bf16 v[64:67], v[104:107], v[124:127], v[64:67]
    v_mfma_f32_16x16x32_bf16 v[84:87], v[104:107], v[128:131], v[84:87]
    buffer_load_dwordx4 v[104:107], v2, s[68:71], s31 offen offset:2048 sc1
    v_mfma_f32_16x16x32_bf16 v[28:31], v[108:111], v[116:119], v[28:31]
    v_mfma_f32_16x16x32_bf16 v[48:51], v[108:111], v[120:123], v[48:51]
    v_mfma_f32_16x16x32_bf16 v[68:71], v[108:111], v[124:127], v[68:71]
    v_mfma_f32_16x16x32_bf16 v[88:91], v[108:111], v[128:131], v[88:91]
    buffer_load_dwordx4 v[108:111], v2, s[68:71], s31 offen offset:3072 sc1
    v_mfma_f32_16x16x32_bf16 v[32:35], v[112:115], v[116:119], v[32:35]
    v_mfma_f32_16x16x32_bf16 v[52:55], v[112:115], v[120:123], v[52:55]
    v_mfma_f32_16x16x32_bf16 v[72:75], v[112:115], v[124:127], v[72:75]
    v_mfma_f32_16x16x32_bf16 v[92:95], v[112:115], v[128:131], v[92:95]
    buffer_load_dwordx4 v[112:115], v3, s[68:71], s31 offen sc1
    buffer_load_dwordx4 v[116:119], v250, s[64:67], s30 offen sc1
    buffer_load_dwordx4 v[120:123], v251, s[64:67], s30 offen sc1
    buffer_load_dwordx4 v[124:127], v252, s[64:67], s30 offen sc1
    buffer_load_dwordx4 v[128:131], v253, s[64:67], s30 offen sc1
    s_waitcnt vmcnt(27)
    s_add_u32 s30, s25, 66
    s_mul_i32 s31, s30, 5120
    s_lshl_b32 s30, s30, 12
    v_mfma_f32_16x16x32_bf16 v[16:19], v[132:135], v[152:155], v[16:19]
    v_mfma_f32_16x16x32_bf16 v[36:39], v[132:135], v[156:159], v[36:39]
    v_mfma_f32_16x16x32_bf16 v[56:59], v[132:135], v[160:163], v[56:59]
    v_mfma_f32_16x16x32_bf16 v[76:79], v[132:135], v[164:167], v[76:79]
    buffer_load_dwordx4 v[132:135], v2, s[68:71], s31 offen offset:0 sc1
    v_mfma_f32_16x16x32_bf16 v[20:23], v[136:139], v[152:155], v[20:23]
    v_mfma_f32_16x16x32_bf16 v[40:43], v[136:139], v[156:159], v[40:43]
    v_mfma_f32_16x16x32_bf16 v[60:63], v[136:139], v[160:163], v[60:63]
    v_mfma_f32_16x16x32_bf16 v[80:83], v[136:139], v[164:167], v[80:83]
    buffer_load_dwordx4 v[136:139], v2, s[68:71], s31 offen offset:1024 sc1
    v_mfma_f32_16x16x32_bf16 v[24:27], v[140:143], v[152:155], v[24:27]
    v_mfma_f32_16x16x32_bf16 v[44:47], v[140:143], v[156:159], v[44:47]
    v_mfma_f32_16x16x32_bf16 v[64:67], v[140:143], v[160:163], v[64:67]
    v_mfma_f32_16x16x32_bf16 v[84:87], v[140:143], v[164:167], v[84:87]
    buffer_load_dwordx4 v[140:143], v2, s[68:71], s31 offen offset:2048 sc1
    v_mfma_f32_16x16x32_bf16 v[28:31], v[144:147], v[152:155], v[28:31]
    v_mfma_f32_16x16x32_bf16 v[48:51], v[144:147], v[156:159], v[48:51]
    v_mfma_f32_16x16x32_bf16 v[68:71], v[144:147], v[160:163], v[68:71]
    v_mfma_f32_16x16x32_bf16 v[88:91], v[144:147], v[164:167], v[88:91]
    buffer_load_dwordx4 v[144:147], v2, s[68:71], s31 offen offset:3072 sc1
    v_mfma_f32_16x16x32_bf16 v[32:35], v[148:151], v[152:155], v[32:35]
    v_mfma_f32_16x16x32_bf16 v[52:55], v[148:151], v[156:159], v[52:55]
    v_mfma_f32_16x16x32_bf16 v[72:75], v[148:151], v[160:163], v[72:75]
    v_mfma_f32_16x16x32_bf16 v[92:95], v[148:151], v[164:167], v[92:95]
    buffer_load_dwordx4 v[148:151], v3, s[68:71], s31 offen sc1
    buffer_load_dwordx4 v[152:155], v250, s[64:67], s30 offen sc1
    buffer_load_dwordx4 v[156:159], v251, s[64:67], s30 offen sc1
    buffer_load_dwordx4 v[160:163], v252, s[64:67], s30 offen sc1
    buffer_load_dwordx4 v[164:167], v253, s[64:67], s30 offen sc1
    s_waitcnt vmcnt(27)
    s_add_u32 s30, s25, 70
    s_mul_i32 s31, s30, 5120
    s_lshl_b32 s30, s30, 12
    v_mfma_f32_16x16x32_bf16 v[16:19], v[168:171], v[188:191], v[16:19]
    v_mfma_f32_16x16x32_bf16 v[36:39], v[168:171], v[192:195], v[36:39]
    v_mfma_f32_16x16x32_bf16 v[56:59], v[168:171], v[196:199], v[56:59]
    v_mfma_f32_16x16x32_bf16 v[76:79], v[168:171], v[200:203], v[76:79]
    buffer_load_dwordx4 v[168:171], v2, s[68:71], s31 offen offset:0 sc1
    v_mfma_f32_16x16x32_bf16 v[20:23], v[172:175], v[188:191], v[20:23]
    v_mfma_f32_16x16x32_bf16 v[40:43], v[172:175], v[192:195], v[40:43]
    v_mfma_f32_16x16x32_bf16 v[60:63], v[172:175], v[196:199], v[60:63]
    v_mfma_f32_16x16x32_bf16 v[80:83], v[172:175], v[200:203], v[80:83]
    buffer_load_dwordx4 v[172:175], v2, s[68:71], s31 offen offset:1024 sc1
    v_mfma_f32_16x16x32_bf16 v[24:27], v[176:179], v[188:191], v[24:27]
    v_mfma_f32_16x16x32_bf16 v[44:47], v[176:179], v[192:195], v[44:47]
    v_mfma_f32_16x16x32_bf16 v[64:67], v[176:179], v[196:199], v[64:67]
    v_mfma_f32_16x16x32_bf16 v[84:87], v[176:179], v[200:203], v[84:87]
    buffer_load_dwordx4 v[176:179], v2, s[68:71], s31 offen offset:2048 sc1
    v_mfma_f32_16x16x32_bf16 v[28:31], v[180:183], v[188:191], v[28:31]
    v_mfma_f32_16x16x32_bf16 v[48:51], v[180:183], v[192:195], v[48:51]
    v_mfma_f32_16x16x32_bf16 v[68:71], v[180:183], v[196:199], v[68:71]
    v_mfma_f32_16x16x32_bf16 v[88:91], v[180:183], v[200:203], v[88:91]
    buffer_load_dwordx4 v[180:183], v2, s[68:71], s31 offen offset:3072 sc1
    v_mfma_f32_16x16x32_bf16 v[32:35], v[184:187], v[188:191], v[32:35]
    v_mfma_f32_16x16x32_bf16 v[52:55], v[184:187], v[192:195], v[52:55]
    v_mfma_f32_16x16x32_bf16 v[72:75], v[184:187], v[196:199], v[72:75]
    v_mfma_f32_16x16x32_bf16 v[92:95], v[184:187], v[200:203], v[92:95]
    buffer_load_dwordx4 v[184:187], v3, s[68:71], s31 offen sc1
    buffer_load_dwordx4 v[188:191], v250, s[64:67], s30 offen sc1
    buffer_load_dwordx4 v[192:195], v251, s[64:67], s30 offen sc1
    buffer_load_dwordx4 v[196:199], v252, s[64:67], s30 offen sc1
    buffer_load_dwordx4 v[200:203], v253, s[64:67], s30 offen sc1
    buffer_load_dwordx2 v[240:241], v4, s[8:11], 0 offen offset:0
    buffer_load_dwordx2 v[242:243], v4, s[8:11], 0 offen offset:32
    buffer_load_dwordx2 v[244:245], v4, s[8:11], 0 offen offset:64
    buffer_load_dwordx2 v[246:247], v4, s[8:11], 0 offen offset:96
    buffer_load_dwordx2 v[248:249], v4, s[8:11], 0 offen offset:128
    s_waitcnt vmcnt(32)
    v_mfma_f32_16x16x32_bf16 v[16:19], v[204:207], v[224:227], v[16:19]
    v_mfma_f32_16x16x32_bf16 v[36:39], v[204:207], v[228:231], v[36:39]
    v_mfma_f32_16x16x32_bf16 v[56:59], v[204:207], v[232:235], v[56:59]
    v_mfma_f32_16x16x32_bf16 v[76:79], v[204:207], v[236:239], v[76:79]
    v_mfma_f32_16x16x32_bf16 v[20:23], v[208:211], v[224:227], v[20:23]
    v_mfma_f32_16x16x32_bf16 v[40:43], v[208:211], v[228:231], v[40:43]
    v_mfma_f32_16x16x32_bf16 v[60:63], v[208:211], v[232:235], v[60:63]
    v_mfma_f32_16x16x32_bf16 v[80:83], v[208:211], v[236:239], v[80:83]
    v_mfma_f32_16x16x32_bf16 v[24:27], v[212:215], v[224:227], v[24:27]
    v_mfma_f32_16x16x32_bf16 v[44:47], v[212:215], v[228:231], v[44:47]
    v_mfma_f32_16x16x32_bf16 v[64:67], v[212:215], v[232:235], v[64:67]
    v_mfma_f32_16x16x32_bf16 v[84:87], v[212:215], v[236:239], v[84:87]
    v_mfma_f32_16x16x32_bf16 v[28:31], v[216:219], v[224:227], v[28:31]
    v_mfma_f32_16x16x32_bf16 v[48:51], v[216:219], v[228:231], v[48:51]
    v_mfma_f32_16x16x32_bf16 v[68:71], v[216:219], v[232:235], v[68:71]
    v_mfma_f32_16x16x32_bf16 v[88:91], v[216:219], v[236:239], v[88:91]
    v_mfma_f32_16x16x32_bf16 v[32:35], v[220:223], v[224:227], v[32:35]
    v_mfma_f32_16x16x32_bf16 v[52:55], v[220:223], v[228:231], v[52:55]
    v_mfma_f32_16x16x32_bf16 v[72:75], v[220:223], v[232:235], v[72:75]
    v_mfma_f32_16x16x32_bf16 v[92:95], v[220:223], v[236:239], v[92:95]
    s_waitcnt vmcnt(23)
    v_mfma_f32_16x16x32_bf16 v[16:19], v[96:99], v[116:119], v[16:19]
    v_mfma_f32_16x16x32_bf16 v[36:39], v[96:99], v[120:123], v[36:39]
    v_mfma_f32_16x16x32_bf16 v[56:59], v[96:99], v[124:127], v[56:59]
    v_mfma_f32_16x16x32_bf16 v[76:79], v[96:99], v[128:131], v[76:79]
    v_mfma_f32_16x16x32_bf16 v[20:23], v[100:103], v[116:119], v[20:23]
    v_mfma_f32_16x16x32_bf16 v[40:43], v[100:103], v[120:123], v[40:43]
    v_mfma_f32_16x16x32_bf16 v[60:63], v[100:103], v[124:127], v[60:63]
    v_mfma_f32_16x16x32_bf16 v[80:83], v[100:103], v[128:131], v[80:83]
    v_mfma_f32_16x16x32_bf16 v[24:27], v[104:107], v[116:119], v[24:27]
    v_mfma_f32_16x16x32_bf16 v[44:47], v[104:107], v[120:123], v[44:47]
    v_mfma_f32_16x16x32_bf16 v[64:67], v[104:107], v[124:127], v[64:67]
    v_mfma_f32_16x16x32_bf16 v[84:87], v[104:107], v[128:131], v[84:87]
    v_mfma_f32_16x16x32_bf16 v[28:31], v[108:111], v[116:119], v[28:31]
    v_mfma_f32_16x16x32_bf16 v[48:51], v[108:111], v[120:123], v[48:51]
    v_mfma_f32_16x16x32_bf16 v[68:71], v[108:111], v[124:127], v[68:71]
    v_mfma_f32_16x16x32_bf16 v[88:91], v[108:111], v[128:131], v[88:91]
    v_mfma_f32_16x16x32_bf16 v[32:35], v[112:115], v[116:119], v[32:35]
    v_mfma_f32_16x16x32_bf16 v[52:55], v[112:115], v[120:123], v[52:55]
    v_mfma_f32_16x16x32_bf16 v[72:75], v[112:115], v[124:127], v[72:75]
    v_mfma_f32_16x16x32_bf16 v[92:95], v[112:115], v[128:131], v[92:95]
    s_waitcnt vmcnt(14)
    v_mfma_f32_16x16x32_bf16 v[16:19], v[132:135], v[152:155], v[16:19]
    v_mfma_f32_16x16x32_bf16 v[36:39], v[132:135], v[156:159], v[36:39]
    v_mfma_f32_16x16x32_bf16 v[56:59], v[132:135], v[160:163], v[56:59]
    v_mfma_f32_16x16x32_bf16 v[76:79], v[132:135], v[164:167], v[76:79]
    v_mfma_f32_16x16x32_bf16 v[20:23], v[136:139], v[152:155], v[20:23]
    v_mfma_f32_16x16x32_bf16 v[40:43], v[136:139], v[156:159], v[40:43]
    v_mfma_f32_16x16x32_bf16 v[60:63], v[136:139], v[160:163], v[60:63]
    v_mfma_f32_16x16x32_bf16 v[80:83], v[136:139], v[164:167], v[80:83]
    v_mfma_f32_16x16x32_bf16 v[24:27], v[140:143], v[152:155], v[24:27]
    v_mfma_f32_16x16x32_bf16 v[44:47], v[140:143], v[156:159], v[44:47]
    v_mfma_f32_16x16x32_bf16 v[64:67], v[140:143], v[160:163], v[64:67]
    v_mfma_f32_16x16x32_bf16 v[84:87], v[140:143], v[164:167], v[84:87]
    v_mfma_f32_16x16x32_bf16 v[28:31], v[144:147], v[152:155], v[28:31]
    v_mfma_f32_16x16x32_bf16 v[48:51], v[144:147], v[156:159], v[48:51]
    v_mfma_f32_16x16x32_bf16 v[68:71], v[144:147], v[160:163], v[68:71]
    v_mfma_f32_16x16x32_bf16 v[88:91], v[144:147], v[164:167], v[88:91]
    v_mfma_f32_16x16x32_bf16 v[32:35], v[148:151], v[152:155], v[32:35]
    v_mfma_f32_16x16x32_bf16 v[52:55], v[148:151], v[156:159], v[52:55]
    v_mfma_f32_16x16x32_bf16 v[72:75], v[148:151], v[160:163], v[72:75]
    v_mfma_f32_16x16x32_bf16 v[92:95], v[148:151], v[164:167], v[92:95]
    s_waitcnt vmcnt(5)
    v_mfma_f32_16x16x32_bf16 v[16:19], v[168:171], v[188:191], v[16:19]
    v_mfma_f32_16x16x32_bf16 v[36:39], v[168:171], v[192:195], v[36:39]
    v_mfma_f32_16x16x32_bf16 v[56:59], v[168:171], v[196:199], v[56:59]
    v_mfma_f32_16x16x32_bf16 v[76:79], v[168:171], v[200:203], v[76:79]
    v_mfma_f32_16x16x32_bf16 v[20:23], v[172:175], v[188:191], v[20:23]
    v_mfma_f32_16x16x32_bf16 v[40:43], v[172:175], v[192:195], v[40:43]
    v_mfma_f32_16x16x32_bf16 v[60:63], v[172:175], v[196:199], v[60:63]
    v_mfma_f32_16x16x32_bf16 v[80:83], v[172:175], v[200:203], v[80:83]
    v_mfma_f32_16x16x32_bf16 v[24:27], v[176:179], v[188:191], v[24:27]
    v_mfma_f32_16x16x32_bf16 v[44:47], v[176:179], v[192:195], v[44:47]
    v_mfma_f32_16x16x32_bf16 v[64:67], v[176:179], v[196:199], v[64:67]
    v_mfma_f32_16x16x32_bf16 v[84:87], v[176:179], v[200:203], v[84:87]
    v_mfma_f32_16x16x32_bf16 v[28:31], v[180:183], v[188:191], v[28:31]
    v_mfma_f32_16x16x32_bf16 v[48:51], v[180:183], v[192:195], v[48:51]
    v_mfma_f32_16x16x32_bf16 v[68:71], v[180:183], v[196:199], v[68:71]
    v_mfma_f32_16x16x32_bf16 v[88:91], v[180:183], v[200:203], v[88:91]
    v_mfma_f32_16x16x32_bf16 v[32:35], v[184:187], v[188:191], v[32:35]
    v_mfma_f32_16x16x32_bf16 v[52:55], v[184:187], v[192:195], v[52:55]
    v_mfma_f32_16x16x32_bf16 v[72:75], v[184:187], v[196:199], v[72:75]
    v_mfma_f32_16x16x32_bf16 v[92:95], v[184:187], v[200:203], v[92:95]
    s_add_u32 s30, s25, 1
    s_and_b32 s30, s30, 3
    s_nop 0
    s_mul_i32 s30, s30, 15360
    s_add_u32 s30, s30, 4096
    v_add_u32_e64 v5, s30, v2
    ds_write_b128 v5, v[36:39] offset:0
    ds_write_b128 v5, v[40:43] offset:1024
    ds_write_b128 v5, v[44:47] offset:2048
    ds_write_b128 v5, v[48:51] offset:3072
    ds_write_b128 v5, v[52:55] offset:4096
    s_add_u32 s30, s25, 2
    s_and_b32 s30, s30, 3
    s_mul_i32 s30, s30, 15360
    s_add_u32 s30, s30, 9216
    v_add_u32_e64 v5, s30, v2
    ds_write_b128 v5, v[56:59] offset:0
    ds_write_b128 v5, v[60:63] offset:1024
    ds_write_b128 v5, v[64:67] offset:2048
    ds_write_b128 v5, v[68:71] offset:3072
    ds_write_b128 v5, v[72:75] offset:4096
    s_add_u32 s30, s25, 3
    s_and_b32 s30, s30, 3
    s_mul_i32 s30, s30, 15360
    s_add_u32 s30, s30, 14336
    v_add_u32_e64 v5, s30, v2
    ds_write_b128 v5, v[76:79] offset:0
    ds_write_b128 v5, v[80:83] offset:1024
    ds_write_b128 v5, v[84:87] offset:2048
    ds_write_b128 v5, v[88:91] offset:3072
    ds_write_b128 v5, v[92:95] offset:4096
    s_waitcnt lgkmcnt(0)
    s_barrier
    s_mul_i32 s30, s25, 15360
    s_add_u32 s30, s30, 4096
    v_add_u32_e64 v5, s30, v2
    ds_read_b128 v[96:99], v5 offset:0
    ds_read_b128 v[116:119], v5 offset:5120
    ds_read_b128 v[136:139], v5 offset:10240
    ds_read_b128 v[100:103], v5 offset:1024
    ds_read_b128 v[120:123], v5 offset:6144
    ds_read_b128 v[140:143], v5 offset:11264
    ds_read_b128 v[104:107], v5 offset:2048
    ds_read_b128 v[124:127], v5 offset:7168
    ds_read_b128 v[144:147], v5 offset:12288
    ds_read_b128 v[108:111], v5 offset:3072
    ds_read_b128 v[128:131], v5 offset:8192
    ds_read_b128 v[148:151], v5 offset:13312
    ds_read_b128 v[112:115], v5 offset:4096
    ds_read_b128 v[132:135], v5 offset:9216
    ds_read_b128 v[152:155], v5 offset:14336
    s_waitcnt vmcnt(0)
    s_waitcnt lgkmcnt(12)
    v_add_f32 v16, v16, v96
    v_add_f32 v17, v17, v97
    v_add_f32 v18, v18, v98
    v_add_f32 v19, v19, v99
    v_add_f32 v16, v16, v116
    v_add_f32 v17, v17, v117
    v_add_f32 v18, v18, v118
    v_add_f32 v19, v19, v119
    v_add_f32 v16, v16, v136
    v_add_f32 v17, v17, v137
    v_add_f32 v18, v18, v138
    v_add_f32 v19, v19, v139
    v_lshlrev_b32_e64 v6, 16, v240
    v_and_b32 v7, 0xffff0000, v240
    v_add_f32 v16, v16, v6
    v_add_f32 v17, v17, v7
    v_lshlrev_b32_e64 v6, 16, v241
    v_and_b32 v7, 0xffff0000, v241
    v_add_f32 v18, v18, v6
    v_add_f32 v19, v19, v7
    v_cvt_pk_bf16_f32 v240, v16, v17
    v_cvt_pk_bf16_f32 v241, v18, v19
    buffer_store_dwordx2 v[240:241], v4, s[12:15], 0 offen offset:0
    s_waitcnt lgkmcnt(9)
    v_add_f32 v20, v20, v100
    v_add_f32 v21, v21, v101
    v_add_f32 v22, v22, v102
    v_add_f32 v23, v23, v103
    v_add_f32 v20, v20, v120
    v_add_f32 v21, v21, v121
    v_add_f32 v22, v22, v122
    v_add_f32 v23, v23, v123
    v_add_f32 v20, v20, v140
    v_add_f32 v21, v21, v141
    v_add_f32 v22, v22, v142
    v_add_f32 v23, v23, v143
    v_lshlrev_b32 v6, 16, v242
    v_and_b32 v7, 0xffff0000, v242
    v_add_f32 v20, v20, v6
    v_add_f32 v21, v21, v7
    v_lshlrev_b32_e64 v6, 16, v243
    v_and_b32 v7, 0xffff0000, v243
    v_add_f32 v22, v22, v6
    v_add_f32 v23, v23, v7
    v_cvt_pk_bf16_f32 v242, v20, v21
    v_cvt_pk_bf16_f32 v243, v22, v23
    buffer_store_dwordx2 v[242:243], v4, s[12:15], 0 offen offset:32
    s_waitcnt lgkmcnt(6)
    v_add_f32 v24, v24, v104
    v_add_f32 v25, v25, v105
    v_add_f32 v26, v26, v106
    v_add_f32 v27, v27, v107
    v_add_f32 v24, v24, v124
    v_add_f32 v25, v25, v125
    v_add_f32 v26, v26, v126
    v_add_f32 v27, v27, v127
    v_add_f32 v24, v24, v144
    v_add_f32 v25, v25, v145
    v_add_f32 v26, v26, v146
    v_add_f32 v27, v27, v147
    v_lshlrev_b32 v6, 16, v244
    v_and_b32 v7, 0xffff0000, v244
    v_add_f32 v24, v24, v6
    v_add_f32 v25, v25, v7
    v_lshlrev_b32_e64 v6, 16, v245
    v_and_b32 v7, 0xffff0000, v245
    v_add_f32 v26, v26, v6
    v_add_f32 v27, v27, v7
    v_cvt_pk_bf16_f32 v244, v24, v25
    v_cvt_pk_bf16_f32 v245, v26, v27
    buffer_store_dwordx2 v[244:245], v4, s[12:15], 0 offen offset:64
    s_waitcnt lgkmcnt(3)
    v_add_f32 v28, v28, v108
    v_add_f32 v29, v29, v109
    v_add_f32 v30, v30, v110
    v_add_f32 v31, v31, v111
    v_add_f32 v28, v28, v128
    v_add_f32 v29, v29, v129
    v_add_f32 v30, v30, v130
    v_add_f32 v31, v31, v131
    v_add_f32 v28, v28, v148
    v_add_f32 v29, v29, v149
    v_add_f32 v30, v30, v150
    v_add_f32 v31, v31, v151
    v_lshlrev_b32 v6, 16, v246
    v_and_b32 v7, 0xffff0000, v246
    v_add_f32 v28, v28, v6
    v_add_f32 v29, v29, v7
    v_lshlrev_b32_e64 v6, 16, v247
    v_and_b32 v7, 0xffff0000, v247
    v_add_f32 v30, v30, v6
    v_add_f32 v31, v31, v7
    v_cvt_pk_bf16_f32 v246, v28, v29
    v_cvt_pk_bf16_f32 v247, v30, v31
    buffer_store_dwordx2 v[246:247], v4, s[12:15], 0 offen offset:96
    s_waitcnt lgkmcnt(0)
    v_add_f32 v32, v32, v112
    v_add_f32 v33, v33, v113
    v_add_f32 v34, v34, v114
    v_add_f32 v35, v35, v115
    v_add_f32 v32, v32, v132
    v_add_f32 v33, v33, v133
    v_add_f32 v34, v34, v134
    v_add_f32 v35, v35, v135
    v_add_f32 v32, v32, v152
    v_add_f32 v33, v33, v153
    v_add_f32 v34, v34, v154
    v_add_f32 v35, v35, v155
    v_lshlrev_b32 v6, 16, v248
    v_and_b32 v7, 0xffff0000, v248
    v_add_f32 v32, v32, v6
    v_add_f32 v33, v33, v7
    v_lshlrev_b32_e64 v6, 16, v249
    v_and_b32 v7, 0xffff0000, v249
    v_add_f32 v34, v34, v6
    v_add_f32 v35, v35, v7
    v_cvt_pk_bf16_f32 v248, v32, v33
    v_cvt_pk_bf16_f32 v249, v34, v35
    buffer_store_dwordx2 v[248:249], v4, s[12:15], 0 offen offset:128
KF_EXIT:
    s_endpgm
.section .rodata,"a"
.p2align 6
.amdhsa_kernel parallel_sum__linear_kernel_hedgehog__dense_activation_relu__prompt_kernel
  .amdhsa_next_free_vgpr 256
  .amdhsa_next_free_sgpr 102
  .amdhsa_accum_offset 256
  .amdhsa_group_segment_fixed_size 0
  .amdhsa_kernarg_size 80
  .amdhsa_user_sgpr_count 2
  .amdhsa_user_sgpr_kernarg_segment_ptr 1
  .amdhsa_system_sgpr_workgroup_id_x 1
.end_amdhsa_kernel
```
